```python
import torch

def _softmax(x, axis=-1):
    return torch.softmax(x, dim=axis)
def _gelu(x):
    return torch.nn.functional.gelu(x, approximate="tanh")
def _silu(x):
    return torch.nn.functional.silu(x)
def _sigmoid(x):
    return torch.sigmoid(x)
def _layernorm(x, axis=-1, eps=1e-5):
    m = x.mean(dim=axis, keepdim=True)
    v = x.var(dim=axis, keepdim=True, unbiased=False)
    return (x - m) / torch.sqrt(v + eps)
def _scatter_add(tgt, idx, src, axis=0):
    return tgt.clone().index_add_(axis, idx, src)
def _segment_sum(src, seg, n):
    out = torch.zeros((n,) + src.shape[1:], dtype=src.dtype)
    return out.index_add_(0, seg, src)
def _pad(x, pw):
    flat = tuple(v for pair in reversed(pw) for v in pair)
    return torch.nn.functional.pad(x, flat)

kernel_name = 'concat_heads__gqa_block_cached__gqa_block_cached__near_ridge'

def setup_inputs():

    _w = (lambda a: (lambda t: t.to(torch.bfloat16) if t.is_floating_point() else t)(torch.as_tensor(a)))
    def _A_setup():
        B, Sq, D = 8, 112, 448
        Hq, Hkv, Sk, Dh = 16, 8, 2048, 256
        assert Hq % Hkv == 0, (Hq, Hkv)
        return {
            "x": _w((lambda *s: torch.randn(*s, dtype=torch.bfloat16) * 0.8)(B, Sq, D)),
            "k_cache": _w((lambda *s: torch.randn(*s, dtype=torch.bfloat16) * 0.8)(B, Hkv, Sk, Dh)),
            "v_cache": _w((lambda *s: torch.randn(*s, dtype=torch.bfloat16) * 0.05)(B, Hkv, Sk, Dh)),
            "wq": _w((lambda *s: torch.randn(*s, dtype=torch.bfloat16) * 0.8)(D, Hq * Dh) * (D ** -0.5)),
            "wo": _w((lambda *s: torch.randn(*s, dtype=torch.bfloat16) * 0.05)(Hq * Dh, D) * ((Hq * Dh) ** -0.5)),
        }
    _A_in = _A_setup()

    def _B_setup():
        B, Sq, D = 8, 112, 448
        Hq, Hkv, Sk, Dh = 16, 8, 2048, 256
        assert Hq % Hkv == 0, (Hq, Hkv)
        return {
            "x": _w((lambda *s: torch.randn(*s, dtype=torch.bfloat16) * 0.8)(B, Sq, D)),
            "k_cache": _w((lambda *s: torch.randn(*s, dtype=torch.bfloat16) * 0.8)(B, Hkv, Sk, Dh)),
            "v_cache": _w((lambda *s: torch.randn(*s, dtype=torch.bfloat16) * 0.05)(B, Hkv, Sk, Dh)),
            "wq": _w((lambda *s: torch.randn(*s, dtype=torch.bfloat16) * 0.8)(D, Hq * Dh) * (D ** -0.5)),
            "wo": _w((lambda *s: torch.randn(*s, dtype=torch.bfloat16) * 0.05)(Hq * Dh, D) * ((Hq * Dh) ** -0.5)),
        }
    _B_in = _B_setup()

    return {
        "A_x": _A_in["x"],
        "A_k_cache": _A_in["k_cache"],
        "A_v_cache": _A_in["v_cache"],
        "A_wq": _A_in["wq"],
        "A_wo": _A_in["wo"],
        "B_x": _B_in["x"],
        "B_k_cache": _B_in["k_cache"],
        "B_v_cache": _B_in["v_cache"],
        "B_wq": _B_in["wq"],
        "B_wo": _B_in["wo"],
    }

def reference(A_x, A_k_cache, A_v_cache, A_wq, A_wo, B_x, B_k_cache, B_v_cache, B_wq, B_wo):
    def _A_ref(x, k_cache, v_cache, wq, wo):
        B, Sq, D = x.shape
        Hq, Dh = 16, 256
        Hkv = k_cache.shape[1]
        rep = Hq // Hkv
        q = (lambda x, *d: x.permute(*d))((x @ wq).reshape(B, Sq, Hq, Dh), 0, 2, 1, 3)
        k = (lambda x, n, axis: torch.repeat_interleave(x, n, dim=axis))(k_cache, rep, axis=1)
        v = (lambda x, n, axis: torch.repeat_interleave(x, n, dim=axis))(v_cache, rep, axis=1)
        scores = torch.einsum("bhqd,bhkd->bhqk", q, k) * (Dh ** -0.5)
        p = _softmax(scores, axis=-1)
        o = torch.einsum("bhqk,bhkd->bhqd", p, v)
        return (lambda x, *d: x.permute(*d))(o, 0, 2, 1, 3).reshape(B, Sq, Hq * Dh) @ wo

    def _B_ref(x, k_cache, v_cache, wq, wo):
        B, Sq, D = x.shape
        Hq, Dh = 16, 256
        Hkv = k_cache.shape[1]
        rep = Hq // Hkv
        q = (lambda x, *d: x.permute(*d))((x @ wq).reshape(B, Sq, Hq, Dh), 0, 2, 1, 3)
        k = (lambda x, n, axis: torch.repeat_interleave(x, n, dim=axis))(k_cache, rep, axis=1)
        v = (lambda x, n, axis: torch.repeat_interleave(x, n, dim=axis))(v_cache, rep, axis=1)
        scores = torch.einsum("bhqd,bhkd->bhqk", q, k) * (Dh ** -0.5)
        p = _softmax(scores, axis=-1)
        o = torch.einsum("bhqk,bhkd->bhqd", p, v)
        return (lambda x, *d: x.permute(*d))(o, 0, 2, 1, 3).reshape(B, Sq, Hq * Dh) @ wo

    a = _A_ref(A_x, A_k_cache, A_v_cache, A_wq, A_wo)
    b = _B_ref(B_x, B_k_cache, B_v_cache, B_wq, B_wo)
    return torch.concatenate([a, b], axis=-1)
```

```asm
; @launch grid=(256,1,1) block=(512,1,1) lds=163840
.amdgcn_target "amdgcn-amd-amdhsa--gfx950"
.text
.globl concat_heads__gqa_block_cached__gqa_block_cached__near_ridge_kernel
.p2align 8
.type concat_heads__gqa_block_cached__gqa_block_cached__near_ridge_kernel,@function
concat_heads__gqa_block_cached__gqa_block_cached__near_ridge_kernel:
    s_cmp_ge_u32 s2, 256
    s_cbranch_scc1 L_done
    s_bfe_u32 s6, s2, 0x10002
    s_and_b32 s3, s2, 3
    s_lshl_b32 s3, s3, 1
    s_bfe_u32 s4, s2, 0x10004
    s_add_u32 s3, s3, s4
    s_bfe_u32 s46, s2, 0x10003
    s_lshr_b32 s7, s2, 5
    s_lshl_b32 s5, s6, 3
    s_add_u32 s5, s5, s7
    s_mul_i32 s42, s6, 40
    s_add_u32 s50, s0, s42
    s_addc_u32 s51, s1, 0
    s_load_dwordx2 s[8:9], s[50:51], 0
    s_load_dwordx2 s[12:13], s[50:51], 24
    s_load_dwordx2 s[16:17], s[50:51], 8
    s_load_dwordx2 s[20:21], s[50:51], 16
    s_load_dwordx2 s[24:25], s[50:51], 32
    s_load_dwordx2 s[28:29], s[0:1], 96
    s_load_dwordx4 s[56:59], s[0:1], 88
    v_lshrrev_b32 v1, 6, v0
    v_and_b32 v0, 63, v0
    v_readfirstlane_b32 s32, v1
    s_lshl_b32 s4, s3, 1
    s_add_u32 s4, s4, s46
    s_bfe_u32 s42, s2, 0x20003
    s_lshl_b32 s42, s42, 1
    s_add_u32 s34, s7, s42
    s_cmp_ge_u32 s34, 7
    s_cselect_b32 s42, 7, 0
    s_sub_u32 s34, s34, s42
    s_and_b32 s33, s32, 3
    s_cmp_eq_u32 s7, 7
    s_cselect_b32 s6, 0, s7
    s_mul_i32 s35, s33, 4224
    s_mov_b32 s40, 0x3db8aa3b
    s_mov_b32 s41, 0x41000000
    v_lshrrev_b32 v1, 3, v0
    v_mul_u32_u24 v1, 896, v1
    v_lshrrev_b32 v6, 4, v0
    v_lshlrev_b32 v6, 1, v6
    v_and_b32 v7, 7, v0
    v_xor_b32 v6, v6, v7
    v_lshl_add_u32 v1, v6, 4, v1
    v_lshrrev_b32 v6, 5, v0
    v_lshlrev_b32 v2, 15, v6
    v_and_b32 v6, 31, v0
    v_lshl_add_u32 v2, v6, 4, v2
    s_lshl_b32 s47, s34, 19
    s_lshl_b32 s45, s32, 16
    s_lshl_b32 s49, s34, 7
    s_mul_i32 s43, s32, 14336
    s_lshl_b32 s52, s32, 11
    s_lshr_b32 s44, s32, 2
    s_mul_i32 s44, s44, 16896
    s_add_u32 s53, s44, s35
    s_waitcnt lgkmcnt(0)
    s_mul_i32 s42, s7, 100352
    s_add_u32 s8, s8, s42
    s_addc_u32 s9, s9, 0
    s_mov_b32 s10, 100352
    s_mov_b32 s11, 0x20000
    s_lshl_b32 s42, s4, 9
    s_add_u32 s12, s12, s42
    s_addc_u32 s13, s13, 0
    s_sub_u32 s14, 3670016, s42
    s_mov_b32 s15, 0x20000
    s_cmp_lg_u32 s32, 0
    s_cbranch_scc1 L_noclr
    s_lshl_b32 s42, s5, 5
    s_add_u32 s42, s42, s4
    s_lshl_b32 s42, s42, 2
    s_add_u32 s42, s42, 31457280
    v_mov_b32 v12, s42
    v_mov_b32 v13, 0
    s_mov_b64 exec, 1
    global_store_dword v12, v13, s[58:59] sc1
    s_mov_b64 exec, -1
L_noclr:
    s_add_u32 m0, s52, 101376
    s_add_u32 s44, s49, s43
    buffer_load_dwordx4 v1, s[8:11], s44 offen lds
    s_add_u32 m0, s52, 102400
    s_add_u32 s44, s44, 7168
    buffer_load_dwordx4 v1, s[8:11], s44 offen lds
    s_add_u32 m0, s53, 118272
    s_add_u32 s44, s47, s45
    buffer_load_dwordx4 v2, s[12:15], s44 offen lds
    s_add_u32 m0, s53, 119328
    s_add_u32 s44, s44, 8192
    buffer_load_dwordx4 v2, s[12:15], s44 offen lds
    s_add_u32 m0, s53, 120384
    s_add_u32 s44, s44, 8192
    buffer_load_dwordx4 v2, s[12:15], s44 offen lds
    s_add_u32 m0, s53, 121440
    s_add_u32 s44, s44, 8192
    buffer_load_dwordx4 v2, s[12:15], s44 offen lds
    s_add_u32 s47, s47, 524288
    s_add_u32 s49, s49, 128
    s_cmp_eq_u32 s49, 896
    s_cselect_b32 s47, 0, s47
    s_cselect_b32 s49, 0, s49
    s_add_u32 m0, s52, 50688
    s_add_u32 s44, s49, s43
    buffer_load_dwordx4 v1, s[8:11], s44 offen lds
    s_add_u32 m0, s52, 51712
    s_add_u32 s44, s44, 7168
    buffer_load_dwordx4 v1, s[8:11], s44 offen lds
    s_add_u32 m0, s53, 67584
    s_add_u32 s44, s47, s45
    buffer_load_dwordx4 v2, s[12:15], s44 offen lds
    s_add_u32 m0, s53, 68640
    s_add_u32 s44, s44, 8192
    buffer_load_dwordx4 v2, s[12:15], s44 offen lds
    s_add_u32 m0, s53, 69696
    s_add_u32 s44, s44, 8192
    buffer_load_dwordx4 v2, s[12:15], s44 offen lds
    s_add_u32 m0, s53, 70752
    s_add_u32 s44, s44, 8192
    buffer_load_dwordx4 v2, s[12:15], s44 offen lds
    s_add_u32 s47, s47, 524288
    s_add_u32 s49, s49, 128
    s_cmp_eq_u32 s49, 896
    s_cselect_b32 s47, 0, s47
    s_cselect_b32 s49, 0, s49
    s_lshl_b32 s42, s7, 3
    s_add_u32 s42, s42, s3
    s_lshl_b32 s42, s42, 20
    s_add_u32 s16, s16, s42
    s_addc_u32 s17, s17, 0
    s_mov_b32 s18, 1048576
    s_mov_b32 s19, 0x20000
    s_add_u32 s20, s20, s42
    s_addc_u32 s21, s21, 0
    s_mov_b32 s22, 1048576
    s_mov_b32 s23, 0x20000
    s_mul_i32 s42, s4, 229376
    s_add_u32 s24, s24, s42
    s_addc_u32 s25, s25, 0
    s_mov_b32 s26, 229376
    s_mov_b32 s27, 0x20000
    s_lshl_b32 s42, s5, 4
    s_add_u32 s42, s42, s4
    s_mul_i32 s42, s42, 114688
    s_add_u32 s28, s28, s42
    s_addc_u32 s29, s29, 0
    s_mov_b32 s30, 114688
    s_mov_b32 s31, 0x20000
    v_and_b32 v6, 15, v0
    v_lshlrev_b32 v3, 7, v6
    v_and_b32 v6, 6, v0
    v_lshrrev_b32 v7, 4, v0
    v_xor_b32 v6, v6, v7
    v_lshl_add_u32 v3, v6, 4, v3
    v_xor_b32 v4, 64, v3
    v_lshrrev_b32 v5, 2, v0
    v_mul_u32_u24 v5, 1056, v5
    v_and_b32 v6, 3, v0
    v_lshl_add_u32 v5, v6, 4, v5
    s_lshl_b32 s42, s32, 6
    v_add_u32 v5, s42, v5
    v_and_b32 v8, 31, v0
    v_lshlrev_b32 v8, 4, v8
    v_lshrrev_b32 v6, 5, v0
    v_lshl_add_u32 v8, v6, 13, v8
    s_lshl_b32 s36, s33, 11
    s_add_u32 s37, s36, 16384
    s_add_u32 s36, s36, 32768
    v_lshlrev_b32 v6, 2, v0
    v_add_u32 v6, 160256, v6
    v_mov_b32 v7, 0
    ds_write_b32 v6, v7
    s_cmp_ge_u32 s32, 4
    s_cbranch_scc1 L_owave
    s_waitcnt vmcnt(6)
    s_waitcnt lgkmcnt(0)
    s_barrier
    v_add_u32 v3, 101376, v3
    v_add_u32 v4, 101376, v4
    v_add_u32 v5, 118272, v5
    ds_read_b64_tr_b16 v[16:17], v5 offset:0
    ds_read_b64_tr_b16 v[18:19], v5 offset:512
    ds_read_b64_tr_b16 v[20:21], v5 offset:8
    ds_read_b64_tr_b16 v[22:23], v5 offset:520
    ds_read_b128 v[32:35], v3 offset:0
    ds_read_b128 v[36:39], v3 offset:2048
    ds_read_b128 v[40:43], v3 offset:4096
    ds_read_b128 v[44:47], v3 offset:6144
    ds_read_b128 v[48:51], v3 offset:8192
    s_waitcnt lgkmcnt(4)
    v_mfma_f32_16x16x32_bf16 v[96:99], v[16:19], v[32:35], 0
    v_mfma_f32_16x16x32_bf16 v[100:103], v[20:23], v[32:35], 0
    ds_read_b64_tr_b16 v[24:25], v5 offset:16896
    ds_read_b64_tr_b16 v[26:27], v5 offset:17408
    ds_read_b64_tr_b16 v[28:29], v5 offset:16904
    ds_read_b64_tr_b16 v[30:31], v5 offset:17416
    ds_read_b128 v[52:55], v3 offset:10240
    s_waitcnt lgkmcnt(8)
    v_mfma_f32_16x16x32_bf16 v[104:107], v[16:19], v[36:39], 0
    v_mfma_f32_16x16x32_bf16 v[108:111], v[20:23], v[36:39], 0
    ds_read_b128 v[56:59], v3 offset:12288
    s_waitcnt lgkmcnt(8)
    v_mfma_f32_16x16x32_bf16 v[112:115], v[16:19], v[40:43], 0
    v_mfma_f32_16x16x32_bf16 v[116:119], v[20:23], v[40:43], 0
    ds_read_b128 v[60:63], v4 offset:0
    s_waitcnt lgkmcnt(8)
    v_mfma_f32_16x16x32_bf16 v[120:123], v[16:19], v[44:47], 0
    v_mfma_f32_16x16x32_bf16 v[124:127], v[20:23], v[44:47], 0
    ds_read_b128 v[64:67], v4 offset:2048
    s_waitcnt lgkmcnt(8)
    v_mfma_f32_16x16x32_bf16 v[128:131], v[16:19], v[48:51], 0
    v_mfma_f32_16x16x32_bf16 v[132:135], v[20:23], v[48:51], 0
    ds_read_b128 v[68:71], v4 offset:4096
    s_waitcnt lgkmcnt(4)
    v_mfma_f32_16x16x32_bf16 v[136:139], v[16:19], v[52:55], 0
    v_mfma_f32_16x16x32_bf16 v[140:143], v[20:23], v[52:55], 0
    ds_read_b128 v[72:75], v4 offset:6144
    s_waitcnt lgkmcnt(4)
    v_mfma_f32_16x16x32_bf16 v[144:147], v[16:19], v[56:59], 0
    v_mfma_f32_16x16x32_bf16 v[148:151], v[20:23], v[56:59], 0
    ds_read_b128 v[76:79], v4 offset:8192
    s_waitcnt lgkmcnt(4)
    v_mfma_f32_16x16x32_bf16 v[96:99], v[24:27], v[60:63], v[96:99]
    v_mfma_f32_16x16x32_bf16 v[100:103], v[28:31], v[60:63], v[100:103]
    ds_read_b128 v[80:83], v4 offset:10240
    s_waitcnt lgkmcnt(4)
    v_mfma_f32_16x16x32_bf16 v[104:107], v[24:27], v[64:67], v[104:107]
    v_mfma_f32_16x16x32_bf16 v[108:111], v[28:31], v[64:67], v[108:111]
    ds_read_b128 v[84:87], v4 offset:12288
    s_waitcnt lgkmcnt(4)
    v_mfma_f32_16x16x32_bf16 v[112:115], v[24:27], v[68:71], v[112:115]
    v_mfma_f32_16x16x32_bf16 v[116:119], v[28:31], v[68:71], v[116:119]
    s_waitcnt lgkmcnt(3)
    v_mfma_f32_16x16x32_bf16 v[120:123], v[24:27], v[72:75], v[120:123]
    v_mfma_f32_16x16x32_bf16 v[124:127], v[28:31], v[72:75], v[124:127]
    s_waitcnt lgkmcnt(2)
    v_mfma_f32_16x16x32_bf16 v[128:131], v[24:27], v[76:79], v[128:131]
    v_mfma_f32_16x16x32_bf16 v[132:135], v[28:31], v[76:79], v[132:135]
    s_waitcnt lgkmcnt(1)
    v_mfma_f32_16x16x32_bf16 v[136:139], v[24:27], v[80:83], v[136:139]
    v_mfma_f32_16x16x32_bf16 v[140:143], v[28:31], v[80:83], v[140:143]
    s_waitcnt lgkmcnt(0)
    v_mfma_f32_16x16x32_bf16 v[144:147], v[24:27], v[84:87], v[144:147]
    v_mfma_f32_16x16x32_bf16 v[148:151], v[28:31], v[84:87], v[148:151]
    s_waitcnt vmcnt(0)
    s_barrier
    v_add_u32 v3, 4294916608, v3
    v_add_u32 v4, 4294916608, v4
    v_add_u32 v5, 4294916608, v5
    ds_read_b64_tr_b16 v[16:17], v5 offset:0
    ds_read_b64_tr_b16 v[18:19], v5 offset:512
    ds_read_b64_tr_b16 v[20:21], v5 offset:8
    ds_read_b64_tr_b16 v[22:23], v5 offset:520
    ds_read_b128 v[32:35], v3 offset:0
    ds_read_b128 v[36:39], v3 offset:2048
    ds_read_b128 v[40:43], v3 offset:4096
    ds_read_b128 v[44:47], v3 offset:6144
    ds_read_b128 v[48:51], v3 offset:8192
    s_waitcnt lgkmcnt(4)
    v_mfma_f32_16x16x32_bf16 v[96:99], v[16:19], v[32:35], v[96:99]
    v_mfma_f32_16x16x32_bf16 v[100:103], v[20:23], v[32:35], v[100:103]
    ds_read_b64_tr_b16 v[24:25], v5 offset:16896
    ds_read_b64_tr_b16 v[26:27], v5 offset:17408
    ds_read_b64_tr_b16 v[28:29], v5 offset:16904
    ds_read_b64_tr_b16 v[30:31], v5 offset:17416
    ds_read_b128 v[52:55], v3 offset:10240
    s_waitcnt lgkmcnt(8)
    v_mfma_f32_16x16x32_bf16 v[104:107], v[16:19], v[36:39], v[104:107]
    v_mfma_f32_16x16x32_bf16 v[108:111], v[20:23], v[36:39], v[108:111]
    ds_read_b128 v[56:59], v3 offset:12288
    s_waitcnt lgkmcnt(8)
    v_mfma_f32_16x16x32_bf16 v[112:115], v[16:19], v[40:43], v[112:115]
    v_mfma_f32_16x16x32_bf16 v[116:119], v[20:23], v[40:43], v[116:119]
    ds_read_b128 v[60:63], v4 offset:0
    s_waitcnt lgkmcnt(8)
    v_mfma_f32_16x16x32_bf16 v[120:123], v[16:19], v[44:47], v[120:123]
    v_mfma_f32_16x16x32_bf16 v[124:127], v[20:23], v[44:47], v[124:127]
    ds_read_b128 v[64:67], v4 offset:2048
    s_waitcnt lgkmcnt(8)
    v_mfma_f32_16x16x32_bf16 v[128:131], v[16:19], v[48:51], v[128:131]
    v_mfma_f32_16x16x32_bf16 v[132:135], v[20:23], v[48:51], v[132:135]
    ds_read_b128 v[68:71], v4 offset:4096
    s_waitcnt lgkmcnt(4)
    v_mfma_f32_16x16x32_bf16 v[136:139], v[16:19], v[52:55], v[136:139]
    v_mfma_f32_16x16x32_bf16 v[140:143], v[20:23], v[52:55], v[140:143]
    ds_read_b128 v[72:75], v4 offset:6144
    s_waitcnt lgkmcnt(4)
    v_mfma_f32_16x16x32_bf16 v[144:147], v[16:19], v[56:59], v[144:147]
    v_mfma_f32_16x16x32_bf16 v[148:151], v[20:23], v[56:59], v[148:151]
    ds_read_b128 v[76:79], v4 offset:8192
    s_waitcnt lgkmcnt(4)
    v_mfma_f32_16x16x32_bf16 v[96:99], v[24:27], v[60:63], v[96:99]
    v_mfma_f32_16x16x32_bf16 v[100:103], v[28:31], v[60:63], v[100:103]
    ds_read_b128 v[80:83], v4 offset:10240
    s_waitcnt lgkmcnt(4)
    v_mfma_f32_16x16x32_bf16 v[104:107], v[24:27], v[64:67], v[104:107]
    v_mfma_f32_16x16x32_bf16 v[108:111], v[28:31], v[64:67], v[108:111]
    ds_read_b128 v[84:87], v4 offset:12288
    s_waitcnt lgkmcnt(4)
    v_mfma_f32_16x16x32_bf16 v[112:115], v[24:27], v[68:71], v[112:115]
    v_mfma_f32_16x16x32_bf16 v[116:119], v[28:31], v[68:71], v[116:119]
    s_waitcnt lgkmcnt(3)
    v_mfma_f32_16x16x32_bf16 v[120:123], v[24:27], v[72:75], v[120:123]
    v_mfma_f32_16x16x32_bf16 v[124:127], v[28:31], v[72:75], v[124:127]
    s_waitcnt lgkmcnt(2)
    v_mfma_f32_16x16x32_bf16 v[128:131], v[24:27], v[76:79], v[128:131]
    v_mfma_f32_16x16x32_bf16 v[132:135], v[28:31], v[76:79], v[132:135]
    s_waitcnt lgkmcnt(1)
    v_mfma_f32_16x16x32_bf16 v[136:139], v[24:27], v[80:83], v[136:139]
    v_mfma_f32_16x16x32_bf16 v[140:143], v[28:31], v[80:83], v[140:143]
    s_waitcnt lgkmcnt(0)
    v_mfma_f32_16x16x32_bf16 v[144:147], v[24:27], v[84:87], v[144:147]
    v_mfma_f32_16x16x32_bf16 v[148:151], v[28:31], v[84:87], v[148:151]
    s_barrier
    v_add_u32 v3, 4294916608, v3
    v_add_u32 v4, 4294916608, v4
    v_add_u32 v5, 4294916608, v5
    ds_read_b64_tr_b16 v[16:17], v5 offset:0
    ds_read_b64_tr_b16 v[18:19], v5 offset:512
    ds_read_b64_tr_b16 v[20:21], v5 offset:8
    ds_read_b64_tr_b16 v[22:23], v5 offset:520
    ds_read_b128 v[32:35], v3 offset:0
    ds_read_b128 v[36:39], v3 offset:2048
    ds_read_b128 v[40:43], v3 offset:4096
    ds_read_b128 v[44:47], v3 offset:6144
    ds_read_b128 v[48:51], v3 offset:8192
    s_waitcnt lgkmcnt(4)
    v_mfma_f32_16x16x32_bf16 v[96:99], v[16:19], v[32:35], v[96:99]
    v_mfma_f32_16x16x32_bf16 v[100:103], v[20:23], v[32:35], v[100:103]
    ds_read_b64_tr_b16 v[24:25], v5 offset:16896
    ds_read_b64_tr_b16 v[26:27], v5 offset:17408
    ds_read_b64_tr_b16 v[28:29], v5 offset:16904
    ds_read_b64_tr_b16 v[30:31], v5 offset:17416
    ds_read_b128 v[52:55], v3 offset:10240
    s_waitcnt lgkmcnt(8)
    v_mfma_f32_16x16x32_bf16 v[104:107], v[16:19], v[36:39], v[104:107]
    v_mfma_f32_16x16x32_bf16 v[108:111], v[20:23], v[36:39], v[108:111]
    ds_read_b128 v[56:59], v3 offset:12288
    s_waitcnt lgkmcnt(8)
    v_mfma_f32_16x16x32_bf16 v[112:115], v[16:19], v[40:43], v[112:115]
    v_mfma_f32_16x16x32_bf16 v[116:119], v[20:23], v[40:43], v[116:119]
    ds_read_b128 v[60:63], v4 offset:0
    s_waitcnt lgkmcnt(8)
    v_mfma_f32_16x16x32_bf16 v[120:123], v[16:19], v[44:47], v[120:123]
    v_mfma_f32_16x16x32_bf16 v[124:127], v[20:23], v[44:47], v[124:127]
    ds_read_b128 v[64:67], v4 offset:2048
    s_waitcnt lgkmcnt(8)
    v_mfma_f32_16x16x32_bf16 v[128:131], v[16:19], v[48:51], v[128:131]
    v_mfma_f32_16x16x32_bf16 v[132:135], v[20:23], v[48:51], v[132:135]
    ds_read_b128 v[68:71], v4 offset:4096
    s_waitcnt lgkmcnt(4)
    v_mfma_f32_16x16x32_bf16 v[136:139], v[16:19], v[52:55], v[136:139]
    v_mfma_f32_16x16x32_bf16 v[140:143], v[20:23], v[52:55], v[140:143]
    ds_read_b128 v[72:75], v4 offset:6144
    s_waitcnt lgkmcnt(4)
    v_mfma_f32_16x16x32_bf16 v[144:147], v[16:19], v[56:59], v[144:147]
    v_mfma_f32_16x16x32_bf16 v[148:151], v[20:23], v[56:59], v[148:151]
    ds_read_b128 v[76:79], v4 offset:8192
    s_waitcnt lgkmcnt(4)
    v_mfma_f32_16x16x32_bf16 v[96:99], v[24:27], v[60:63], v[96:99]
    v_mfma_f32_16x16x32_bf16 v[100:103], v[28:31], v[60:63], v[100:103]
    ds_read_b128 v[80:83], v4 offset:10240
    s_waitcnt lgkmcnt(4)
    v_mfma_f32_16x16x32_bf16 v[104:107], v[24:27], v[64:67], v[104:107]
    v_mfma_f32_16x16x32_bf16 v[108:111], v[28:31], v[64:67], v[108:111]
    ds_read_b128 v[84:87], v4 offset:12288
    s_waitcnt lgkmcnt(4)
    v_mfma_f32_16x16x32_bf16 v[112:115], v[24:27], v[68:71], v[112:115]
    v_mfma_f32_16x16x32_bf16 v[116:119], v[28:31], v[68:71], v[116:119]
    s_waitcnt lgkmcnt(3)
    v_mfma_f32_16x16x32_bf16 v[120:123], v[24:27], v[72:75], v[120:123]
    v_mfma_f32_16x16x32_bf16 v[124:127], v[28:31], v[72:75], v[124:127]
    s_waitcnt lgkmcnt(2)
    v_mfma_f32_16x16x32_bf16 v[128:131], v[24:27], v[76:79], v[128:131]
    v_mfma_f32_16x16x32_bf16 v[132:135], v[28:31], v[76:79], v[132:135]
    s_waitcnt lgkmcnt(1)
    v_mfma_f32_16x16x32_bf16 v[136:139], v[24:27], v[80:83], v[136:139]
    v_mfma_f32_16x16x32_bf16 v[140:143], v[28:31], v[80:83], v[140:143]
    s_waitcnt lgkmcnt(0)
    v_mfma_f32_16x16x32_bf16 v[144:147], v[24:27], v[84:87], v[144:147]
    v_mfma_f32_16x16x32_bf16 v[148:151], v[28:31], v[84:87], v[148:151]
    s_barrier
    v_add_u32 v3, 101376, v3
    v_add_u32 v4, 101376, v4
    v_add_u32 v5, 101376, v5
    ds_read_b64_tr_b16 v[16:17], v5 offset:0
    ds_read_b64_tr_b16 v[18:19], v5 offset:512
    ds_read_b64_tr_b16 v[20:21], v5 offset:8
    ds_read_b64_tr_b16 v[22:23], v5 offset:520
    ds_read_b128 v[32:35], v3 offset:0
    ds_read_b128 v[36:39], v3 offset:2048
    ds_read_b128 v[40:43], v3 offset:4096
    ds_read_b128 v[44:47], v3 offset:6144
    ds_read_b128 v[48:51], v3 offset:8192
    s_waitcnt lgkmcnt(4)
    v_mfma_f32_16x16x32_bf16 v[96:99], v[16:19], v[32:35], v[96:99]
    v_mfma_f32_16x16x32_bf16 v[100:103], v[20:23], v[32:35], v[100:103]
    ds_read_b64_tr_b16 v[24:25], v5 offset:16896
    ds_read_b64_tr_b16 v[26:27], v5 offset:17408
    ds_read_b64_tr_b16 v[28:29], v5 offset:16904
    ds_read_b64_tr_b16 v[30:31], v5 offset:17416
    ds_read_b128 v[52:55], v3 offset:10240
    s_waitcnt lgkmcnt(8)
    v_mfma_f32_16x16x32_bf16 v[104:107], v[16:19], v[36:39], v[104:107]
    v_mfma_f32_16x16x32_bf16 v[108:111], v[20:23], v[36:39], v[108:111]
    ds_read_b128 v[56:59], v3 offset:12288
    s_waitcnt lgkmcnt(8)
    v_mfma_f32_16x16x32_bf16 v[112:115], v[16:19], v[40:43], v[112:115]
    v_mfma_f32_16x16x32_bf16 v[116:119], v[20:23], v[40:43], v[116:119]
    ds_read_b128 v[60:63], v4 offset:0
    s_waitcnt lgkmcnt(8)
    v_mfma_f32_16x16x32_bf16 v[120:123], v[16:19], v[44:47], v[120:123]
    v_mfma_f32_16x16x32_bf16 v[124:127], v[20:23], v[44:47], v[124:127]
    ds_read_b128 v[64:67], v4 offset:2048
    s_waitcnt lgkmcnt(8)
    v_mfma_f32_16x16x32_bf16 v[128:131], v[16:19], v[48:51], v[128:131]
    v_mfma_f32_16x16x32_bf16 v[132:135], v[20:23], v[48:51], v[132:135]
    ds_read_b128 v[68:71], v4 offset:4096
    s_waitcnt lgkmcnt(4)
    v_mfma_f32_16x16x32_bf16 v[136:139], v[16:19], v[52:55], v[136:139]
    v_mfma_f32_16x16x32_bf16 v[140:143], v[20:23], v[52:55], v[140:143]
    ds_read_b128 v[72:75], v4 offset:6144
    s_waitcnt lgkmcnt(4)
    v_mfma_f32_16x16x32_bf16 v[144:147], v[16:19], v[56:59], v[144:147]
    v_mfma_f32_16x16x32_bf16 v[148:151], v[20:23], v[56:59], v[148:151]
    ds_read_b128 v[76:79], v4 offset:8192
    s_waitcnt lgkmcnt(4)
    v_mfma_f32_16x16x32_bf16 v[96:99], v[24:27], v[60:63], v[96:99]
    v_mfma_f32_16x16x32_bf16 v[100:103], v[28:31], v[60:63], v[100:103]
    ds_read_b128 v[80:83], v4 offset:10240
    s_waitcnt lgkmcnt(4)
    v_mfma_f32_16x16x32_bf16 v[104:107], v[24:27], v[64:67], v[104:107]
    v_mfma_f32_16x16x32_bf16 v[108:111], v[28:31], v[64:67], v[108:111]
    ds_read_b128 v[84:87], v4 offset:12288
    s_waitcnt lgkmcnt(4)
    v_mfma_f32_16x16x32_bf16 v[112:115], v[24:27], v[68:71], v[112:115]
    v_mfma_f32_16x16x32_bf16 v[116:119], v[28:31], v[68:71], v[116:119]
    s_waitcnt lgkmcnt(3)
    v_mfma_f32_16x16x32_bf16 v[120:123], v[24:27], v[72:75], v[120:123]
    v_mfma_f32_16x16x32_bf16 v[124:127], v[28:31], v[72:75], v[124:127]
    s_waitcnt lgkmcnt(2)
    v_mfma_f32_16x16x32_bf16 v[128:131], v[24:27], v[76:79], v[128:131]
    v_mfma_f32_16x16x32_bf16 v[132:135], v[28:31], v[76:79], v[132:135]
    s_waitcnt lgkmcnt(1)
    v_mfma_f32_16x16x32_bf16 v[136:139], v[24:27], v[80:83], v[136:139]
    v_mfma_f32_16x16x32_bf16 v[140:143], v[28:31], v[80:83], v[140:143]
    s_waitcnt lgkmcnt(0)
    v_mfma_f32_16x16x32_bf16 v[144:147], v[24:27], v[84:87], v[144:147]
    v_mfma_f32_16x16x32_bf16 v[148:151], v[28:31], v[84:87], v[148:151]
    s_barrier
    v_add_u32 v3, 4294916608, v3
    v_add_u32 v4, 4294916608, v4
    v_add_u32 v5, 4294916608, v5
    ds_read_b64_tr_b16 v[16:17], v5 offset:0
    ds_read_b64_tr_b16 v[18:19], v5 offset:512
    ds_read_b64_tr_b16 v[20:21], v5 offset:8
    ds_read_b64_tr_b16 v[22:23], v5 offset:520
    ds_read_b128 v[32:35], v3 offset:0
    ds_read_b128 v[36:39], v3 offset:2048
    ds_read_b128 v[40:43], v3 offset:4096
    ds_read_b128 v[44:47], v3 offset:6144
    ds_read_b128 v[48:51], v3 offset:8192
    s_waitcnt lgkmcnt(4)
    v_mfma_f32_16x16x32_bf16 v[96:99], v[16:19], v[32:35], v[96:99]
    v_mfma_f32_16x16x32_bf16 v[100:103], v[20:23], v[32:35], v[100:103]
    ds_read_b64_tr_b16 v[24:25], v5 offset:16896
    ds_read_b64_tr_b16 v[26:27], v5 offset:17408
    ds_read_b64_tr_b16 v[28:29], v5 offset:16904
    ds_read_b64_tr_b16 v[30:31], v5 offset:17416
    ds_read_b128 v[52:55], v3 offset:10240
    s_waitcnt lgkmcnt(8)
    v_mfma_f32_16x16x32_bf16 v[104:107], v[16:19], v[36:39], v[104:107]
    v_mfma_f32_16x16x32_bf16 v[108:111], v[20:23], v[36:39], v[108:111]
    ds_read_b128 v[56:59], v3 offset:12288
    s_waitcnt lgkmcnt(8)
    v_mfma_f32_16x16x32_bf16 v[112:115], v[16:19], v[40:43], v[112:115]
    v_mfma_f32_16x16x32_bf16 v[116:119], v[20:23], v[40:43], v[116:119]
    ds_read_b128 v[60:63], v4 offset:0
    s_waitcnt lgkmcnt(8)
    v_mfma_f32_16x16x32_bf16 v[120:123], v[16:19], v[44:47], v[120:123]
    v_mfma_f32_16x16x32_bf16 v[124:127], v[20:23], v[44:47], v[124:127]
    ds_read_b128 v[64:67], v4 offset:2048
    s_waitcnt lgkmcnt(8)
    v_mfma_f32_16x16x32_bf16 v[128:131], v[16:19], v[48:51], v[128:131]
    v_mfma_f32_16x16x32_bf16 v[132:135], v[20:23], v[48:51], v[132:135]
    ds_read_b128 v[68:71], v4 offset:4096
    s_waitcnt lgkmcnt(4)
    v_mfma_f32_16x16x32_bf16 v[136:139], v[16:19], v[52:55], v[136:139]
    v_mfma_f32_16x16x32_bf16 v[140:143], v[20:23], v[52:55], v[140:143]
    ds_read_b128 v[72:75], v4 offset:6144
    s_waitcnt lgkmcnt(4)
    v_mfma_f32_16x16x32_bf16 v[144:147], v[16:19], v[56:59], v[144:147]
    v_mfma_f32_16x16x32_bf16 v[148:151], v[20:23], v[56:59], v[148:151]
    ds_read_b128 v[76:79], v4 offset:8192
    s_waitcnt lgkmcnt(4)
    v_mfma_f32_16x16x32_bf16 v[96:99], v[24:27], v[60:63], v[96:99]
    v_mfma_f32_16x16x32_bf16 v[100:103], v[28:31], v[60:63], v[100:103]
    ds_read_b128 v[80:83], v4 offset:10240
    s_waitcnt lgkmcnt(4)
    v_mfma_f32_16x16x32_bf16 v[104:107], v[24:27], v[64:67], v[104:107]
    v_mfma_f32_16x16x32_bf16 v[108:111], v[28:31], v[64:67], v[108:111]
    ds_read_b128 v[84:87], v4 offset:12288
    s_waitcnt lgkmcnt(4)
    v_mfma_f32_16x16x32_bf16 v[112:115], v[24:27], v[68:71], v[112:115]
    v_mfma_f32_16x16x32_bf16 v[116:119], v[28:31], v[68:71], v[116:119]
    s_waitcnt lgkmcnt(3)
    v_mfma_f32_16x16x32_bf16 v[120:123], v[24:27], v[72:75], v[120:123]
    v_mfma_f32_16x16x32_bf16 v[124:127], v[28:31], v[72:75], v[124:127]
    s_waitcnt lgkmcnt(2)
    v_mfma_f32_16x16x32_bf16 v[128:131], v[24:27], v[76:79], v[128:131]
    v_mfma_f32_16x16x32_bf16 v[132:135], v[28:31], v[76:79], v[132:135]
    s_waitcnt lgkmcnt(1)
    v_mfma_f32_16x16x32_bf16 v[136:139], v[24:27], v[80:83], v[136:139]
    v_mfma_f32_16x16x32_bf16 v[140:143], v[28:31], v[80:83], v[140:143]
    s_waitcnt lgkmcnt(0)
    v_mfma_f32_16x16x32_bf16 v[144:147], v[24:27], v[84:87], v[144:147]
    v_mfma_f32_16x16x32_bf16 v[148:151], v[28:31], v[84:87], v[148:151]
    s_barrier
    v_add_u32 v3, 4294916608, v3
    v_add_u32 v4, 4294916608, v4
    v_add_u32 v5, 4294916608, v5
    s_lshl_b32 s45, s32, 10
    s_mul_i32 s43, s32, 2112
    ds_read_b64_tr_b16 v[16:17], v5 offset:0
    ds_read_b64_tr_b16 v[18:19], v5 offset:512
    ds_read_b64_tr_b16 v[20:21], v5 offset:8
    ds_read_b64_tr_b16 v[22:23], v5 offset:520
    ds_read_b128 v[32:35], v3 offset:0
    ds_read_b128 v[36:39], v3 offset:2048
    ds_read_b128 v[40:43], v3 offset:4096
    ds_read_b128 v[44:47], v3 offset:6144
    ds_read_b128 v[48:51], v3 offset:8192
    s_waitcnt lgkmcnt(4)
    v_mfma_f32_16x16x32_bf16 v[96:99], v[16:19], v[32:35], v[96:99]
    v_mfma_f32_16x16x32_bf16 v[100:103], v[20:23], v[32:35], v[100:103]
    ds_read_b64_tr_b16 v[24:25], v5 offset:16896
    ds_read_b64_tr_b16 v[26:27], v5 offset:17408
    ds_read_b64_tr_b16 v[28:29], v5 offset:16904
    ds_read_b64_tr_b16 v[30:31], v5 offset:17416
    ds_read_b128 v[52:55], v3 offset:10240
    s_add_u32 m0, s43, 50688
    s_add_u32 s44, s45, 0
    buffer_load_dwordx4 v8, s[16:19], s44 offen offset:0 nt lds
    s_waitcnt lgkmcnt(8)
    v_mfma_f32_16x16x32_bf16 v[104:107], v[16:19], v[36:39], v[104:107]
    v_mfma_f32_16x16x32_bf16 v[108:111], v[20:23], v[36:39], v[108:111]
    ds_read_b128 v[56:59], v3 offset:12288
    s_add_u32 m0, s43, 51232
    s_add_u32 s44, s45, 0
    buffer_load_dwordx4 v8, s[16:19], s44 offen offset:512 nt lds
    s_waitcnt lgkmcnt(8)
    v_mfma_f32_16x16x32_bf16 v[112:115], v[16:19], v[40:43], v[112:115]
    v_mfma_f32_16x16x32_bf16 v[116:119], v[20:23], v[40:43], v[116:119]
    ds_read_b128 v[60:63], v4 offset:0
    s_waitcnt lgkmcnt(8)
    v_mfma_f32_16x16x32_bf16 v[120:123], v[16:19], v[44:47], v[120:123]
    v_mfma_f32_16x16x32_bf16 v[124:127], v[20:23], v[44:47], v[124:127]
    ds_read_b128 v[64:67], v4 offset:2048
    s_add_u32 m0, s43, 67584
    s_add_u32 s44, s45, 16384
    buffer_load_dwordx4 v8, s[16:19], s44 offen offset:0 nt lds
    s_waitcnt lgkmcnt(8)
    v_mfma_f32_16x16x32_bf16 v[128:131], v[16:19], v[48:51], v[128:131]
    v_mfma_f32_16x16x32_bf16 v[132:135], v[20:23], v[48:51], v[132:135]
    ds_read_b128 v[68:71], v4 offset:4096
    s_waitcnt lgkmcnt(4)
    v_mfma_f32_16x16x32_bf16 v[136:139], v[16:19], v[52:55], v[136:139]
    v_mfma_f32_16x16x32_bf16 v[140:143], v[20:23], v[52:55], v[140:143]
    ds_read_b128 v[72:75], v4 offset:6144
    s_add_u32 m0, s43, 68128
    s_add_u32 s44, s45, 16384
    buffer_load_dwordx4 v8, s[16:19], s44 offen offset:512 nt lds
    s_waitcnt lgkmcnt(4)
    v_mfma_f32_16x16x32_bf16 v[144:147], v[16:19], v[56:59], v[144:147]
    v_mfma_f32_16x16x32_bf16 v[148:151], v[20:23], v[56:59], v[148:151]
    ds_read_b128 v[76:79], v4 offset:8192
    s_add_u32 m0, s43, 84480
    s_add_u32 s44, s45, 0
    buffer_load_dwordx4 v8, s[20:23], s44 offen offset:0 nt lds
    s_waitcnt lgkmcnt(4)
    v_mfma_f32_16x16x32_bf16 v[96:99], v[24:27], v[60:63], v[96:99]
    v_mfma_f32_16x16x32_bf16 v[100:103], v[28:31], v[60:63], v[100:103]
    ds_read_b128 v[80:83], v4 offset:10240
    s_waitcnt lgkmcnt(4)
    v_mfma_f32_16x16x32_bf16 v[104:107], v[24:27], v[64:67], v[104:107]
    v_mfma_f32_16x16x32_bf16 v[108:111], v[28:31], v[64:67], v[108:111]
    ds_read_b128 v[84:87], v4 offset:12288
    s_add_u32 m0, s43, 85024
    s_add_u32 s44, s45, 0
    buffer_load_dwordx4 v8, s[20:23], s44 offen offset:512 nt lds
    s_waitcnt lgkmcnt(4)
    v_mfma_f32_16x16x32_bf16 v[112:115], v[24:27], v[68:71], v[112:115]
    v_mfma_f32_16x16x32_bf16 v[116:119], v[28:31], v[68:71], v[116:119]
    s_waitcnt lgkmcnt(3)
    v_mfma_f32_16x16x32_bf16 v[120:123], v[24:27], v[72:75], v[120:123]
    v_mfma_f32_16x16x32_bf16 v[124:127], v[28:31], v[72:75], v[124:127]
    s_waitcnt lgkmcnt(2)
    v_mfma_f32_16x16x32_bf16 v[128:131], v[24:27], v[76:79], v[128:131]
    v_mfma_f32_16x16x32_bf16 v[132:135], v[28:31], v[76:79], v[132:135]
    s_waitcnt lgkmcnt(1)
    v_mfma_f32_16x16x32_bf16 v[136:139], v[24:27], v[80:83], v[136:139]
    v_mfma_f32_16x16x32_bf16 v[140:143], v[28:31], v[80:83], v[140:143]
    s_waitcnt lgkmcnt(0)
    v_mfma_f32_16x16x32_bf16 v[144:147], v[24:27], v[84:87], v[144:147]
    v_mfma_f32_16x16x32_bf16 v[148:151], v[28:31], v[84:87], v[148:151]
    s_barrier
    v_add_u32 v3, 101376, v3
    v_add_u32 v4, 101376, v4
    v_add_u32 v5, 101376, v5
    ds_read_b64_tr_b16 v[16:17], v5 offset:0
    ds_read_b64_tr_b16 v[18:19], v5 offset:512
    ds_read_b64_tr_b16 v[20:21], v5 offset:8
    ds_read_b64_tr_b16 v[22:23], v5 offset:520
    ds_read_b128 v[32:35], v3 offset:0
    ds_read_b128 v[36:39], v3 offset:2048
    ds_read_b128 v[40:43], v3 offset:4096
    ds_read_b128 v[44:47], v3 offset:6144
    ds_read_b128 v[48:51], v3 offset:8192
    s_waitcnt lgkmcnt(4)
    v_mfma_f32_16x16x32_bf16 v[96:99], v[16:19], v[32:35], v[96:99]
    v_mfma_f32_16x16x32_bf16 v[100:103], v[20:23], v[32:35], v[100:103]
    ds_read_b64_tr_b16 v[24:25], v5 offset:16896
    ds_read_b64_tr_b16 v[26:27], v5 offset:17408
    ds_read_b64_tr_b16 v[28:29], v5 offset:16904
    ds_read_b64_tr_b16 v[30:31], v5 offset:17416
    ds_read_b128 v[52:55], v3 offset:10240
    s_waitcnt lgkmcnt(8)
    v_mfma_f32_16x16x32_bf16 v[104:107], v[16:19], v[36:39], v[104:107]
    v_mfma_f32_16x16x32_bf16 v[108:111], v[20:23], v[36:39], v[108:111]
    ds_read_b128 v[56:59], v3 offset:12288
    s_waitcnt lgkmcnt(8)
    v_mfma_f32_16x16x32_bf16 v[112:115], v[16:19], v[40:43], v[112:115]
    v_mfma_f32_16x16x32_bf16 v[116:119], v[20:23], v[40:43], v[116:119]
    ds_read_b128 v[60:63], v4 offset:0
    s_waitcnt lgkmcnt(8)
    v_mfma_f32_16x16x32_bf16 v[120:123], v[16:19], v[44:47], v[120:123]
    v_mfma_f32_16x16x32_bf16 v[124:127], v[20:23], v[44:47], v[124:127]
    ds_read_b128 v[64:67], v4 offset:2048
    s_waitcnt lgkmcnt(8)
    v_mfma_f32_16x16x32_bf16 v[128:131], v[16:19], v[48:51], v[128:131]
    v_mfma_f32_16x16x32_bf16 v[132:135], v[20:23], v[48:51], v[132:135]
    ds_read_b128 v[68:71], v4 offset:4096
    s_waitcnt lgkmcnt(4)
    v_mfma_f32_16x16x32_bf16 v[136:139], v[16:19], v[52:55], v[136:139]
    v_mfma_f32_16x16x32_bf16 v[140:143], v[20:23], v[52:55], v[140:143]
    ds_read_b128 v[72:75], v4 offset:6144
    s_waitcnt lgkmcnt(4)
    v_mfma_f32_16x16x32_bf16 v[144:147], v[16:19], v[56:59], v[144:147]
    v_mfma_f32_16x16x32_bf16 v[148:151], v[20:23], v[56:59], v[148:151]
    ds_read_b128 v[76:79], v4 offset:8192
    ds_read_b128 v[80:83], v4 offset:10240
    ds_read_b128 v[84:87], v4 offset:12288
    v_lshlrev_b32 v6, 4, v0
    s_lshl_b32 s42, s32, 10
    v_add_u32 v6, s42, v6
    s_waitcnt lgkmcnt(6)
    v_mfma_f32_16x16x32_bf16 v[96:99], v[24:27], v[60:63], v[96:99]
    v_mfma_f32_16x16x32_bf16 v[100:103], v[28:31], v[60:63], v[100:103]
    s_waitcnt lgkmcnt(5)
    v_mfma_f32_16x16x32_bf16 v[104:107], v[24:27], v[64:67], v[104:107]
    v_mfma_f32_16x16x32_bf16 v[108:111], v[28:31], v[64:67], v[108:111]
    s_waitcnt lgkmcnt(4)
    v_mfma_f32_16x16x32_bf16 v[112:115], v[24:27], v[68:71], v[112:115]
    v_mfma_f32_16x16x32_bf16 v[116:119], v[28:31], v[68:71], v[116:119]
    s_waitcnt lgkmcnt(3)
    v_mfma_f32_16x16x32_bf16 v[120:123], v[24:27], v[72:75], v[120:123]
    v_mfma_f32_16x16x32_bf16 v[124:127], v[28:31], v[72:75], v[124:127]
    v_pk_mul_f32 v[96:97], v[96:97], s[40:41] op_sel_hi:[1,0]
    v_pk_mul_f32 v[98:99], v[98:99], s[40:41] op_sel_hi:[1,0]
    v_pk_mul_f32 v[100:101], v[100:101], s[40:41] op_sel_hi:[1,0]
    v_pk_mul_f32 v[102:103], v[102:103], s[40:41] op_sel_hi:[1,0]
    v_cvt_pk_bf16_f32 v152, v96, v97
    v_cvt_pk_bf16_f32 v153, v98, v99
    v_cvt_pk_bf16_f32 v154, v100, v101
    v_cvt_pk_bf16_f32 v155, v102, v103
    ds_write_b128 v6, v[152:155] offset:0
    s_waitcnt lgkmcnt(3)
    v_mfma_f32_16x16x32_bf16 v[128:131], v[24:27], v[76:79], v[128:131]
    v_mfma_f32_16x16x32_bf16 v[132:135], v[28:31], v[76:79], v[132:135]
    v_pk_mul_f32 v[104:105], v[104:105], s[40:41] op_sel_hi:[1,0]
    v_pk_mul_f32 v[106:107], v[106:107], s[40:41] op_sel_hi:[1,0]
    v_pk_mul_f32 v[108:109], v[108:109], s[40:41] op_sel_hi:[1,0]
    v_pk_mul_f32 v[110:111], v[110:111], s[40:41] op_sel_hi:[1,0]
    v_cvt_pk_bf16_f32 v156, v104, v105
    v_cvt_pk_bf16_f32 v157, v106, v107
    v_cvt_pk_bf16_f32 v158, v108, v109
    v_cvt_pk_bf16_f32 v159, v110, v111
    ds_write_b128 v6, v[156:159] offset:8192
    s_waitcnt lgkmcnt(3)
    v_mfma_f32_16x16x32_bf16 v[136:139], v[24:27], v[80:83], v[136:139]
    v_mfma_f32_16x16x32_bf16 v[140:143], v[28:31], v[80:83], v[140:143]
    v_pk_mul_f32 v[112:113], v[112:113], s[40:41] op_sel_hi:[1,0]
    v_pk_mul_f32 v[114:115], v[114:115], s[40:41] op_sel_hi:[1,0]
    v_pk_mul_f32 v[116:117], v[116:117], s[40:41] op_sel_hi:[1,0]
    v_pk_mul_f32 v[118:119], v[118:119], s[40:41] op_sel_hi:[1,0]
    v_cvt_pk_bf16_f32 v160, v112, v113
    v_cvt_pk_bf16_f32 v161, v114, v115
    v_cvt_pk_bf16_f32 v162, v116, v117
    v_cvt_pk_bf16_f32 v163, v118, v119
    ds_write_b128 v6, v[160:163] offset:16896
    s_waitcnt lgkmcnt(3)
    v_mfma_f32_16x16x32_bf16 v[144:147], v[24:27], v[84:87], v[144:147]
    v_mfma_f32_16x16x32_bf16 v[148:151], v[28:31], v[84:87], v[148:151]
    v_pk_mul_f32 v[120:121], v[120:121], s[40:41] op_sel_hi:[1,0]
    v_pk_mul_f32 v[122:123], v[122:123], s[40:41] op_sel_hi:[1,0]
    v_pk_mul_f32 v[124:125], v[124:125], s[40:41] op_sel_hi:[1,0]
    v_pk_mul_f32 v[126:127], v[126:127], s[40:41] op_sel_hi:[1,0]
    v_cvt_pk_bf16_f32 v164, v120, v121
    v_cvt_pk_bf16_f32 v165, v122, v123
    v_cvt_pk_bf16_f32 v166, v124, v125
    v_cvt_pk_bf16_f32 v167, v126, v127
    ds_write_b128 v6, v[164:167] offset:25088
    v_pk_mul_f32 v[128:129], v[128:129], s[40:41] op_sel_hi:[1,0]
    v_pk_mul_f32 v[130:131], v[130:131], s[40:41] op_sel_hi:[1,0]
    v_pk_mul_f32 v[132:133], v[132:133], s[40:41] op_sel_hi:[1,0]
    v_pk_mul_f32 v[134:135], v[134:135], s[40:41] op_sel_hi:[1,0]
    v_cvt_pk_bf16_f32 v168, v128, v129
    v_cvt_pk_bf16_f32 v169, v130, v131
    v_cvt_pk_bf16_f32 v170, v132, v133
    v_cvt_pk_bf16_f32 v171, v134, v135
    ds_write_b128 v6, v[168:171] offset:33792
    v_pk_mul_f32 v[136:137], v[136:137], s[40:41] op_sel_hi:[1,0]
    v_pk_mul_f32 v[138:139], v[138:139], s[40:41] op_sel_hi:[1,0]
    v_pk_mul_f32 v[140:141], v[140:141], s[40:41] op_sel_hi:[1,0]
    v_pk_mul_f32 v[142:143], v[142:143], s[40:41] op_sel_hi:[1,0]
    v_cvt_pk_bf16_f32 v172, v136, v137
    v_cvt_pk_bf16_f32 v173, v138, v139
    v_cvt_pk_bf16_f32 v174, v140, v141
    v_cvt_pk_bf16_f32 v175, v142, v143
    ds_write_b128 v6, v[172:175] offset:41984
    v_pk_mul_f32 v[144:145], v[144:145], s[40:41] op_sel_hi:[1,0]
    v_pk_mul_f32 v[146:147], v[146:147], s[40:41] op_sel_hi:[1,0]
    v_pk_mul_f32 v[148:149], v[148:149], s[40:41] op_sel_hi:[1,0]
    v_pk_mul_f32 v[150:151], v[150:151], s[40:41] op_sel_hi:[1,0]
    v_cvt_pk_bf16_f32 v176, v144, v145
    v_cvt_pk_bf16_f32 v177, v146, v147
    v_cvt_pk_bf16_f32 v178, v148, v149
    v_cvt_pk_bf16_f32 v179, v150, v151
    v_add_u32 v6, 152064, v6
    ds_write_b128 v6, v[176:179] offset:0
    s_mov_b32 s39, 0
    s_cmp_eq_u32 s32, 3
    s_cbranch_scc1 L_swave3
    v_lshlrev_b32 v2, 4, v0
    s_mul_i32 s42, s33, 16896
    s_add_u32 s42, s42, 0
    v_add_u32 v9, s42, v2
    v_and_b32 v1, 15, v0
    v_mul_u32_u24 v1, 1056, v1
    v_lshrrev_b32 v11, 4, v0
    v_lshl_add_u32 v1, v11, 4, v1
    s_lshl_b32 s42, s33, 11
    v_add_u32 v2, s42, v2
    v_and_b32 v3, 15, v0
    v_lshlrev_b32 v3, 2, v3
    s_lshl_b32 s42, s33, 7
    s_add_u32 s42, s42, 160512
    v_add_u32 v3, s42, v3
    v_mov_b32 v6, 0
    v_mov_b32 v136, 0
    v_mov_b32 v137, 0
    v_mov_b32 v138, 0
    v_mov_b32 v139, 0
    v_mov_b32 v7, 0
    v_mov_b32 v140, 0
    v_mov_b32 v141, 0
    v_mov_b32 v142, 0
    v_mov_b32 v143, 0
    s_mov_b32 s41, 0x40004000
    s_setprio 1
    s_waitcnt lgkmcnt(0)
    s_waitcnt vmcnt(2)
    s_barrier
    ds_read_b128 v[16:19], v9 offset:0
    ds_read_b128 v[20:23], v9 offset:1024
    ds_read_b128 v[48:51], v9 offset:8192
    ds_read_b128 v[52:55], v9 offset:9216
    v_add_u32 v1, 50688, v1
    ds_read_b128 v[144:147], v1 offset:0
    ds_read_b128 v[148:151], v1 offset:512
    ds_read_b128 v[152:155], v1 offset:64
    ds_read_b128 v[156:159], v1 offset:576
    ds_read_b128 v[160:163], v1 offset:128
    ds_read_b128 v[164:167], v1 offset:640
    ds_read_b128 v[168:171], v1 offset:192
    ds_read_b128 v[172:175], v1 offset:704
    ds_read_b128 v[176:179], v1 offset:256
    ds_read_b128 v[180:183], v1 offset:768
    ds_read_b128 v[184:187], v1 offset:320
    ds_read_b128 v[188:191], v1 offset:832
    ds_read_b128 v[192:195], v1 offset:384
    ds_read_b128 v[196:199], v1 offset:896
    ds_read_b128 v[24:27], v9 offset:2048
    ds_read_b128 v[56:59], v9 offset:10240
    ds_read_b128 v[28:31], v9 offset:3072
    ds_read_b128 v[60:63], v9 offset:11264
    ds_read_b128 v[32:35], v9 offset:4096
    ds_read_b128 v[64:67], v9 offset:12288
    ds_read_b128 v[36:39], v9 offset:5120
    ds_read_b128 v[68:71], v9 offset:13312
    ds_read_b128 v[40:43], v9 offset:6144
    ds_read_b128 v[72:75], v9 offset:14336
    ds_read_b128 v[44:47], v9 offset:7168
    ds_read_b128 v[76:79], v9 offset:15360
    s_waitcnt lgkmcnt(15)
    v_mfma_f32_16x16x32_bf16 v[80:83], v[144:147], v[16:19], v[136:139]
    v_mfma_f32_16x16x32_bf16 v[88:91], v[144:147], v[48:51], v[140:143]
    ds_read_b128 v[200:203], v1 offset:448
    v_mfma_f32_16x16x32_bf16 v[84:87], v[148:151], v[16:19], v[136:139]
    v_mfma_f32_16x16x32_bf16 v[92:95], v[148:151], v[48:51], v[140:143]
    ds_read_b128 v[204:207], v1 offset:960
    v_mfma_f32_16x16x32_bf16 v[80:83], v[152:155], v[20:23], v[80:83]
    v_mfma_f32_16x16x32_bf16 v[88:91], v[152:155], v[52:55], v[88:91]
    v_add_u32 v1, 16896, v1
    ds_read_b128 v[144:147], v1 offset:0
    v_mfma_f32_16x16x32_bf16 v[84:87], v[156:159], v[20:23], v[84:87]
    v_mfma_f32_16x16x32_bf16 v[92:95], v[156:159], v[52:55], v[92:95]
    ds_read_b128 v[148:151], v1 offset:512
    s_waitcnt lgkmcnt(15)
    v_mfma_f32_16x16x32_bf16 v[80:83], v[160:163], v[24:27], v[80:83]
    s_waitcnt lgkmcnt(14)
    v_mfma_f32_16x16x32_bf16 v[88:91], v[160:163], v[56:59], v[88:91]
    ds_read_b128 v[152:155], v1 offset:64
    v_mfma_f32_16x16x32_bf16 v[84:87], v[164:167], v[24:27], v[84:87]
    v_mfma_f32_16x16x32_bf16 v[92:95], v[164:167], v[56:59], v[92:95]
    ds_read_b128 v[156:159], v1 offset:576
    s_waitcnt lgkmcnt(15)
    v_mfma_f32_16x16x32_bf16 v[80:83], v[168:171], v[28:31], v[80:83]
    s_waitcnt lgkmcnt(14)
    v_mfma_f32_16x16x32_bf16 v[88:91], v[168:171], v[60:63], v[88:91]
    ds_read_b128 v[160:163], v1 offset:128
    v_mfma_f32_16x16x32_bf16 v[84:87], v[172:175], v[28:31], v[84:87]
    v_mfma_f32_16x16x32_bf16 v[92:95], v[172:175], v[60:63], v[92:95]
    ds_read_b128 v[164:167], v1 offset:640
    s_waitcnt lgkmcnt(15)
    v_mfma_f32_16x16x32_bf16 v[80:83], v[176:179], v[32:35], v[80:83]
    s_waitcnt lgkmcnt(14)
    v_mfma_f32_16x16x32_bf16 v[88:91], v[176:179], v[64:67], v[88:91]
    ds_read_b128 v[168:171], v1 offset:192
    v_mfma_f32_16x16x32_bf16 v[84:87], v[180:183], v[32:35], v[84:87]
    v_mfma_f32_16x16x32_bf16 v[92:95], v[180:183], v[64:67], v[92:95]
    ds_read_b128 v[172:175], v1 offset:704
    s_waitcnt lgkmcnt(15)
    v_mfma_f32_16x16x32_bf16 v[80:83], v[184:187], v[36:39], v[80:83]
    s_waitcnt lgkmcnt(14)
    v_mfma_f32_16x16x32_bf16 v[88:91], v[184:187], v[68:71], v[88:91]
    ds_read_b128 v[176:179], v1 offset:256
    v_mfma_f32_16x16x32_bf16 v[84:87], v[188:191], v[36:39], v[84:87]
    v_mfma_f32_16x16x32_bf16 v[92:95], v[188:191], v[68:71], v[92:95]
    ds_read_b128 v[180:183], v1 offset:768
    s_waitcnt lgkmcnt(15)
    v_mfma_f32_16x16x32_bf16 v[80:83], v[192:195], v[40:43], v[80:83]
    s_waitcnt lgkmcnt(14)
    v_mfma_f32_16x16x32_bf16 v[88:91], v[192:195], v[72:75], v[88:91]
    ds_read_b128 v[184:187], v1 offset:320
    v_mfma_f32_16x16x32_bf16 v[84:87], v[196:199], v[40:43], v[84:87]
    v_mfma_f32_16x16x32_bf16 v[92:95], v[196:199], v[72:75], v[92:95]
    ds_read_b128 v[188:191], v1 offset:832
    s_waitcnt lgkmcnt(12)
    v_mfma_f32_16x16x32_bf16 v[80:83], v[200:203], v[44:47], v[80:83]
    v_mfma_f32_16x16x32_bf16 v[88:91], v[200:203], v[76:79], v[88:91]
    ds_read_b128 v[192:195], v1 offset:384
    v_mfma_f32_16x16x32_bf16 v[84:87], v[204:207], v[44:47], v[84:87]
    v_mfma_f32_16x16x32_bf16 v[92:95], v[204:207], v[76:79], v[92:95]
    ds_read_b128 v[196:199], v1 offset:896
    s_waitcnt vmcnt(0)
    s_barrier
    s_cmp_lg_u32 s32, 0
    s_cbranch_scc1 L_noclr2
    s_lshr_b32 s44, s2, 5
    s_lshl_b32 s44, s44, 5
    v_mov_b32 v14, s44
    s_and_b32 s42, s2, 31
    s_lshl_b32 s42, 1, s42
    v_mov_b32 v15, s42
    s_mov_b64 exec, 1
    global_atomic_or v14, v15, s[56:57] sc1
    s_mov_b64 exec, -1
L_noclr2:
    s_waitcnt lgkmcnt(12)
    v_mfma_f32_16x16x32_bf16 v[96:99], v[144:147], v[16:19], v[136:139]
    v_mfma_f32_16x16x32_bf16 v[104:107], v[144:147], v[48:51], v[140:143]
    ds_read_b128 v[200:203], v1 offset:448
    v_mfma_f32_16x16x32_bf16 v[100:103], v[148:151], v[16:19], v[136:139]
    v_mfma_f32_16x16x32_bf16 v[108:111], v[148:151], v[48:51], v[140:143]
    ds_read_b128 v[204:207], v1 offset:960
    s_waitcnt lgkmcnt(12)
    v_mfma_f32_16x16x32_bf16 v[96:99], v[152:155], v[20:23], v[96:99]
    v_mfma_f32_16x16x32_bf16 v[104:107], v[152:155], v[52:55], v[104:107]
    v_mfma_f32_16x16x32_bf16 v[100:103], v[156:159], v[20:23], v[100:103]
    v_mfma_f32_16x16x32_bf16 v[108:111], v[156:159], v[52:55], v[108:111]
    s_waitcnt lgkmcnt(10)
    v_mfma_f32_16x16x32_bf16 v[96:99], v[160:163], v[24:27], v[96:99]
    s_add_u32 s39, s39, 1
    v_max3_f32 v9, v80, v81, v82
    v_max3_f32 v9, v9, v83, v84
    v_max3_f32 v9, v9, v85, v86
    v_max_f32 v9, v9, v87
    v_max3_f32 v10, v88, v89, v90
    v_max3_f32 v10, v10, v91, v92
    v_max3_f32 v10, v10, v93, v94
    v_max_f32 v10, v10, v95
    v_mov_b32 v11, v9
    v_mov_b32 v12, v10
    s_nop 1
    v_permlane16_swap_b32 v9, v11
    v_permlane16_swap_b32 v10, v12
    v_max_f32 v9, v9, v11
    v_max_f32 v10, v10, v12
    v_mov_b32 v11, v9
    v_mov_b32 v12, v10
    s_nop 1
    v_permlane32_swap_b32 v9, v11
    v_permlane32_swap_b32 v10, v12
    v_max_f32 v9, v9, v11
    v_max_f32 v10, v10, v12
    v_sub_f32 v9, 0xc0e00000, v9
    v_add_f32 v136, v136, v9
    v_add_f32 v137, v137, v9
    v_add_f32 v138, v138, v9
    v_add_f32 v139, v139, v9
    v_add_f32 v80, v80, v9
    v_add_f32 v81, v81, v9
    v_add_f32 v82, v82, v9
    v_add_f32 v83, v83, v9
    v_add_f32 v84, v84, v9
    v_add_f32 v85, v85, v9
    v_add_f32 v86, v86, v9
    v_add_f32 v87, v87, v9
    v_add_f32 v96, v96, v9
    v_add_f32 v97, v97, v9
    v_add_f32 v98, v98, v9
    v_add_f32 v99, v99, v9
    v_add_f32 v100, v100, v9
    v_add_f32 v101, v101, v9
    v_add_f32 v102, v102, v9
    v_add_f32 v103, v103, v9
    v_sub_f32 v10, 0xc0e00000, v10
    v_add_f32 v140, v140, v10
    v_add_f32 v141, v141, v10
    v_add_f32 v142, v142, v10
    v_add_f32 v143, v143, v10
    v_add_f32 v88, v88, v10
    v_add_f32 v89, v89, v10
    v_add_f32 v90, v90, v10
    v_add_f32 v91, v91, v10
    v_add_f32 v92, v92, v10
    v_add_f32 v93, v93, v10
    v_add_f32 v94, v94, v10
    v_add_f32 v95, v95, v10
    v_add_f32 v104, v104, v10
    v_add_f32 v105, v105, v10
    v_add_f32 v106, v106, v10
    v_add_f32 v107, v107, v10
    v_add_f32 v108, v108, v10
    v_add_f32 v109, v109, v10
    v_add_f32 v110, v110, v10
    v_add_f32 v111, v111, v10
    v_exp_f32 v120, v80
    v_exp_f32 v121, v81
    v_exp_f32 v122, v82
    v_exp_f32 v123, v83
    v_cvt_pk_bf16_f32 v112, v120, v121
    v_exp_f32 v124, v84
    v_exp_f32 v125, v85
    v_cvt_pk_bf16_f32 v113, v122, v123
    v_exp_f32 v126, v86
    v_exp_f32 v127, v87
    v_cvt_pk_bf16_f32 v114, v124, v125
    v_exp_f32 v128, v88
    v_exp_f32 v129, v89
    v_cvt_pk_bf16_f32 v115, v126, v127
    v_exp_f32 v130, v90
    v_exp_f32 v131, v91
    v_cvt_pk_bf16_f32 v116, v128, v129
    v_exp_f32 v132, v92
    v_exp_f32 v133, v93
    v_cvt_pk_bf16_f32 v117, v130, v131
    v_exp_f32 v134, v94
    v_exp_f32 v135, v95
    v_cvt_pk_bf16_f32 v118, v132, v133
    v_cvt_pk_bf16_f32 v119, v134, v135
    v_mfma_f32_16x16x32_bf16 v[104:107], v[160:163], v[56:59], v[104:107]
    ds_write_b128 v2, v[112:115] offset:0
    v_mfma_f32_16x16x32_bf16 v[100:103], v[164:167], v[24:27], v[100:103]
    ds_write_b128 v2, v[116:119] offset:1024
    v_mfma_f32_16x16x32_bf16 v[108:111], v[164:167], v[56:59], v[108:111]
    v_add_f32 v6, v6, v120
    s_waitcnt lgkmcnt(10)
    v_mfma_f32_16x16x32_bf16 v[96:99], v[168:171], v[28:31], v[96:99]
    v_add_f32 v7, v7, v128
    v_mfma_f32_16x16x32_bf16 v[104:107], v[168:171], v[60:63], v[104:107]
    v_add_f32 v6, v6, v121
    v_mfma_f32_16x16x32_bf16 v[100:103], v[172:175], v[28:31], v[100:103]
    v_add_f32 v7, v7, v129
    v_mfma_f32_16x16x32_bf16 v[108:111], v[172:175], v[60:63], v[108:111]
    v_add_f32 v6, v6, v122
    s_waitcnt lgkmcnt(8)
    v_mfma_f32_16x16x32_bf16 v[96:99], v[176:179], v[32:35], v[96:99]
    v_add_f32 v7, v7, v130
    v_mfma_f32_16x16x32_bf16 v[104:107], v[176:179], v[64:67], v[104:107]
    v_add_f32 v6, v6, v123
    v_mfma_f32_16x16x32_bf16 v[100:103], v[180:183], v[32:35], v[100:103]
    v_mfma_f32_16x16x32_bf16 v[108:111], v[180:183], v[64:67], v[108:111]
    v_add_f32 v7, v7, v131
    s_waitcnt lgkmcnt(6)
    v_mfma_f32_16x16x32_bf16 v[96:99], v[184:187], v[36:39], v[96:99]
    v_add_f32 v6, v6, v124
    v_mfma_f32_16x16x32_bf16 v[104:107], v[184:187], v[68:71], v[104:107]
    v_add_f32 v7, v7, v132
    v_mfma_f32_16x16x32_bf16 v[100:103], v[188:191], v[36:39], v[100:103]
    v_add_f32 v6, v6, v125
    v_mfma_f32_16x16x32_bf16 v[108:111], v[188:191], v[68:71], v[108:111]
    v_add_f32 v7, v7, v133
    s_waitcnt lgkmcnt(4)
    v_mfma_f32_16x16x32_bf16 v[96:99], v[192:195], v[40:43], v[96:99]
    v_add_f32 v6, v6, v126
    v_mfma_f32_16x16x32_bf16 v[104:107], v[192:195], v[72:75], v[104:107]
    v_add_f32 v7, v7, v134
    v_mfma_f32_16x16x32_bf16 v[100:103], v[196:199], v[40:43], v[100:103]
    v_add_f32 v6, v6, v127
    v_mfma_f32_16x16x32_bf16 v[108:111], v[196:199], v[72:75], v[108:111]
    v_add_f32 v7, v7, v135
    s_waitcnt lgkmcnt(2)
    v_mfma_f32_16x16x32_bf16 v[96:99], v[200:203], v[44:47], v[96:99]
    v_mfma_f32_16x16x32_bf16 v[104:107], v[200:203], v[76:79], v[104:107]
    v_mfma_f32_16x16x32_bf16 v[100:103], v[204:207], v[44:47], v[100:103]
    v_mfma_f32_16x16x32_bf16 v[108:111], v[204:207], v[76:79], v[108:111]
    s_waitcnt lgkmcnt(0)
    s_barrier
    v_add_u32 v1, 33792, v1
    ds_read_b128 v[144:147], v1 offset:0
    ds_read_b128 v[148:151], v1 offset:512
    ds_read_b128 v[152:155], v1 offset:64
    ds_read_b128 v[156:159], v1 offset:576
    ds_read_b128 v[160:163], v1 offset:128
    ds_read_b128 v[164:167], v1 offset:640
    ds_read_b128 v[168:171], v1 offset:192
    ds_read_b128 v[172:175], v1 offset:704
    ds_read_b128 v[176:179], v1 offset:256
    ds_read_b128 v[180:183], v1 offset:768
    ds_read_b128 v[184:187], v1 offset:320
    ds_read_b128 v[188:191], v1 offset:832
    ds_read_b128 v[192:195], v1 offset:384
    ds_read_b128 v[196:199], v1 offset:896
    s_waitcnt lgkmcnt(12)
    v_mfma_f32_16x16x32_bf16 v[80:83], v[144:147], v[16:19], v[136:139]
    v_mfma_f32_16x16x32_bf16 v[88:91], v[144:147], v[48:51], v[140:143]
    ds_read_b128 v[200:203], v1 offset:448
    v_mfma_f32_16x16x32_bf16 v[84:87], v[148:151], v[16:19], v[136:139]
    v_mfma_f32_16x16x32_bf16 v[92:95], v[148:151], v[48:51], v[140:143]
    ds_read_b128 v[204:207], v1 offset:960
    s_waitcnt lgkmcnt(12)
    v_mfma_f32_16x16x32_bf16 v[80:83], v[152:155], v[20:23], v[80:83]
    v_mfma_f32_16x16x32_bf16 v[88:91], v[152:155], v[52:55], v[88:91]
    v_add_u32 v1, 33792, v1
    ds_read_b128 v[144:147], v1 offset:0
    v_mfma_f32_16x16x32_bf16 v[84:87], v[156:159], v[20:23], v[84:87]
    v_mfma_f32_16x16x32_bf16 v[92:95], v[156:159], v[52:55], v[92:95]
    ds_read_b128 v[148:151], v1 offset:512
    s_waitcnt lgkmcnt(12)
    v_mfma_f32_16x16x32_bf16 v[80:83], v[160:163], v[24:27], v[80:83]
    v_exp_f32 v120, v96
    v_exp_f32 v121, v97
    v_exp_f32 v122, v98
    v_mfma_f32_16x16x32_bf16 v[88:91], v[160:163], v[56:59], v[88:91]
    ds_read_b128 v[152:155], v1 offset:64
    v_exp_f32 v123, v99
    v_cvt_pk_bf16_f32 v112, v120, v121
    v_mfma_f32_16x16x32_bf16 v[84:87], v[164:167], v[24:27], v[84:87]
    v_exp_f32 v124, v100
    v_exp_f32 v125, v101
    v_cvt_pk_bf16_f32 v113, v122, v123
    v_mfma_f32_16x16x32_bf16 v[92:95], v[164:167], v[56:59], v[92:95]
    ds_read_b128 v[156:159], v1 offset:576
    v_exp_f32 v126, v102
    v_exp_f32 v127, v103
    s_waitcnt lgkmcnt(12)
    v_mfma_f32_16x16x32_bf16 v[80:83], v[168:171], v[28:31], v[80:83]
    v_cvt_pk_bf16_f32 v114, v124, v125
    v_exp_f32 v128, v104
    v_exp_f32 v129, v105
    v_mfma_f32_16x16x32_bf16 v[88:91], v[168:171], v[60:63], v[88:91]
    ds_read_b128 v[160:163], v1 offset:128
    v_cvt_pk_bf16_f32 v115, v126, v127
    v_exp_f32 v130, v106
    v_mfma_f32_16x16x32_bf16 v[84:87], v[172:175], v[28:31], v[84:87]
    v_exp_f32 v131, v107
    v_cvt_pk_bf16_f32 v116, v128, v129
    v_exp_f32 v132, v108
    v_mfma_f32_16x16x32_bf16 v[92:95], v[172:175], v[60:63], v[92:95]
    ds_read_b128 v[164:167], v1 offset:640
    v_exp_f32 v133, v109
    v_cvt_pk_bf16_f32 v117, v130, v131
    s_waitcnt lgkmcnt(12)
    v_mfma_f32_16x16x32_bf16 v[80:83], v[176:179], v[32:35], v[80:83]
    v_exp_f32 v134, v110
    v_exp_f32 v135, v111
    v_cvt_pk_bf16_f32 v118, v132, v133
    v_mfma_f32_16x16x32_bf16 v[88:91], v[176:179], v[64:67], v[88:91]
    ds_read_b128 v[168:171], v1 offset:192
    v_cvt_pk_bf16_f32 v119, v134, v135
    v_or3_b32 v9, v112, v113, v114
    v_mfma_f32_16x16x32_bf16 v[84:87], v[180:183], v[32:35], v[84:87]
    v_or3_b32 v11, v115, v116, v117
    v_or3_b32 v9, v9, v118, v119
    v_or_b32 v9, v9, v11
    v_mfma_f32_16x16x32_bf16 v[92:95], v[180:183], v[64:67], v[92:95]
    ds_read_b128 v[172:175], v1 offset:704
    v_and_b32 v9, s41, v9
    v_cmp_ne_u32 vcc, 0, v9
    s_waitcnt lgkmcnt(12)
    v_mfma_f32_16x16x32_bf16 v[80:83], v[184:187], v[36:39], v[80:83]
    v_mfma_f32_16x16x32_bf16 v[88:91], v[184:187], v[68:71], v[88:91]
    ds_read_b128 v[176:179], v1 offset:256
    s_add_u32 s39, s39, 1
    s_cbranch_vccnz L_stub_sa_2
L_back_sa_2:
    ds_write_b128 v2, v[112:115] offset:7168
    v_mfma_f32_16x16x32_bf16 v[84:87], v[188:191], v[36:39], v[84:87]
    ds_write_b128 v2, v[116:119] offset:8192
    v_add_f32 v6, v6, v120
    v_add_f32 v7, v7, v128
    v_mfma_f32_16x16x32_bf16 v[92:95], v[188:191], v[68:71], v[92:95]
    ds_read_b128 v[180:183], v1 offset:768
    v_add_f32 v6, v6, v121
    v_add_f32 v7, v7, v129
    s_waitcnt lgkmcnt(14)
    v_mfma_f32_16x16x32_bf16 v[80:83], v[192:195], v[40:43], v[80:83]
    v_add_f32 v6, v6, v122
    v_add_f32 v7, v7, v130
    v_add_f32 v6, v6, v123
    v_mfma_f32_16x16x32_bf16 v[88:91], v[192:195], v[72:75], v[88:91]
    ds_read_b128 v[184:187], v1 offset:320
    v_add_f32 v7, v7, v131
    v_add_f32 v6, v6, v124
    v_mfma_f32_16x16x32_bf16 v[84:87], v[196:199], v[40:43], v[84:87]
    v_add_f32 v7, v7, v132
    v_add_f32 v6, v6, v125
    v_add_f32 v7, v7, v133
    v_mfma_f32_16x16x32_bf16 v[92:95], v[196:199], v[72:75], v[92:95]
    ds_read_b128 v[188:191], v1 offset:832
    v_add_f32 v6, v6, v126
    v_add_f32 v7, v7, v134
    s_waitcnt lgkmcnt(14)
    v_mfma_f32_16x16x32_bf16 v[80:83], v[200:203], v[44:47], v[80:83]
    v_add_f32 v6, v6, v127
    v_add_f32 v7, v7, v135
    v_mfma_f32_16x16x32_bf16 v[88:91], v[200:203], v[76:79], v[88:91]
    ds_read_b128 v[192:195], v1 offset:384
    v_mfma_f32_16x16x32_bf16 v[84:87], v[204:207], v[44:47], v[84:87]
    v_mfma_f32_16x16x32_bf16 v[92:95], v[204:207], v[76:79], v[92:95]
    ds_read_b128 v[196:199], v1 offset:896
    s_waitcnt lgkmcnt(5)
    s_barrier
    v_mfma_f32_16x16x32_bf16 v[96:99], v[144:147], v[16:19], v[136:139]
    v_mfma_f32_16x16x32_bf16 v[104:107], v[144:147], v[48:51], v[140:143]
    ds_read_b128 v[200:203], v1 offset:448
    v_mfma_f32_16x16x32_bf16 v[100:103], v[148:151], v[16:19], v[136:139]
    v_mfma_f32_16x16x32_bf16 v[108:111], v[148:151], v[48:51], v[140:143]
    ds_read_b128 v[204:207], v1 offset:960
    v_mfma_f32_16x16x32_bf16 v[96:99], v[152:155], v[20:23], v[96:99]
    v_mfma_f32_16x16x32_bf16 v[104:107], v[152:155], v[52:55], v[104:107]
    v_add_u32 v1, 4294882816, v1
    ds_read_b128 v[144:147], v1 offset:0
    v_mfma_f32_16x16x32_bf16 v[100:103], v[156:159], v[20:23], v[100:103]
    v_mfma_f32_16x16x32_bf16 v[108:111], v[156:159], v[52:55], v[108:111]
    ds_read_b128 v[148:151], v1 offset:512
    v_mfma_f32_16x16x32_bf16 v[96:99], v[160:163], v[24:27], v[96:99]
    v_exp_f32 v120, v80
    v_exp_f32 v121, v81
    v_exp_f32 v122, v82
    v_mfma_f32_16x16x32_bf16 v[104:107], v[160:163], v[56:59], v[104:107]
    ds_read_b128 v[152:155], v1 offset:64
    v_exp_f32 v123, v83
    v_cvt_pk_bf16_f32 v112, v120, v121
    v_mfma_f32_16x16x32_bf16 v[100:103], v[164:167], v[24:27], v[100:103]
    v_exp_f32 v124, v84
    v_exp_f32 v125, v85
    v_cvt_pk_bf16_f32 v113, v122, v123
    v_mfma_f32_16x16x32_bf16 v[108:111], v[164:167], v[56:59], v[108:111]
    ds_read_b128 v[156:159], v1 offset:576
    v_exp_f32 v126, v86
    v_exp_f32 v127, v87
    v_mfma_f32_16x16x32_bf16 v[96:99], v[168:171], v[28:31], v[96:99]
    v_cvt_pk_bf16_f32 v114, v124, v125
    v_exp_f32 v128, v88
    v_exp_f32 v129, v89
    v_mfma_f32_16x16x32_bf16 v[104:107], v[168:171], v[60:63], v[104:107]
    ds_read_b128 v[160:163], v1 offset:128
    v_cvt_pk_bf16_f32 v115, v126, v127
    v_exp_f32 v130, v90
    v_mfma_f32_16x16x32_bf16 v[100:103], v[172:175], v[28:31], v[100:103]
    v_exp_f32 v131, v91
    v_cvt_pk_bf16_f32 v116, v128, v129
    v_exp_f32 v132, v92
    v_mfma_f32_16x16x32_bf16 v[108:111], v[172:175], v[60:63], v[108:111]
    ds_read_b128 v[164:167], v1 offset:640
    v_exp_f32 v133, v93
    v_cvt_pk_bf16_f32 v117, v130, v131
    s_waitcnt lgkmcnt(12)
    v_mfma_f32_16x16x32_bf16 v[96:99], v[176:179], v[32:35], v[96:99]
    v_exp_f32 v134, v94
    v_exp_f32 v135, v95
    v_cvt_pk_bf16_f32 v118, v132, v133
    v_mfma_f32_16x16x32_bf16 v[104:107], v[176:179], v[64:67], v[104:107]
    ds_read_b128 v[168:171], v1 offset:192
    v_cvt_pk_bf16_f32 v119, v134, v135
    v_or3_b32 v9, v112, v113, v114
    v_mfma_f32_16x16x32_bf16 v[100:103], v[180:183], v[32:35], v[100:103]
    v_or3_b32 v11, v115, v116, v117
    v_or3_b32 v9, v9, v118, v119
    v_or_b32 v9, v9, v11
    v_mfma_f32_16x16x32_bf16 v[108:111], v[180:183], v[64:67], v[108:111]
    ds_read_b128 v[172:175], v1 offset:704
    v_and_b32 v9, s41, v9
    v_cmp_ne_u32 vcc, 0, v9
    s_waitcnt lgkmcnt(12)
    v_mfma_f32_16x16x32_bf16 v[96:99], v[184:187], v[36:39], v[96:99]
    v_mfma_f32_16x16x32_bf16 v[104:107], v[184:187], v[68:71], v[104:107]
    ds_read_b128 v[176:179], v1 offset:256
    s_add_u32 s39, s39, 1
    s_cbranch_vccnz L_stub_sa_3
L_back_sa_3:
    ds_write_b128 v2, v[112:115] offset:0
    v_mfma_f32_16x16x32_bf16 v[100:103], v[188:191], v[36:39], v[100:103]
    ds_write_b128 v2, v[116:119] offset:1024
    v_add_f32 v6, v6, v120
    v_add_f32 v7, v7, v128
    v_mfma_f32_16x16x32_bf16 v[108:111], v[188:191], v[68:71], v[108:111]
    ds_read_b128 v[180:183], v1 offset:768
    v_add_f32 v6, v6, v121
    v_add_f32 v7, v7, v129
    s_waitcnt lgkmcnt(14)
    v_mfma_f32_16x16x32_bf16 v[96:99], v[192:195], v[40:43], v[96:99]
    v_add_f32 v6, v6, v122
    v_add_f32 v7, v7, v130
    v_add_f32 v6, v6, v123
    v_mfma_f32_16x16x32_bf16 v[104:107], v[192:195], v[72:75], v[104:107]
    ds_read_b128 v[184:187], v1 offset:320
    v_add_f32 v7, v7, v131
    v_add_f32 v6, v6, v124
    v_mfma_f32_16x16x32_bf16 v[100:103], v[196:199], v[40:43], v[100:103]
    v_add_f32 v7, v7, v132
    v_add_f32 v6, v6, v125
    v_add_f32 v7, v7, v133
    v_mfma_f32_16x16x32_bf16 v[108:111], v[196:199], v[72:75], v[108:111]
    ds_read_b128 v[188:191], v1 offset:832
    v_add_f32 v6, v6, v126
    v_add_f32 v7, v7, v134
    s_waitcnt lgkmcnt(14)
    v_mfma_f32_16x16x32_bf16 v[96:99], v[200:203], v[44:47], v[96:99]
    v_add_f32 v6, v6, v127
    v_add_f32 v7, v7, v135
    v_mfma_f32_16x16x32_bf16 v[104:107], v[200:203], v[76:79], v[104:107]
    ds_read_b128 v[192:195], v1 offset:384
    v_mfma_f32_16x16x32_bf16 v[100:103], v[204:207], v[44:47], v[100:103]
    v_mfma_f32_16x16x32_bf16 v[108:111], v[204:207], v[76:79], v[108:111]
    ds_read_b128 v[196:199], v1 offset:896
    s_waitcnt lgkmcnt(5)
    s_barrier
    v_mfma_f32_16x16x32_bf16 v[80:83], v[144:147], v[16:19], v[136:139]
    v_mfma_f32_16x16x32_bf16 v[88:91], v[144:147], v[48:51], v[140:143]
    ds_read_b128 v[200:203], v1 offset:448
    v_mfma_f32_16x16x32_bf16 v[84:87], v[148:151], v[16:19], v[136:139]
    v_mfma_f32_16x16x32_bf16 v[92:95], v[148:151], v[48:51], v[140:143]
    ds_read_b128 v[204:207], v1 offset:960
    v_mfma_f32_16x16x32_bf16 v[80:83], v[152:155], v[20:23], v[80:83]
    v_mfma_f32_16x16x32_bf16 v[88:91], v[152:155], v[52:55], v[88:91]
    v_add_u32 v1, 16896, v1
    ds_read_b128 v[144:147], v1 offset:0
    v_mfma_f32_16x16x32_bf16 v[84:87], v[156:159], v[20:23], v[84:87]
    v_mfma_f32_16x16x32_bf16 v[92:95], v[156:159], v[52:55], v[92:95]
    ds_read_b128 v[148:151], v1 offset:512
    v_mfma_f32_16x16x32_bf16 v[80:83], v[160:163], v[24:27], v[80:83]
    v_exp_f32 v120, v96
    v_exp_f32 v121, v97
    v_exp_f32 v122, v98
    v_mfma_f32_16x16x32_bf16 v[88:91], v[160:163], v[56:59], v[88:91]
    ds_read_b128 v[152:155], v1 offset:64
    v_exp_f32 v123, v99
    v_cvt_pk_bf16_f32 v112, v120, v121
    v_mfma_f32_16x16x32_bf16 v[84:87], v[164:167], v[24:27], v[84:87]
    v_exp_f32 v124, v100
    v_exp_f32 v125, v101
    v_cvt_pk_bf16_f32 v113, v122, v123
    v_mfma_f32_16x16x32_bf16 v[92:95], v[164:167], v[56:59], v[92:95]
    ds_read_b128 v[156:159], v1 offset:576
    v_exp_f32 v126, v102
    v_exp_f32 v127, v103
    v_mfma_f32_16x16x32_bf16 v[80:83], v[168:171], v[28:31], v[80:83]
    v_cvt_pk_bf16_f32 v114, v124, v125
    v_exp_f32 v128, v104
    v_exp_f32 v129, v105
    v_mfma_f32_16x16x32_bf16 v[88:91], v[168:171], v[60:63], v[88:91]
    ds_read_b128 v[160:163], v1 offset:128
    v_cvt_pk_bf16_f32 v115, v126, v127
    v_exp_f32 v130, v106
    v_mfma_f32_16x16x32_bf16 v[84:87], v[172:175], v[28:31], v[84:87]
    v_exp_f32 v131, v107
    v_cvt_pk_bf16_f32 v116, v128, v129
    v_exp_f32 v132, v108
    v_mfma_f32_16x16x32_bf16 v[92:95], v[172:175], v[60:63], v[92:95]
    ds_read_b128 v[164:167], v1 offset:640
    v_exp_f32 v133, v109
    v_cvt_pk_bf16_f32 v117, v130, v131
    s_waitcnt lgkmcnt(12)
    v_mfma_f32_16x16x32_bf16 v[80:83], v[176:179], v[32:35], v[80:83]
    v_exp_f32 v134, v110
    v_exp_f32 v135, v111
    v_cvt_pk_bf16_f32 v118, v132, v133
    v_mfma_f32_16x16x32_bf16 v[88:91], v[176:179], v[64:67], v[88:91]
    ds_read_b128 v[168:171], v1 offset:192
    v_cvt_pk_bf16_f32 v119, v134, v135
    v_or3_b32 v9, v112, v113, v114
    v_mfma_f32_16x16x32_bf16 v[84:87], v[180:183], v[32:35], v[84:87]
    v_or3_b32 v11, v115, v116, v117
    v_or3_b32 v9, v9, v118, v119
    v_or_b32 v9, v9, v11
    v_mfma_f32_16x16x32_bf16 v[92:95], v[180:183], v[64:67], v[92:95]
    ds_read_b128 v[172:175], v1 offset:704
    v_and_b32 v9, s41, v9
    v_cmp_ne_u32 vcc, 0, v9
    s_waitcnt lgkmcnt(12)
    v_mfma_f32_16x16x32_bf16 v[80:83], v[184:187], v[36:39], v[80:83]
    v_mfma_f32_16x16x32_bf16 v[88:91], v[184:187], v[68:71], v[88:91]
    ds_read_b128 v[176:179], v1 offset:256
    s_add_u32 s39, s39, 1
    s_cbranch_vccnz L_stub_sa_4
L_back_sa_4:
    ds_write_b128 v2, v[112:115] offset:7168
    v_mfma_f32_16x16x32_bf16 v[84:87], v[188:191], v[36:39], v[84:87]
    ds_write_b128 v2, v[116:119] offset:8192
    v_add_f32 v6, v6, v120
    v_add_f32 v7, v7, v128
    v_mfma_f32_16x16x32_bf16 v[92:95], v[188:191], v[68:71], v[92:95]
    ds_read_b128 v[180:183], v1 offset:768
    v_add_f32 v6, v6, v121
    v_add_f32 v7, v7, v129
    s_waitcnt lgkmcnt(14)
    v_mfma_f32_16x16x32_bf16 v[80:83], v[192:195], v[40:43], v[80:83]
    v_add_f32 v6, v6, v122
    v_add_f32 v7, v7, v130
    v_add_f32 v6, v6, v123
    v_mfma_f32_16x16x32_bf16 v[88:91], v[192:195], v[72:75], v[88:91]
    ds_read_b128 v[184:187], v1 offset:320
    v_add_f32 v7, v7, v131
    v_add_f32 v6, v6, v124
    v_mfma_f32_16x16x32_bf16 v[84:87], v[196:199], v[40:43], v[84:87]
    v_add_f32 v7, v7, v132
    v_add_f32 v6, v6, v125
    v_add_f32 v7, v7, v133
    v_mfma_f32_16x16x32_bf16 v[92:95], v[196:199], v[72:75], v[92:95]
    ds_read_b128 v[188:191], v1 offset:832
    v_add_f32 v6, v6, v126
    v_add_f32 v7, v7, v134
    s_waitcnt lgkmcnt(14)
    v_mfma_f32_16x16x32_bf16 v[80:83], v[200:203], v[44:47], v[80:83]
    v_add_f32 v6, v6, v127
    v_add_f32 v7, v7, v135
    v_mfma_f32_16x16x32_bf16 v[88:91], v[200:203], v[76:79], v[88:91]
    ds_read_b128 v[192:195], v1 offset:384
    v_mfma_f32_16x16x32_bf16 v[84:87], v[204:207], v[44:47], v[84:87]
    v_mfma_f32_16x16x32_bf16 v[92:95], v[204:207], v[76:79], v[92:95]
    ds_read_b128 v[196:199], v1 offset:896
    s_waitcnt lgkmcnt(5)
    s_barrier
    s_mov_b32 s38, 14
L_sloopa:
    v_mfma_f32_16x16x32_bf16 v[96:99], v[144:147], v[16:19], v[136:139]
    v_mfma_f32_16x16x32_bf16 v[104:107], v[144:147], v[48:51], v[140:143]
    ds_read_b128 v[200:203], v1 offset:448
    v_mfma_f32_16x16x32_bf16 v[100:103], v[148:151], v[16:19], v[136:139]
    v_mfma_f32_16x16x32_bf16 v[108:111], v[148:151], v[48:51], v[140:143]
    ds_read_b128 v[204:207], v1 offset:960
    v_mfma_f32_16x16x32_bf16 v[96:99], v[152:155], v[20:23], v[96:99]
    v_mfma_f32_16x16x32_bf16 v[104:107], v[152:155], v[52:55], v[104:107]
    v_add_u32 v1, 33792, v1
    ds_read_b128 v[144:147], v1 offset:0
    v_mfma_f32_16x16x32_bf16 v[100:103], v[156:159], v[20:23], v[100:103]
    v_mfma_f32_16x16x32_bf16 v[108:111], v[156:159], v[52:55], v[108:111]
    ds_read_b128 v[148:151], v1 offset:512
    v_mfma_f32_16x16x32_bf16 v[96:99], v[160:163], v[24:27], v[96:99]
    v_exp_f32 v120, v80
    v_exp_f32 v121, v81
    v_exp_f32 v122, v82
    v_mfma_f32_16x16x32_bf16 v[104:107], v[160:163], v[56:59], v[104:107]
    ds_read_b128 v[152:155], v1 offset:64
    v_exp_f32 v123, v83
    v_cvt_pk_bf16_f32 v112, v120, v121
    v_mfma_f32_16x16x32_bf16 v[100:103], v[164:167], v[24:27], v[100:103]
    v_exp_f32 v124, v84
    v_exp_f32 v125, v85
    v_cvt_pk_bf16_f32 v113, v122, v123
    v_mfma_f32_16x16x32_bf16 v[108:111], v[164:167], v[56:59], v[108:111]
    ds_read_b128 v[156:159], v1 offset:576
    v_exp_f32 v126, v86
    v_exp_f32 v127, v87
    v_mfma_f32_16x16x32_bf16 v[96:99], v[168:171], v[28:31], v[96:99]
    v_cvt_pk_bf16_f32 v114, v124, v125
    v_exp_f32 v128, v88
    v_exp_f32 v129, v89
    v_mfma_f32_16x16x32_bf16 v[104:107], v[168:171], v[60:63], v[104:107]
    ds_read_b128 v[160:163], v1 offset:128
    v_cvt_pk_bf16_f32 v115, v126, v127
    v_exp_f32 v130, v90
    v_mfma_f32_16x16x32_bf16 v[100:103], v[172:175], v[28:31], v[100:103]
    v_exp_f32 v131, v91
    v_cvt_pk_bf16_f32 v116, v128, v129
    v_exp_f32 v132, v92
    v_mfma_f32_16x16x32_bf16 v[108:111], v[172:175], v[60:63], v[108:111]
    ds_read_b128 v[164:167], v1 offset:640
    v_exp_f32 v133, v93
    v_cvt_pk_bf16_f32 v117, v130, v131
    s_waitcnt lgkmcnt(12)
    v_mfma_f32_16x16x32_bf16 v[96:99], v[176:179], v[32:35], v[96:99]
    v_exp_f32 v134, v94
    v_exp_f32 v135, v95
    v_cvt_pk_bf16_f32 v118, v132, v133
    v_mfma_f32_16x16x32_bf16 v[104:107], v[176:179], v[64:67], v[104:107]
    ds_read_b128 v[168:171], v1 offset:192
    v_cvt_pk_bf16_f32 v119, v134, v135
    v_or3_b32 v9, v112, v113, v114
    v_mfma_f32_16x16x32_bf16 v[100:103], v[180:183], v[32:35], v[100:103]
    v_or3_b32 v11, v115, v116, v117
    v_or3_b32 v9, v9, v118, v119
    v_or_b32 v9, v9, v11
    v_mfma_f32_16x16x32_bf16 v[108:111], v[180:183], v[64:67], v[108:111]
    ds_read_b128 v[172:175], v1 offset:704
    v_and_b32 v9, s41, v9
    v_cmp_ne_u32 vcc, 0, v9
    s_waitcnt lgkmcnt(12)
    v_mfma_f32_16x16x32_bf16 v[96:99], v[184:187], v[36:39], v[96:99]
    v_mfma_f32_16x16x32_bf16 v[104:107], v[184:187], v[68:71], v[104:107]
    ds_read_b128 v[176:179], v1 offset:256
    s_add_u32 s39, s39, 1
    s_cbranch_vccnz L_stub_sa_5
L_back_sa_5:
    ds_write_b128 v2, v[112:115] offset:0
    v_mfma_f32_16x16x32_bf16 v[100:103], v[188:191], v[36:39], v[100:103]
    ds_write_b128 v2, v[116:119] offset:1024
    v_add_f32 v6, v6, v120
    v_add_f32 v7, v7, v128
    v_mfma_f32_16x16x32_bf16 v[108:111], v[188:191], v[68:71], v[108:111]
    ds_read_b128 v[180:183], v1 offset:768
    v_add_f32 v6, v6, v121
    v_add_f32 v7, v7, v129
    s_waitcnt lgkmcnt(14)
    v_mfma_f32_16x16x32_bf16 v[96:99], v[192:195], v[40:43], v[96:99]
    v_add_f32 v6, v6, v122
    v_add_f32 v7, v7, v130
    v_add_f32 v6, v6, v123
    v_mfma_f32_16x16x32_bf16 v[104:107], v[192:195], v[72:75], v[104:107]
    ds_read_b128 v[184:187], v1 offset:320
    v_add_f32 v7, v7, v131
    v_add_f32 v6, v6, v124
    v_mfma_f32_16x16x32_bf16 v[100:103], v[196:199], v[40:43], v[100:103]
    v_add_f32 v7, v7, v132
    v_add_f32 v6, v6, v125
    v_add_f32 v7, v7, v133
    v_mfma_f32_16x16x32_bf16 v[108:111], v[196:199], v[72:75], v[108:111]
    ds_read_b128 v[188:191], v1 offset:832
    v_add_f32 v6, v6, v126
    v_add_f32 v7, v7, v134
    s_waitcnt lgkmcnt(14)
    v_mfma_f32_16x16x32_bf16 v[96:99], v[200:203], v[44:47], v[96:99]
    v_add_f32 v6, v6, v127
    v_add_f32 v7, v7, v135
    v_mfma_f32_16x16x32_bf16 v[104:107], v[200:203], v[76:79], v[104:107]
    ds_read_b128 v[192:195], v1 offset:384
    v_mfma_f32_16x16x32_bf16 v[100:103], v[204:207], v[44:47], v[100:103]
    v_mfma_f32_16x16x32_bf16 v[108:111], v[204:207], v[76:79], v[108:111]
    ds_read_b128 v[196:199], v1 offset:896
    s_waitcnt lgkmcnt(5)
    s_barrier
    v_mfma_f32_16x16x32_bf16 v[80:83], v[144:147], v[16:19], v[136:139]
    v_mfma_f32_16x16x32_bf16 v[88:91], v[144:147], v[48:51], v[140:143]
    ds_read_b128 v[200:203], v1 offset:448
    v_mfma_f32_16x16x32_bf16 v[84:87], v[148:151], v[16:19], v[136:139]
    v_mfma_f32_16x16x32_bf16 v[92:95], v[148:151], v[48:51], v[140:143]
    ds_read_b128 v[204:207], v1 offset:960
    v_mfma_f32_16x16x32_bf16 v[80:83], v[152:155], v[20:23], v[80:83]
    v_mfma_f32_16x16x32_bf16 v[88:91], v[152:155], v[52:55], v[88:91]
    v_add_u32 v1, 33792, v1
    ds_read_b128 v[144:147], v1 offset:0
    v_mfma_f32_16x16x32_bf16 v[84:87], v[156:159], v[20:23], v[84:87]
    v_mfma_f32_16x16x32_bf16 v[92:95], v[156:159], v[52:55], v[92:95]
    ds_read_b128 v[148:151], v1 offset:512
    v_mfma_f32_16x16x32_bf16 v[80:83], v[160:163], v[24:27], v[80:83]
    v_exp_f32 v120, v96
    v_exp_f32 v121, v97
    v_exp_f32 v122, v98
    v_mfma_f32_16x16x32_bf16 v[88:91], v[160:163], v[56:59], v[88:91]
    ds_read_b128 v[152:155], v1 offset:64
    v_exp_f32 v123, v99
    v_cvt_pk_bf16_f32 v112, v120, v121
    v_mfma_f32_16x16x32_bf16 v[84:87], v[164:167], v[24:27], v[84:87]
    v_exp_f32 v124, v100
    v_exp_f32 v125, v101
    v_cvt_pk_bf16_f32 v113, v122, v123
    v_mfma_f32_16x16x32_bf16 v[92:95], v[164:167], v[56:59], v[92:95]
    ds_read_b128 v[156:159], v1 offset:576
    v_exp_f32 v126, v102
    v_exp_f32 v127, v103
    v_mfma_f32_16x16x32_bf16 v[80:83], v[168:171], v[28:31], v[80:83]
    v_cvt_pk_bf16_f32 v114, v124, v125
    v_exp_f32 v128, v104
    v_exp_f32 v129, v105
    v_mfma_f32_16x16x32_bf16 v[88:91], v[168:171], v[60:63], v[88:91]
    ds_read_b128 v[160:163], v1 offset:128
    v_cvt_pk_bf16_f32 v115, v126, v127
    v_exp_f32 v130, v106
    v_mfma_f32_16x16x32_bf16 v[84:87], v[172:175], v[28:31], v[84:87]
    v_exp_f32 v131, v107
    v_cvt_pk_bf16_f32 v116, v128, v129
    v_exp_f32 v132, v108
    v_mfma_f32_16x16x32_bf16 v[92:95], v[172:175], v[60:63], v[92:95]
    ds_read_b128 v[164:167], v1 offset:640
    v_exp_f32 v133, v109
    v_cvt_pk_bf16_f32 v117, v130, v131
    s_waitcnt lgkmcnt(12)
    v_mfma_f32_16x16x32_bf16 v[80:83], v[176:179], v[32:35], v[80:83]
    v_exp_f32 v134, v110
    v_exp_f32 v135, v111
    v_cvt_pk_bf16_f32 v118, v132, v133
    v_mfma_f32_16x16x32_bf16 v[88:91], v[176:179], v[64:67], v[88:91]
    ds_read_b128 v[168:171], v1 offset:192
    v_cvt_pk_bf16_f32 v119, v134, v135
    v_or3_b32 v9, v112, v113, v114
    v_mfma_f32_16x16x32_bf16 v[84:87], v[180:183], v[32:35], v[84:87]
    v_or3_b32 v11, v115, v116, v117
    v_or3_b32 v9, v9, v118, v119
    v_or_b32 v9, v9, v11
    v_mfma_f32_16x16x32_bf16 v[92:95], v[180:183], v[64:67], v[92:95]
    ds_read_b128 v[172:175], v1 offset:704
    v_and_b32 v9, s41, v9
    v_cmp_ne_u32 vcc, 0, v9
    s_waitcnt lgkmcnt(12)
    v_mfma_f32_16x16x32_bf16 v[80:83], v[184:187], v[36:39], v[80:83]
    v_mfma_f32_16x16x32_bf16 v[88:91], v[184:187], v[68:71], v[88:91]
    ds_read_b128 v[176:179], v1 offset:256
    s_add_u32 s39, s39, 1
    s_cbranch_vccnz L_stub_sa_6
L_back_sa_6:
    ds_write_b128 v2, v[112:115] offset:7168
    v_mfma_f32_16x16x32_bf16 v[84:87], v[188:191], v[36:39], v[84:87]
    ds_write_b128 v2, v[116:119] offset:8192
    v_add_f32 v6, v6, v120
    v_add_f32 v7, v7, v128
    v_mfma_f32_16x16x32_bf16 v[92:95], v[188:191], v[68:71], v[92:95]
    ds_read_b128 v[180:183], v1 offset:768
    v_add_f32 v6, v6, v121
    v_add_f32 v7, v7, v129
    s_waitcnt lgkmcnt(14)
    v_mfma_f32_16x16x32_bf16 v[80:83], v[192:195], v[40:43], v[80:83]
    v_add_f32 v6, v6, v122
    v_add_f32 v7, v7, v130
    v_add_f32 v6, v6, v123
    v_mfma_f32_16x16x32_bf16 v[88:91], v[192:195], v[72:75], v[88:91]
    ds_read_b128 v[184:187], v1 offset:320
    v_add_f32 v7, v7, v131
    v_add_f32 v6, v6, v124
    v_mfma_f32_16x16x32_bf16 v[84:87], v[196:199], v[40:43], v[84:87]
    v_add_f32 v7, v7, v132
    v_add_f32 v6, v6, v125
    v_add_f32 v7, v7, v133
    v_mfma_f32_16x16x32_bf16 v[92:95], v[196:199], v[72:75], v[92:95]
    ds_read_b128 v[188:191], v1 offset:832
    v_add_f32 v6, v6, v126
    v_add_f32 v7, v7, v134
    s_waitcnt lgkmcnt(14)
    v_mfma_f32_16x16x32_bf16 v[80:83], v[200:203], v[44:47], v[80:83]
    v_add_f32 v6, v6, v127
    v_add_f32 v7, v7, v135
    v_mfma_f32_16x16x32_bf16 v[88:91], v[200:203], v[76:79], v[88:91]
    ds_read_b128 v[192:195], v1 offset:384
    v_mfma_f32_16x16x32_bf16 v[84:87], v[204:207], v[44:47], v[84:87]
    v_mfma_f32_16x16x32_bf16 v[92:95], v[204:207], v[76:79], v[92:95]
    ds_read_b128 v[196:199], v1 offset:896
    s_waitcnt lgkmcnt(5)
    s_barrier
    v_mfma_f32_16x16x32_bf16 v[96:99], v[144:147], v[16:19], v[136:139]
    v_mfma_f32_16x16x32_bf16 v[104:107], v[144:147], v[48:51], v[140:143]
    ds_read_b128 v[200:203], v1 offset:448
    v_mfma_f32_16x16x32_bf16 v[100:103], v[148:151], v[16:19], v[136:139]
    v_mfma_f32_16x16x32_bf16 v[108:111], v[148:151], v[48:51], v[140:143]
    ds_read_b128 v[204:207], v1 offset:960
    v_mfma_f32_16x16x32_bf16 v[96:99], v[152:155], v[20:23], v[96:99]
    v_mfma_f32_16x16x32_bf16 v[104:107], v[152:155], v[52:55], v[104:107]
    v_add_u32 v1, 4294882816, v1
    ds_read_b128 v[144:147], v1 offset:0
    v_mfma_f32_16x16x32_bf16 v[100:103], v[156:159], v[20:23], v[100:103]
    v_mfma_f32_16x16x32_bf16 v[108:111], v[156:159], v[52:55], v[108:111]
    ds_read_b128 v[148:151], v1 offset:512
    v_mfma_f32_16x16x32_bf16 v[96:99], v[160:163], v[24:27], v[96:99]
    v_exp_f32 v120, v80
    v_exp_f32 v121, v81
    v_exp_f32 v122, v82
    v_mfma_f32_16x16x32_bf16 v[104:107], v[160:163], v[56:59], v[104:107]
    ds_read_b128 v[152:155], v1 offset:64
    v_exp_f32 v123, v83
    v_cvt_pk_bf16_f32 v112, v120, v121
    v_mfma_f32_16x16x32_bf16 v[100:103], v[164:167], v[24:27], v[100:103]
    v_exp_f32 v124, v84
    v_exp_f32 v125, v85
    v_cvt_pk_bf16_f32 v113, v122, v123
    v_mfma_f32_16x16x32_bf16 v[108:111], v[164:167], v[56:59], v[108:111]
    ds_read_b128 v[156:159], v1 offset:576
    v_exp_f32 v126, v86
    v_exp_f32 v127, v87
    v_mfma_f32_16x16x32_bf16 v[96:99], v[168:171], v[28:31], v[96:99]
    v_cvt_pk_bf16_f32 v114, v124, v125
    v_exp_f32 v128, v88
    v_exp_f32 v129, v89
    v_mfma_f32_16x16x32_bf16 v[104:107], v[168:171], v[60:63], v[104:107]
    ds_read_b128 v[160:163], v1 offset:128
    v_cvt_pk_bf16_f32 v115, v126, v127
    v_exp_f32 v130, v90
    v_mfma_f32_16x16x32_bf16 v[100:103], v[172:175], v[28:31], v[100:103]
    v_exp_f32 v131, v91
    v_cvt_pk_bf16_f32 v116, v128, v129
    v_exp_f32 v132, v92
    v_mfma_f32_16x16x32_bf16 v[108:111], v[172:175], v[60:63], v[108:111]
    ds_read_b128 v[164:167], v1 offset:640
    v_exp_f32 v133, v93
    v_cvt_pk_bf16_f32 v117, v130, v131
    s_waitcnt lgkmcnt(12)
    v_mfma_f32_16x16x32_bf16 v[96:99], v[176:179], v[32:35], v[96:99]
    v_exp_f32 v134, v94
    v_exp_f32 v135, v95
    v_cvt_pk_bf16_f32 v118, v132, v133
    v_mfma_f32_16x16x32_bf16 v[104:107], v[176:179], v[64:67], v[104:107]
    ds_read_b128 v[168:171], v1 offset:192
    v_cvt_pk_bf16_f32 v119, v134, v135
    v_or3_b32 v9, v112, v113, v114
    v_mfma_f32_16x16x32_bf16 v[100:103], v[180:183], v[32:35], v[100:103]
    v_or3_b32 v11, v115, v116, v117
    v_or3_b32 v9, v9, v118, v119
    v_or_b32 v9, v9, v11
    v_mfma_f32_16x16x32_bf16 v[108:111], v[180:183], v[64:67], v[108:111]
    ds_read_b128 v[172:175], v1 offset:704
    v_and_b32 v9, s41, v9
    v_cmp_ne_u32 vcc, 0, v9
    s_waitcnt lgkmcnt(12)
    v_mfma_f32_16x16x32_bf16 v[96:99], v[184:187], v[36:39], v[96:99]
    v_mfma_f32_16x16x32_bf16 v[104:107], v[184:187], v[68:71], v[104:107]
    ds_read_b128 v[176:179], v1 offset:256
    s_add_u32 s39, s39, 1
    s_cbranch_vccnz L_stub_sa_7
L_back_sa_7:
    ds_write_b128 v2, v[112:115] offset:0
    v_mfma_f32_16x16x32_bf16 v[100:103], v[188:191], v[36:39], v[100:103]
    ds_write_b128 v2, v[116:119] offset:1024
    v_add_f32 v6, v6, v120
    v_add_f32 v7, v7, v128
    v_mfma_f32_16x16x32_bf16 v[108:111], v[188:191], v[68:71], v[108:111]
    ds_read_b128 v[180:183], v1 offset:768
    v_add_f32 v6, v6, v121
    v_add_f32 v7, v7, v129
    s_waitcnt lgkmcnt(14)
    v_mfma_f32_16x16x32_bf16 v[96:99], v[192:195], v[40:43], v[96:99]
    v_add_f32 v6, v6, v122
    v_add_f32 v7, v7, v130
    v_add_f32 v6, v6, v123
    v_mfma_f32_16x16x32_bf16 v[104:107], v[192:195], v[72:75], v[104:107]
    ds_read_b128 v[184:187], v1 offset:320
    v_add_f32 v7, v7, v131
    v_add_f32 v6, v6, v124
    v_mfma_f32_16x16x32_bf16 v[100:103], v[196:199], v[40:43], v[100:103]
    v_add_f32 v7, v7, v132
    v_add_f32 v6, v6, v125
    v_add_f32 v7, v7, v133
    v_mfma_f32_16x16x32_bf16 v[108:111], v[196:199], v[72:75], v[108:111]
    ds_read_b128 v[188:191], v1 offset:832
    v_add_f32 v6, v6, v126
    v_add_f32 v7, v7, v134
    s_waitcnt lgkmcnt(14)
    v_mfma_f32_16x16x32_bf16 v[96:99], v[200:203], v[44:47], v[96:99]
    v_add_f32 v6, v6, v127
    v_add_f32 v7, v7, v135
    v_mfma_f32_16x16x32_bf16 v[104:107], v[200:203], v[76:79], v[104:107]
    ds_read_b128 v[192:195], v1 offset:384
    v_mfma_f32_16x16x32_bf16 v[100:103], v[204:207], v[44:47], v[100:103]
    v_mfma_f32_16x16x32_bf16 v[108:111], v[204:207], v[76:79], v[108:111]
    ds_read_b128 v[196:199], v1 offset:896
    s_waitcnt lgkmcnt(5)
    s_barrier
    v_mfma_f32_16x16x32_bf16 v[80:83], v[144:147], v[16:19], v[136:139]
    v_mfma_f32_16x16x32_bf16 v[88:91], v[144:147], v[48:51], v[140:143]
    ds_read_b128 v[200:203], v1 offset:448
    v_mfma_f32_16x16x32_bf16 v[84:87], v[148:151], v[16:19], v[136:139]
    v_mfma_f32_16x16x32_bf16 v[92:95], v[148:151], v[48:51], v[140:143]
    ds_read_b128 v[204:207], v1 offset:960
    v_mfma_f32_16x16x32_bf16 v[80:83], v[152:155], v[20:23], v[80:83]
    v_mfma_f32_16x16x32_bf16 v[88:91], v[152:155], v[52:55], v[88:91]
    v_add_u32 v1, 16896, v1
    ds_read_b128 v[144:147], v1 offset:0
    v_mfma_f32_16x16x32_bf16 v[84:87], v[156:159], v[20:23], v[84:87]
    v_mfma_f32_16x16x32_bf16 v[92:95], v[156:159], v[52:55], v[92:95]
    ds_read_b128 v[148:151], v1 offset:512
    v_mfma_f32_16x16x32_bf16 v[80:83], v[160:163], v[24:27], v[80:83]
    v_exp_f32 v120, v96
    v_exp_f32 v121, v97
    v_exp_f32 v122, v98
    v_mfma_f32_16x16x32_bf16 v[88:91], v[160:163], v[56:59], v[88:91]
    ds_read_b128 v[152:155], v1 offset:64
    v_exp_f32 v123, v99
    v_cvt_pk_bf16_f32 v112, v120, v121
    v_mfma_f32_16x16x32_bf16 v[84:87], v[164:167], v[24:27], v[84:87]
    v_exp_f32 v124, v100
    v_exp_f32 v125, v101
    v_cvt_pk_bf16_f32 v113, v122, v123
    v_mfma_f32_16x16x32_bf16 v[92:95], v[164:167], v[56:59], v[92:95]
    ds_read_b128 v[156:159], v1 offset:576
    v_exp_f32 v126, v102
    v_exp_f32 v127, v103
    v_mfma_f32_16x16x32_bf16 v[80:83], v[168:171], v[28:31], v[80:83]
    v_cvt_pk_bf16_f32 v114, v124, v125
    v_exp_f32 v128, v104
    v_exp_f32 v129, v105
    v_mfma_f32_16x16x32_bf16 v[88:91], v[168:171], v[60:63], v[88:91]
    ds_read_b128 v[160:163], v1 offset:128
    v_cvt_pk_bf16_f32 v115, v126, v127
    v_exp_f32 v130, v106
    v_mfma_f32_16x16x32_bf16 v[84:87], v[172:175], v[28:31], v[84:87]
    v_exp_f32 v131, v107
    v_cvt_pk_bf16_f32 v116, v128, v129
    v_exp_f32 v132, v108
    v_mfma_f32_16x16x32_bf16 v[92:95], v[172:175], v[60:63], v[92:95]
    ds_read_b128 v[164:167], v1 offset:640
    v_exp_f32 v133, v109
    v_cvt_pk_bf16_f32 v117, v130, v131
    s_waitcnt lgkmcnt(12)
    v_mfma_f32_16x16x32_bf16 v[80:83], v[176:179], v[32:35], v[80:83]
    v_exp_f32 v134, v110
    v_exp_f32 v135, v111
    v_cvt_pk_bf16_f32 v118, v132, v133
    v_mfma_f32_16x16x32_bf16 v[88:91], v[176:179], v[64:67], v[88:91]
    ds_read_b128 v[168:171], v1 offset:192
    v_cvt_pk_bf16_f32 v119, v134, v135
    v_or3_b32 v9, v112, v113, v114
    v_mfma_f32_16x16x32_bf16 v[84:87], v[180:183], v[32:35], v[84:87]
    v_or3_b32 v11, v115, v116, v117
    v_or3_b32 v9, v9, v118, v119
    v_or_b32 v9, v9, v11
    v_mfma_f32_16x16x32_bf16 v[92:95], v[180:183], v[64:67], v[92:95]
    ds_read_b128 v[172:175], v1 offset:704
    v_and_b32 v9, s41, v9
    v_cmp_ne_u32 vcc, 0, v9
    s_waitcnt lgkmcnt(12)
    v_mfma_f32_16x16x32_bf16 v[80:83], v[184:187], v[36:39], v[80:83]
    v_mfma_f32_16x16x32_bf16 v[88:91], v[184:187], v[68:71], v[88:91]
    ds_read_b128 v[176:179], v1 offset:256
    s_add_u32 s39, s39, 1
    s_cbranch_vccnz L_stub_sa_8
L_back_sa_8:
    ds_write_b128 v2, v[112:115] offset:7168
    v_mfma_f32_16x16x32_bf16 v[84:87], v[188:191], v[36:39], v[84:87]
    ds_write_b128 v2, v[116:119] offset:8192
    v_add_f32 v6, v6, v120
    v_add_f32 v7, v7, v128
    v_mfma_f32_16x16x32_bf16 v[92:95], v[188:191], v[68:71], v[92:95]
    ds_read_b128 v[180:183], v1 offset:768
    v_add_f32 v6, v6, v121
    v_add_f32 v7, v7, v129
    s_waitcnt lgkmcnt(14)
    v_mfma_f32_16x16x32_bf16 v[80:83], v[192:195], v[40:43], v[80:83]
    v_add_f32 v6, v6, v122
    v_add_f32 v7, v7, v130
    v_add_f32 v6, v6, v123
    v_mfma_f32_16x16x32_bf16 v[88:91], v[192:195], v[72:75], v[88:91]
    ds_read_b128 v[184:187], v1 offset:320
    v_add_f32 v7, v7, v131
    v_add_f32 v6, v6, v124
    v_mfma_f32_16x16x32_bf16 v[84:87], v[196:199], v[40:43], v[84:87]
    v_add_f32 v7, v7, v132
    v_add_f32 v6, v6, v125
    v_add_f32 v7, v7, v133
    v_mfma_f32_16x16x32_bf16 v[92:95], v[196:199], v[72:75], v[92:95]
    ds_read_b128 v[188:191], v1 offset:832
    v_add_f32 v6, v6, v126
    v_add_f32 v7, v7, v134
    s_waitcnt lgkmcnt(14)
    v_mfma_f32_16x16x32_bf16 v[80:83], v[200:203], v[44:47], v[80:83]
    v_add_f32 v6, v6, v127
    v_add_f32 v7, v7, v135
    v_mfma_f32_16x16x32_bf16 v[88:91], v[200:203], v[76:79], v[88:91]
    ds_read_b128 v[192:195], v1 offset:384
    v_mfma_f32_16x16x32_bf16 v[84:87], v[204:207], v[44:47], v[84:87]
    v_mfma_f32_16x16x32_bf16 v[92:95], v[204:207], v[76:79], v[92:95]
    ds_read_b128 v[196:199], v1 offset:896
    s_waitcnt lgkmcnt(5)
    s_barrier
    s_sub_u32 s38, s38, 1
    s_cmp_lg_u32 s38, 0
    s_cbranch_scc1 L_sloopa
    v_mfma_f32_16x16x32_bf16 v[96:99], v[144:147], v[16:19], v[136:139]
    v_mfma_f32_16x16x32_bf16 v[104:107], v[144:147], v[48:51], v[140:143]
    ds_read_b128 v[200:203], v1 offset:448
    v_mfma_f32_16x16x32_bf16 v[100:103], v[148:151], v[16:19], v[136:139]
    v_mfma_f32_16x16x32_bf16 v[108:111], v[148:151], v[48:51], v[140:143]
    ds_read_b128 v[204:207], v1 offset:960
    v_mfma_f32_16x16x32_bf16 v[96:99], v[152:155], v[20:23], v[96:99]
    v_mfma_f32_16x16x32_bf16 v[104:107], v[152:155], v[52:55], v[104:107]
    v_add_u32 v1, 33792, v1
    ds_read_b128 v[144:147], v1 offset:0
    v_mfma_f32_16x16x32_bf16 v[100:103], v[156:159], v[20:23], v[100:103]
    v_mfma_f32_16x16x32_bf16 v[108:111], v[156:159], v[52:55], v[108:111]
    ds_read_b128 v[148:151], v1 offset:512
    v_mfma_f32_16x16x32_bf16 v[96:99], v[160:163], v[24:27], v[96:99]
    v_exp_f32 v120, v80
    v_exp_f32 v121, v81
    v_exp_f32 v122, v82
    v_mfma_f32_16x16x32_bf16 v[104:107], v[160:163], v[56:59], v[104:107]
    ds_read_b128 v[152:155], v1 offset:64
    v_exp_f32 v123, v83
    v_cvt_pk_bf16_f32 v112, v120, v121
    v_mfma_f32_16x16x32_bf16 v[100:103], v[164:167], v[24:27], v[100:103]
    v_exp_f32 v124, v84
    v_exp_f32 v125, v85
    v_cvt_pk_bf16_f32 v113, v122, v123
    v_mfma_f32_16x16x32_bf16 v[108:111], v[164:167], v[56:59], v[108:111]
    ds_read_b128 v[156:159], v1 offset:576
    v_exp_f32 v126, v86
    v_exp_f32 v127, v87
    v_mfma_f32_16x16x32_bf16 v[96:99], v[168:171], v[28:31], v[96:99]
    v_cvt_pk_bf16_f32 v114, v124, v125
    v_exp_f32 v128, v88
    v_exp_f32 v129, v89
    v_mfma_f32_16x16x32_bf16 v[104:107], v[168:171], v[60:63], v[104:107]
    ds_read_b128 v[160:163], v1 offset:128
    v_cvt_pk_bf16_f32 v115, v126, v127
    v_exp_f32 v130, v90
    v_mfma_f32_16x16x32_bf16 v[100:103], v[172:175], v[28:31], v[100:103]
    v_exp_f32 v131, v91
    v_cvt_pk_bf16_f32 v116, v128, v129
    v_exp_f32 v132, v92
    v_mfma_f32_16x16x32_bf16 v[108:111], v[172:175], v[60:63], v[108:111]
    ds_read_b128 v[164:167], v1 offset:640
    v_exp_f32 v133, v93
    v_cvt_pk_bf16_f32 v117, v130, v131
    s_waitcnt lgkmcnt(12)
    v_mfma_f32_16x16x32_bf16 v[96:99], v[176:179], v[32:35], v[96:99]
    v_exp_f32 v134, v94
    v_exp_f32 v135, v95
    v_cvt_pk_bf16_f32 v118, v132, v133
    v_mfma_f32_16x16x32_bf16 v[104:107], v[176:179], v[64:67], v[104:107]
    ds_read_b128 v[168:171], v1 offset:192
    v_cvt_pk_bf16_f32 v119, v134, v135
    v_or3_b32 v9, v112, v113, v114
    v_mfma_f32_16x16x32_bf16 v[100:103], v[180:183], v[32:35], v[100:103]
    v_or3_b32 v11, v115, v116, v117
    v_or3_b32 v9, v9, v118, v119
    v_or_b32 v9, v9, v11
    v_mfma_f32_16x16x32_bf16 v[108:111], v[180:183], v[64:67], v[108:111]
    ds_read_b128 v[172:175], v1 offset:704
    v_and_b32 v9, s41, v9
    v_cmp_ne_u32 vcc, 0, v9
    s_waitcnt lgkmcnt(12)
    v_mfma_f32_16x16x32_bf16 v[96:99], v[184:187], v[36:39], v[96:99]
    v_mfma_f32_16x16x32_bf16 v[104:107], v[184:187], v[68:71], v[104:107]
    ds_read_b128 v[176:179], v1 offset:256
    s_add_u32 s39, s39, 1
    s_cbranch_vccnz L_stub_sa_61
L_back_sa_61:
    ds_write_b128 v2, v[112:115] offset:0
    v_mfma_f32_16x16x32_bf16 v[100:103], v[188:191], v[36:39], v[100:103]
    ds_write_b128 v2, v[116:119] offset:1024
    v_add_f32 v6, v6, v120
    v_add_f32 v7, v7, v128
    v_mfma_f32_16x16x32_bf16 v[108:111], v[188:191], v[68:71], v[108:111]
    ds_read_b128 v[180:183], v1 offset:768
    v_add_f32 v6, v6, v121
    v_add_f32 v7, v7, v129
    s_waitcnt lgkmcnt(14)
    v_mfma_f32_16x16x32_bf16 v[96:99], v[192:195], v[40:43], v[96:99]
    v_add_f32 v6, v6, v122
    v_add_f32 v7, v7, v130
    v_add_f32 v6, v6, v123
    v_mfma_f32_16x16x32_bf16 v[104:107], v[192:195], v[72:75], v[104:107]
    ds_read_b128 v[184:187], v1 offset:320
    v_add_f32 v7, v7, v131
    v_add_f32 v6, v6, v124
    v_mfma_f32_16x16x32_bf16 v[100:103], v[196:199], v[40:43], v[100:103]
    v_add_f32 v7, v7, v132
    v_add_f32 v6, v6, v125
    v_add_f32 v7, v7, v133
    v_mfma_f32_16x16x32_bf16 v[108:111], v[196:199], v[72:75], v[108:111]
    ds_read_b128 v[188:191], v1 offset:832
    v_add_f32 v6, v6, v126
    v_add_f32 v7, v7, v134
    s_waitcnt lgkmcnt(14)
    v_mfma_f32_16x16x32_bf16 v[96:99], v[200:203], v[44:47], v[96:99]
    v_add_f32 v6, v6, v127
    v_add_f32 v7, v7, v135
    v_mfma_f32_16x16x32_bf16 v[104:107], v[200:203], v[76:79], v[104:107]
    ds_read_b128 v[192:195], v1 offset:384
    v_mfma_f32_16x16x32_bf16 v[100:103], v[204:207], v[44:47], v[100:103]
    v_mfma_f32_16x16x32_bf16 v[108:111], v[204:207], v[76:79], v[108:111]
    ds_read_b128 v[196:199], v1 offset:896
    s_waitcnt lgkmcnt(5)
    s_barrier
    v_mfma_f32_16x16x32_bf16 v[80:83], v[144:147], v[16:19], v[136:139]
    v_mfma_f32_16x16x32_bf16 v[88:91], v[144:147], v[48:51], v[140:143]
    ds_read_b128 v[200:203], v1 offset:448
    v_mfma_f32_16x16x32_bf16 v[84:87], v[148:151], v[16:19], v[136:139]
    v_mfma_f32_16x16x32_bf16 v[92:95], v[148:151], v[48:51], v[140:143]
    ds_read_b128 v[204:207], v1 offset:960
    v_mfma_f32_16x16x32_bf16 v[80:83], v[152:155], v[20:23], v[80:83]
    v_mfma_f32_16x16x32_bf16 v[88:91], v[152:155], v[52:55], v[88:91]
    v_add_u32 v1, 33792, v1
    ds_read_b128 v[144:147], v1 offset:0
    v_mfma_f32_16x16x32_bf16 v[84:87], v[156:159], v[20:23], v[84:87]
    v_mfma_f32_16x16x32_bf16 v[92:95], v[156:159], v[52:55], v[92:95]
    ds_read_b128 v[148:151], v1 offset:512
    v_mfma_f32_16x16x32_bf16 v[80:83], v[160:163], v[24:27], v[80:83]
    v_exp_f32 v120, v96
    v_exp_f32 v121, v97
    v_exp_f32 v122, v98
    v_mfma_f32_16x16x32_bf16 v[88:91], v[160:163], v[56:59], v[88:91]
    ds_read_b128 v[152:155], v1 offset:64
    v_exp_f32 v123, v99
    v_cvt_pk_bf16_f32 v112, v120, v121
    v_mfma_f32_16x16x32_bf16 v[84:87], v[164:167], v[24:27], v[84:87]
    v_exp_f32 v124, v100
    v_exp_f32 v125, v101
    v_cvt_pk_bf16_f32 v113, v122, v123
    v_mfma_f32_16x16x32_bf16 v[92:95], v[164:167], v[56:59], v[92:95]
    ds_read_b128 v[156:159], v1 offset:576
    v_exp_f32 v126, v102
    v_exp_f32 v127, v103
    v_mfma_f32_16x16x32_bf16 v[80:83], v[168:171], v[28:31], v[80:83]
    v_cvt_pk_bf16_f32 v114, v124, v125
    v_exp_f32 v128, v104
    v_exp_f32 v129, v105
    v_mfma_f32_16x16x32_bf16 v[88:91], v[168:171], v[60:63], v[88:91]
    ds_read_b128 v[160:163], v1 offset:128
    v_cvt_pk_bf16_f32 v115, v126, v127
    v_exp_f32 v130, v106
    v_mfma_f32_16x16x32_bf16 v[84:87], v[172:175], v[28:31], v[84:87]
    v_exp_f32 v131, v107
    v_cvt_pk_bf16_f32 v116, v128, v129
    v_exp_f32 v132, v108
    v_mfma_f32_16x16x32_bf16 v[92:95], v[172:175], v[60:63], v[92:95]
    ds_read_b128 v[164:167], v1 offset:640
    v_exp_f32 v133, v109
    v_cvt_pk_bf16_f32 v117, v130, v131
    s_waitcnt lgkmcnt(12)
    v_mfma_f32_16x16x32_bf16 v[80:83], v[176:179], v[32:35], v[80:83]
    v_exp_f32 v134, v110
    v_exp_f32 v135, v111
    v_cvt_pk_bf16_f32 v118, v132, v133
    v_mfma_f32_16x16x32_bf16 v[88:91], v[176:179], v[64:67], v[88:91]
    ds_read_b128 v[168:171], v1 offset:192
    v_cvt_pk_bf16_f32 v119, v134, v135
    v_or3_b32 v9, v112, v113, v114
    v_mfma_f32_16x16x32_bf16 v[84:87], v[180:183], v[32:35], v[84:87]
    v_or3_b32 v11, v115, v116, v117
    v_or3_b32 v9, v9, v118, v119
    v_or_b32 v9, v9, v11
    v_mfma_f32_16x16x32_bf16 v[92:95], v[180:183], v[64:67], v[92:95]
    ds_read_b128 v[172:175], v1 offset:704
    v_and_b32 v9, s41, v9
    v_cmp_ne_u32 vcc, 0, v9
    s_waitcnt lgkmcnt(12)
    v_mfma_f32_16x16x32_bf16 v[80:83], v[184:187], v[36:39], v[80:83]
    v_mfma_f32_16x16x32_bf16 v[88:91], v[184:187], v[68:71], v[88:91]
    ds_read_b128 v[176:179], v1 offset:256
    s_add_u32 s39, s39, 1
    s_cbranch_vccnz L_stub_sa_62
L_back_sa_62:
    ds_write_b128 v2, v[112:115] offset:7168
    v_mfma_f32_16x16x32_bf16 v[84:87], v[188:191], v[36:39], v[84:87]
    ds_write_b128 v2, v[116:119] offset:8192
    v_add_f32 v6, v6, v120
    v_add_f32 v7, v7, v128
    v_mfma_f32_16x16x32_bf16 v[92:95], v[188:191], v[68:71], v[92:95]
    ds_read_b128 v[180:183], v1 offset:768
    v_add_f32 v6, v6, v121
    v_add_f32 v7, v7, v129
    s_waitcnt lgkmcnt(14)
    v_mfma_f32_16x16x32_bf16 v[80:83], v[192:195], v[40:43], v[80:83]
    v_add_f32 v6, v6, v122
    v_add_f32 v7, v7, v130
    v_add_f32 v6, v6, v123
    v_mfma_f32_16x16x32_bf16 v[88:91], v[192:195], v[72:75], v[88:91]
    ds_read_b128 v[184:187], v1 offset:320
    v_add_f32 v7, v7, v131
    v_add_f32 v6, v6, v124
    v_mfma_f32_16x16x32_bf16 v[84:87], v[196:199], v[40:43], v[84:87]
    v_add_f32 v7, v7, v132
    v_add_f32 v6, v6, v125
    v_add_f32 v7, v7, v133
    v_mfma_f32_16x16x32_bf16 v[92:95], v[196:199], v[72:75], v[92:95]
    ds_read_b128 v[188:191], v1 offset:832
    v_add_f32 v6, v6, v126
    v_add_f32 v7, v7, v134
    s_waitcnt lgkmcnt(14)
    v_mfma_f32_16x16x32_bf16 v[80:83], v[200:203], v[44:47], v[80:83]
    v_add_f32 v6, v6, v127
    v_add_f32 v7, v7, v135
    v_mfma_f32_16x16x32_bf16 v[88:91], v[200:203], v[76:79], v[88:91]
    ds_read_b128 v[192:195], v1 offset:384
    v_mfma_f32_16x16x32_bf16 v[84:87], v[204:207], v[44:47], v[84:87]
    v_mfma_f32_16x16x32_bf16 v[92:95], v[204:207], v[76:79], v[92:95]
    ds_read_b128 v[196:199], v1 offset:896
    s_waitcnt lgkmcnt(5)
    s_barrier
    v_mfma_f32_16x16x32_bf16 v[96:99], v[144:147], v[16:19], v[136:139]
    v_mfma_f32_16x16x32_bf16 v[104:107], v[144:147], v[48:51], v[140:143]
    ds_read_b128 v[200:203], v1 offset:448
    v_mfma_f32_16x16x32_bf16 v[100:103], v[148:151], v[16:19], v[136:139]
    v_mfma_f32_16x16x32_bf16 v[108:111], v[148:151], v[48:51], v[140:143]
    ds_read_b128 v[204:207], v1 offset:960
    v_mfma_f32_16x16x32_bf16 v[96:99], v[152:155], v[20:23], v[96:99]
    v_mfma_f32_16x16x32_bf16 v[104:107], v[152:155], v[52:55], v[104:107]
    v_mfma_f32_16x16x32_bf16 v[100:103], v[156:159], v[20:23], v[100:103]
    v_mfma_f32_16x16x32_bf16 v[108:111], v[156:159], v[52:55], v[108:111]
    v_mfma_f32_16x16x32_bf16 v[96:99], v[160:163], v[24:27], v[96:99]
    v_exp_f32 v120, v80
    v_exp_f32 v121, v81
    v_exp_f32 v122, v82
    v_mfma_f32_16x16x32_bf16 v[104:107], v[160:163], v[56:59], v[104:107]
    v_exp_f32 v123, v83
    v_cvt_pk_bf16_f32 v112, v120, v121
    v_mfma_f32_16x16x32_bf16 v[100:103], v[164:167], v[24:27], v[100:103]
    v_exp_f32 v124, v84
    v_exp_f32 v125, v85
    v_cvt_pk_bf16_f32 v113, v122, v123
    v_mfma_f32_16x16x32_bf16 v[108:111], v[164:167], v[56:59], v[108:111]
    v_exp_f32 v126, v86
    v_exp_f32 v127, v87
    v_mfma_f32_16x16x32_bf16 v[96:99], v[168:171], v[28:31], v[96:99]
    v_cvt_pk_bf16_f32 v114, v124, v125
    v_exp_f32 v128, v88
    v_exp_f32 v129, v89
    v_mfma_f32_16x16x32_bf16 v[104:107], v[168:171], v[60:63], v[104:107]
    v_cvt_pk_bf16_f32 v115, v126, v127
    v_exp_f32 v130, v90
    v_mfma_f32_16x16x32_bf16 v[100:103], v[172:175], v[28:31], v[100:103]
    v_exp_f32 v131, v91
    v_cvt_pk_bf16_f32 v116, v128, v129
    v_exp_f32 v132, v92
    v_mfma_f32_16x16x32_bf16 v[108:111], v[172:175], v[60:63], v[108:111]
    v_exp_f32 v133, v93
    v_cvt_pk_bf16_f32 v117, v130, v131
    s_waitcnt lgkmcnt(6)
    v_mfma_f32_16x16x32_bf16 v[96:99], v[176:179], v[32:35], v[96:99]
    v_exp_f32 v134, v94
    v_exp_f32 v135, v95
    v_cvt_pk_bf16_f32 v118, v132, v133
    v_mfma_f32_16x16x32_bf16 v[104:107], v[176:179], v[64:67], v[104:107]
    v_cvt_pk_bf16_f32 v119, v134, v135
    v_or3_b32 v9, v112, v113, v114
    v_mfma_f32_16x16x32_bf16 v[100:103], v[180:183], v[32:35], v[100:103]
    v_or3_b32 v11, v115, v116, v117
    v_or3_b32 v9, v9, v118, v119
    v_or_b32 v9, v9, v11
    v_mfma_f32_16x16x32_bf16 v[108:111], v[180:183], v[64:67], v[108:111]
    v_and_b32 v9, s41, v9
    v_cmp_ne_u32 vcc, 0, v9
    s_waitcnt lgkmcnt(4)
    v_mfma_f32_16x16x32_bf16 v[96:99], v[184:187], v[36:39], v[96:99]
    v_mfma_f32_16x16x32_bf16 v[104:107], v[184:187], v[68:71], v[104:107]
    s_add_u32 s39, s39, 1
    s_cbranch_vccnz L_stub_sa_63
L_back_sa_63:
    ds_write_b128 v2, v[112:115] offset:0
    v_mfma_f32_16x16x32_bf16 v[100:103], v[188:191], v[36:39], v[100:103]
    ds_write_b128 v2, v[116:119] offset:1024
    v_add_f32 v6, v6, v120
    v_add_f32 v7, v7, v128
    v_mfma_f32_16x16x32_bf16 v[108:111], v[188:191], v[68:71], v[108:111]
    v_add_f32 v6, v6, v121
    v_add_f32 v7, v7, v129
    s_waitcnt lgkmcnt(4)
    v_mfma_f32_16x16x32_bf16 v[96:99], v[192:195], v[40:43], v[96:99]
    v_add_f32 v6, v6, v122
    v_add_f32 v7, v7, v130
    v_add_f32 v6, v6, v123
    v_mfma_f32_16x16x32_bf16 v[104:107], v[192:195], v[72:75], v[104:107]
    v_add_f32 v7, v7, v131
    v_add_f32 v6, v6, v124
    v_mfma_f32_16x16x32_bf16 v[100:103], v[196:199], v[40:43], v[100:103]
    v_add_f32 v7, v7, v132
    v_add_f32 v6, v6, v125
    v_add_f32 v7, v7, v133
    v_mfma_f32_16x16x32_bf16 v[108:111], v[196:199], v[72:75], v[108:111]
    v_add_f32 v6, v6, v126
    v_add_f32 v7, v7, v134
    s_waitcnt lgkmcnt(2)
    v_mfma_f32_16x16x32_bf16 v[96:99], v[200:203], v[44:47], v[96:99]
    v_add_f32 v6, v6, v127
    v_add_f32 v7, v7, v135
    v_mfma_f32_16x16x32_bf16 v[104:107], v[200:203], v[76:79], v[104:107]
    v_mfma_f32_16x16x32_bf16 v[100:103], v[204:207], v[44:47], v[100:103]
    v_mfma_f32_16x16x32_bf16 v[108:111], v[204:207], v[76:79], v[108:111]
    s_waitcnt lgkmcnt(0)
    s_nop 7
    s_barrier
    v_exp_f32 v120, v96
    v_exp_f32 v121, v97
    v_exp_f32 v122, v98
    v_exp_f32 v123, v99
    v_cvt_pk_bf16_f32 v112, v120, v121
    v_exp_f32 v124, v100
    v_exp_f32 v125, v101
    v_cvt_pk_bf16_f32 v113, v122, v123
    v_exp_f32 v126, v102
    v_exp_f32 v127, v103
    v_cvt_pk_bf16_f32 v114, v124, v125
    v_exp_f32 v128, v104
    v_exp_f32 v129, v105
    v_cvt_pk_bf16_f32 v115, v126, v127
    v_exp_f32 v130, v106
    v_exp_f32 v131, v107
    v_cvt_pk_bf16_f32 v116, v128, v129
    v_exp_f32 v132, v108
    v_exp_f32 v133, v109
    v_cvt_pk_bf16_f32 v117, v130, v131
    v_exp_f32 v134, v110
    v_exp_f32 v135, v111
    v_cvt_pk_bf16_f32 v118, v132, v133
    v_cvt_pk_bf16_f32 v119, v134, v135
    v_or3_b32 v9, v112, v113, v114
    v_or3_b32 v11, v115, v116, v117
    v_or3_b32 v9, v9, v118, v119
    v_or_b32 v9, v9, v11
    v_and_b32 v9, s41, v9
    v_cmp_ne_u32 vcc, 0, v9
    s_add_u32 s39, s39, 1
    s_cbranch_vccnz L_stub_sa_64
L_back_sa_64:
    ds_write_b128 v2, v[112:115] offset:7168
    ds_write_b128 v2, v[116:119] offset:8192
    v_add_f32 v6, v6, v120
    v_add_f32 v7, v7, v128
    v_add_f32 v6, v6, v121
    v_add_f32 v7, v7, v129
    v_add_f32 v6, v6, v122
    v_add_f32 v7, v7, v130
    v_add_f32 v6, v6, v123
    v_add_f32 v7, v7, v131
    v_add_f32 v6, v6, v124
    v_add_f32 v7, v7, v132
    v_add_f32 v6, v6, v125
    v_add_f32 v7, v7, v133
    v_add_f32 v6, v6, v126
    v_add_f32 v7, v7, v134
    v_add_f32 v6, v6, v127
    v_add_f32 v7, v7, v135
    v_mov_b32 v9, v6
    v_mov_b32 v10, v7
    s_nop 1
    v_permlane16_swap_b32 v6, v9
    v_permlane16_swap_b32 v7, v10
    v_add_f32 v6, v6, v9
    v_add_f32 v7, v7, v10
    v_mov_b32 v9, v6
    v_mov_b32 v10, v7
    s_nop 1
    v_permlane32_swap_b32 v6, v9
    v_permlane32_swap_b32 v7, v10
    v_add_f32 v6, v6, v9
    v_add_f32 v7, v7, v10
    v_rcp_f32 v6, v6
    v_rcp_f32 v7, v7
    s_nop 0
    ds_write_b32 v3, v6 offset:1024
    ds_write_b32 v3, v7 offset:1088
    s_waitcnt lgkmcnt(0)
    s_barrier
    s_branch L_sjoin
L_swave3:
    v_lshlrev_b32 v2, 4, v0
    v_add_u32 v9, 152064, v2
    v_and_b32 v1, 15, v0
    v_mul_u32_u24 v1, 1056, v1
    v_lshrrev_b32 v11, 4, v0
    v_lshl_add_u32 v1, v11, 4, v1
    s_lshl_b32 s42, s33, 11
    v_add_u32 v2, s42, v2
    v_and_b32 v3, 15, v0
    v_lshlrev_b32 v3, 2, v3
    s_lshl_b32 s42, s33, 7
    s_add_u32 s42, s42, 160512
    v_add_u32 v3, s42, v3
    v_mov_b32 v6, 0
    v_mov_b32 v136, 0
    v_mov_b32 v137, 0
    v_mov_b32 v138, 0
    v_mov_b32 v139, 0
    s_mov_b32 s41, 0x40004000
    s_mov_b32 s36, 32768
    s_setprio 1
    s_waitcnt lgkmcnt(0)
    s_waitcnt vmcnt(2)
    s_barrier
    ds_read_b128 v[16:19], v9 offset:0
    ds_read_b128 v[20:23], v9 offset:1024
    v_add_u32 v1, 50688, v1
    ds_read_b128 v[144:147], v1 offset:0
    ds_read_b128 v[148:151], v1 offset:512
    ds_read_b128 v[152:155], v1 offset:64
    ds_read_b128 v[156:159], v1 offset:576
    ds_read_b128 v[160:163], v1 offset:128
    ds_read_b128 v[164:167], v1 offset:640
    ds_read_b128 v[168:171], v1 offset:192
    ds_read_b128 v[172:175], v1 offset:704
    ds_read_b128 v[176:179], v1 offset:256
    ds_read_b128 v[180:183], v1 offset:768
    ds_read_b128 v[184:187], v1 offset:320
    ds_read_b128 v[188:191], v1 offset:832
    ds_read_b128 v[192:195], v1 offset:384
    ds_read_b128 v[196:199], v1 offset:896
    ds_read_b128 v[24:27], v9 offset:2048
    ds_read_b128 v[28:31], v9 offset:3072
    ds_read_b128 v[32:35], v9 offset:4096
    ds_read_b128 v[36:39], v9 offset:5120
    ds_read_b128 v[40:43], v9 offset:6144
    ds_read_b128 v[44:47], v9 offset:7168
    s_waitcnt lgkmcnt(15)
    v_mfma_f32_16x16x32_bf16 v[80:83], v[144:147], v[16:19], v[136:139]
    ds_read_b128 v[200:203], v1 offset:448
    s_mov_b32 m0, 101376
    s_nop 0
    buffer_load_dwordx4 v8, s[16:19], s36 offen offset:0 nt lds
    s_mov_b32 m0, 101920
    s_nop 0
    buffer_load_dwordx4 v8, s[16:19], s36 offen offset:512 nt lds
    v_mfma_f32_16x16x32_bf16 v[84:87], v[148:151], v[16:19], v[136:139]
    ds_read_b128 v[204:207], v1 offset:960
    s_mov_b32 m0, 102464
    s_nop 0
    buffer_load_dwordx4 v8, s[16:19], s36 offen offset:1024 nt lds
    s_mov_b32 m0, 103008
    s_nop 0
    buffer_load_dwordx4 v8, s[16:19], s36 offen offset:1536 nt lds
    v_mfma_f32_16x16x32_bf16 v[80:83], v[152:155], v[20:23], v[80:83]
    v_add_u32 v1, 16896, v1
    ds_read_b128 v[144:147], v1 offset:0
    s_mov_b32 m0, 103552
    s_nop 0
    buffer_load_dwordx4 v8, s[16:19], s36 offen offset:2048 nt lds
    s_mov_b32 m0, 104096
    s_nop 0
    buffer_load_dwordx4 v8, s[16:19], s36 offen offset:2560 nt lds
    v_mfma_f32_16x16x32_bf16 v[84:87], v[156:159], v[20:23], v[84:87]
    ds_read_b128 v[148:151], v1 offset:512
    s_mov_b32 m0, 104640
    s_nop 0
    buffer_load_dwordx4 v8, s[16:19], s36 offen offset:3072 nt lds
    s_mov_b32 m0, 105184
    s_nop 0
    buffer_load_dwordx4 v8, s[16:19], s36 offen offset:3584 nt lds
    s_waitcnt lgkmcnt(9)
    v_mfma_f32_16x16x32_bf16 v[80:83], v[160:163], v[24:27], v[80:83]
    ds_read_b128 v[152:155], v1 offset:64
    s_add_u32 s36, s36, 4096
    s_mov_b32 m0, 109824
    s_nop 0
    buffer_load_dwordx4 v8, s[16:19], s36 offen offset:0 nt lds
    s_mov_b32 m0, 110368
    s_nop 0
    buffer_load_dwordx4 v8, s[16:19], s36 offen offset:512 nt lds
    v_mfma_f32_16x16x32_bf16 v[84:87], v[164:167], v[24:27], v[84:87]
    ds_read_b128 v[156:159], v1 offset:576
    s_mov_b32 m0, 110912
    s_nop 0
    buffer_load_dwordx4 v8, s[16:19], s36 offen offset:1024 nt lds
    s_mov_b32 m0, 111456
    s_nop 0
    buffer_load_dwordx4 v8, s[16:19], s36 offen offset:1536 nt lds
    s_waitcnt lgkmcnt(10)
    v_mfma_f32_16x16x32_bf16 v[80:83], v[168:171], v[28:31], v[80:83]
    ds_read_b128 v[160:163], v1 offset:128
    s_mov_b32 m0, 112000
    s_nop 0
    buffer_load_dwordx4 v8, s[16:19], s36 offen offset:2048 nt lds
    s_mov_b32 m0, 112544
    s_nop 0
    buffer_load_dwordx4 v8, s[16:19], s36 offen offset:2560 nt lds
    v_mfma_f32_16x16x32_bf16 v[84:87], v[172:175], v[28:31], v[84:87]
    ds_read_b128 v[164:167], v1 offset:640
    s_mov_b32 m0, 113088
    s_nop 0
    buffer_load_dwordx4 v8, s[16:19], s36 offen offset:3072 nt lds
    s_mov_b32 m0, 113632
    s_nop 0
    buffer_load_dwordx4 v8, s[16:19], s36 offen offset:3584 nt lds
    s_add_u32 s36, s36, 12288
    s_waitcnt lgkmcnt(11)
    v_mfma_f32_16x16x32_bf16 v[80:83], v[176:179], v[32:35], v[80:83]
    ds_read_b128 v[168:171], v1 offset:192
    s_mov_b32 m0, 135168
    s_nop 0
    buffer_load_dwordx4 v8, s[16:19], s36 offen offset:0 nt lds
    s_mov_b32 m0, 135712
    s_nop 0
    buffer_load_dwordx4 v8, s[16:19], s36 offen offset:512 nt lds
    v_mfma_f32_16x16x32_bf16 v[84:87], v[180:183], v[32:35], v[84:87]
    ds_read_b128 v[172:175], v1 offset:704
    s_mov_b32 m0, 136256
    s_nop 0
    buffer_load_dwordx4 v8, s[16:19], s36 offen offset:1024 nt lds
    s_mov_b32 m0, 136800
    s_nop 0
    buffer_load_dwordx4 v8, s[16:19], s36 offen offset:1536 nt lds
    s_waitcnt lgkmcnt(12)
    v_mfma_f32_16x16x32_bf16 v[80:83], v[184:187], v[36:39], v[80:83]
    ds_read_b128 v[176:179], v1 offset:256
    s_mov_b32 m0, 137344
    s_nop 0
    buffer_load_dwordx4 v8, s[16:19], s36 offen offset:2048 nt lds
    s_mov_b32 m0, 137888
    s_nop 0
    buffer_load_dwordx4 v8, s[16:19], s36 offen offset:2560 nt lds
    v_mfma_f32_16x16x32_bf16 v[84:87], v[188:191], v[36:39], v[84:87]
    ds_read_b128 v[180:183], v1 offset:768
    s_mov_b32 m0, 138432
    s_nop 0
    buffer_load_dwordx4 v8, s[16:19], s36 offen offset:3072 nt lds
    s_mov_b32 m0, 138976
    s_nop 0
    buffer_load_dwordx4 v8, s[16:19], s36 offen offset:3584 nt lds
    s_waitcnt lgkmcnt(13)
    v_mfma_f32_16x16x32_bf16 v[80:83], v[192:195], v[40:43], v[80:83]
    ds_read_b128 v[184:187], v1 offset:320
    s_add_u32 s36, s36, 4096
    s_mov_b32 m0, 143616
    s_nop 0
    buffer_load_dwordx4 v8, s[16:19], s36 offen offset:0 nt lds
    s_mov_b32 m0, 144160
    s_nop 0
    buffer_load_dwordx4 v8, s[16:19], s36 offen offset:512 nt lds
    v_mfma_f32_16x16x32_bf16 v[84:87], v[196:199], v[40:43], v[84:87]
    ds_read_b128 v[188:191], v1 offset:832
    s_mov_b32 m0, 144704
    s_nop 0
    buffer_load_dwordx4 v8, s[16:19], s36 offen offset:1024 nt lds
    s_mov_b32 m0, 145248
    s_nop 0
    buffer_load_dwordx4 v8, s[16:19], s36 offen offset:1536 nt lds
    s_waitcnt lgkmcnt(12)
    v_mfma_f32_16x16x32_bf16 v[80:83], v[200:203], v[44:47], v[80:83]
    ds_read_b128 v[192:195], v1 offset:384
    s_mov_b32 m0, 145792
    s_nop 0
    buffer_load_dwordx4 v8, s[16:19], s36 offen offset:2048 nt lds
    s_mov_b32 m0, 146336
    s_nop 0
    buffer_load_dwordx4 v8, s[16:19], s36 offen offset:2560 nt lds
    v_mfma_f32_16x16x32_bf16 v[84:87], v[204:207], v[44:47], v[84:87]
    ds_read_b128 v[196:199], v1 offset:896
    s_mov_b32 m0, 146880
    s_nop 0
    buffer_load_dwordx4 v8, s[16:19], s36 offen offset:3072 nt lds
    s_mov_b32 m0, 147424
    s_nop 0
    buffer_load_dwordx4 v8, s[16:19], s36 offen offset:3584 nt lds
    s_add_u32 s36, s36, 12288
    s_waitcnt vmcnt(32)
    s_barrier
    s_waitcnt lgkmcnt(12)
    v_mfma_f32_16x16x32_bf16 v[96:99], v[144:147], v[16:19], v[136:139]
    ds_read_b128 v[200:203], v1 offset:448
    s_mov_b32 m0, 50688
    s_nop 0
    buffer_load_dwordx4 v8, s[16:19], s36 offen offset:0 nt lds
    v_mfma_f32_16x16x32_bf16 v[100:103], v[148:151], v[16:19], v[136:139]
    ds_read_b128 v[204:207], v1 offset:960
    s_mov_b32 m0, 51232
    s_nop 0
    buffer_load_dwordx4 v8, s[16:19], s36 offen offset:512 nt lds
    s_waitcnt lgkmcnt(12)
    v_mfma_f32_16x16x32_bf16 v[96:99], v[152:155], v[20:23], v[96:99]
    s_mov_b32 m0, 51776
    s_nop 0
    buffer_load_dwordx4 v8, s[16:19], s36 offen offset:1024 nt lds
    v_mfma_f32_16x16x32_bf16 v[100:103], v[156:159], v[20:23], v[100:103]
    s_mov_b32 m0, 52320
    s_nop 0
    buffer_load_dwordx4 v8, s[16:19], s36 offen offset:1536 nt lds
    s_waitcnt lgkmcnt(10)
    v_mfma_f32_16x16x32_bf16 v[96:99], v[160:163], v[24:27], v[96:99]
    s_mov_b32 m0, 52864
    s_nop 0
    buffer_load_dwordx4 v8, s[16:19], s36 offen offset:2048 nt lds
    s_add_u32 s39, s39, 1
    v_max3_f32 v9, v80, v81, v82
    v_max3_f32 v9, v9, v83, v84
    v_max3_f32 v9, v9, v85, v86
    v_max_f32 v9, v9, v87
    v_mov_b32 v11, v9
    s_nop 1
    v_permlane16_swap_b32 v9, v11
    v_max_f32 v9, v9, v11
    v_mov_b32 v11, v9
    s_nop 1
    v_permlane32_swap_b32 v9, v11
    v_max_f32 v9, v9, v11
    v_sub_f32 v9, 0xc0e00000, v9
    v_add_f32 v136, v136, v9
    v_add_f32 v137, v137, v9
    v_add_f32 v138, v138, v9
    v_add_f32 v139, v139, v9
    v_add_f32 v80, v80, v9
    v_add_f32 v81, v81, v9
    v_add_f32 v82, v82, v9
    v_add_f32 v83, v83, v9
    v_add_f32 v84, v84, v9
    v_add_f32 v85, v85, v9
    v_add_f32 v86, v86, v9
    v_add_f32 v87, v87, v9
    v_add_f32 v96, v96, v9
    v_add_f32 v97, v97, v9
    v_add_f32 v98, v98, v9
    v_add_f32 v99, v99, v9
    v_add_f32 v100, v100, v9
    v_add_f32 v101, v101, v9
    v_add_f32 v102, v102, v9
    v_add_f32 v103, v103, v9
    v_exp_f32 v120, v80
    v_exp_f32 v121, v81
    v_exp_f32 v122, v82
    v_exp_f32 v123, v83
    v_cvt_pk_bf16_f32 v112, v120, v121
    v_exp_f32 v124, v84
    v_exp_f32 v125, v85
    v_cvt_pk_bf16_f32 v113, v122, v123
    v_exp_f32 v126, v86
    v_exp_f32 v127, v87
    v_cvt_pk_bf16_f32 v114, v124, v125
    v_cvt_pk_bf16_f32 v115, v126, v127
    v_mfma_f32_16x16x32_bf16 v[100:103], v[164:167], v[24:27], v[100:103]
    s_mov_b32 m0, 53408
    s_nop 0
    buffer_load_dwordx4 v8, s[16:19], s36 offen offset:2560 nt lds
    ds_write_b128 v2, v[112:115] offset:0
    s_waitcnt lgkmcnt(9)
    v_mfma_f32_16x16x32_bf16 v[96:99], v[168:171], v[28:31], v[96:99]
    s_mov_b32 m0, 53952
    s_nop 0
    buffer_load_dwordx4 v8, s[16:19], s36 offen offset:3072 nt lds
    v_add_f32 v6, v6, v120
    v_mfma_f32_16x16x32_bf16 v[100:103], v[172:175], v[28:31], v[100:103]
    s_mov_b32 m0, 54496
    s_nop 0
    buffer_load_dwordx4 v8, s[16:19], s36 offen offset:3584 nt lds
    v_add_f32 v6, v6, v121
    s_waitcnt lgkmcnt(7)
    v_mfma_f32_16x16x32_bf16 v[96:99], v[176:179], v[32:35], v[96:99]
    s_add_u32 s36, s36, 4096
    s_mov_b32 m0, 59136
    s_nop 0
    buffer_load_dwordx4 v8, s[16:19], s36 offen offset:0 nt lds
    v_add_f32 v6, v6, v122
    v_mfma_f32_16x16x32_bf16 v[100:103], v[180:183], v[32:35], v[100:103]
    s_mov_b32 m0, 59680
    s_nop 0
    buffer_load_dwordx4 v8, s[16:19], s36 offen offset:512 nt lds
    s_waitcnt lgkmcnt(5)
    v_mfma_f32_16x16x32_bf16 v[96:99], v[184:187], v[36:39], v[96:99]
    s_mov_b32 m0, 60224
    s_nop 0
    buffer_load_dwordx4 v8, s[16:19], s36 offen offset:1024 nt lds
    v_add_f32 v6, v6, v123
    v_mfma_f32_16x16x32_bf16 v[100:103], v[188:191], v[36:39], v[100:103]
    s_mov_b32 m0, 60768
    s_nop 0
    buffer_load_dwordx4 v8, s[16:19], s36 offen offset:1536 nt lds
    v_add_f32 v6, v6, v124
    s_waitcnt lgkmcnt(3)
    v_mfma_f32_16x16x32_bf16 v[96:99], v[192:195], v[40:43], v[96:99]
    s_mov_b32 m0, 61312
    s_nop 0
    buffer_load_dwordx4 v8, s[16:19], s36 offen offset:2048 nt lds
    v_add_f32 v6, v6, v125
    v_mfma_f32_16x16x32_bf16 v[100:103], v[196:199], v[40:43], v[100:103]
    s_mov_b32 m0, 61856
    s_nop 0
    buffer_load_dwordx4 v8, s[16:19], s36 offen offset:2560 nt lds
    v_add_f32 v6, v6, v126
    s_waitcnt lgkmcnt(1)
    v_mfma_f32_16x16x32_bf16 v[96:99], v[200:203], v[44:47], v[96:99]
    s_mov_b32 m0, 62400
    s_nop 0
    buffer_load_dwordx4 v8, s[16:19], s36 offen offset:3072 nt lds
    v_add_f32 v6, v6, v127
    v_mfma_f32_16x16x32_bf16 v[100:103], v[204:207], v[44:47], v[100:103]
    s_mov_b32 m0, 62944
    s_nop 0
    buffer_load_dwordx4 v8, s[16:19], s36 offen offset:3584 nt lds
    s_add_u32 s36, s36, 12288
    s_waitcnt lgkmcnt(0)
    s_waitcnt vmcnt(16)
    s_barrier
    v_add_u32 v1, 33792, v1
    ds_read_b128 v[144:147], v1 offset:0
    ds_read_b128 v[148:151], v1 offset:512
    ds_read_b128 v[152:155], v1 offset:64
    ds_read_b128 v[156:159], v1 offset:576
    ds_read_b128 v[160:163], v1 offset:128
    ds_read_b128 v[164:167], v1 offset:640
    ds_read_b128 v[168:171], v1 offset:192
    ds_read_b128 v[172:175], v1 offset:704
    ds_read_b128 v[176:179], v1 offset:256
    ds_read_b128 v[180:183], v1 offset:768
    ds_read_b128 v[184:187], v1 offset:320
    ds_read_b128 v[188:191], v1 offset:832
    ds_read_b128 v[192:195], v1 offset:384
    ds_read_b128 v[196:199], v1 offset:896
    s_waitcnt lgkmcnt(12)
    v_mfma_f32_16x16x32_bf16 v[80:83], v[144:147], v[16:19], v[136:139]
    ds_read_b128 v[200:203], v1 offset:448
    s_mov_b32 m0, 67584
    s_nop 0
    buffer_load_dwordx4 v8, s[16:19], s36 offen offset:0 nt lds
    v_mfma_f32_16x16x32_bf16 v[84:87], v[148:151], v[16:19], v[136:139]
    ds_read_b128 v[204:207], v1 offset:960
    s_mov_b32 m0, 68128
    s_nop 0
    buffer_load_dwordx4 v8, s[16:19], s36 offen offset:512 nt lds
    s_waitcnt lgkmcnt(12)
    v_mfma_f32_16x16x32_bf16 v[80:83], v[152:155], v[20:23], v[80:83]
    v_add_u32 v1, 33792, v1
    ds_read_b128 v[144:147], v1 offset:0
    s_mov_b32 m0, 68672
    s_nop 0
    buffer_load_dwordx4 v8, s[16:19], s36 offen offset:1024 nt lds
    v_mfma_f32_16x16x32_bf16 v[84:87], v[156:159], v[20:23], v[84:87]
    ds_read_b128 v[148:151], v1 offset:512
    s_mov_b32 m0, 69216
    s_nop 0
    buffer_load_dwordx4 v8, s[16:19], s36 offen offset:1536 nt lds
    s_waitcnt lgkmcnt(12)
    v_mfma_f32_16x16x32_bf16 v[80:83], v[160:163], v[24:27], v[80:83]
    ds_read_b128 v[152:155], v1 offset:64
    s_mov_b32 m0, 69760
    s_nop 0
    buffer_load_dwordx4 v8, s[16:19], s36 offen offset:2048 nt lds
    v_exp_f32 v120, v96
    v_exp_f32 v121, v97
    v_exp_f32 v122, v98
    v_mfma_f32_16x16x32_bf16 v[84:87], v[164:167], v[24:27], v[84:87]
    ds_read_b128 v[156:159], v1 offset:576
    s_mov_b32 m0, 70304
    s_nop 0
    buffer_load_dwordx4 v8, s[16:19], s36 offen offset:2560 nt lds
    v_exp_f32 v123, v99
    v_cvt_pk_bf16_f32 v112, v120, v121
    s_waitcnt lgkmcnt(12)
    v_mfma_f32_16x16x32_bf16 v[80:83], v[168:171], v[28:31], v[80:83]
    ds_read_b128 v[160:163], v1 offset:128
    s_mov_b32 m0, 70848
    s_nop 0
    buffer_load_dwordx4 v8, s[16:19], s36 offen offset:3072 nt lds
    v_exp_f32 v124, v100
    v_exp_f32 v125, v101
    v_cvt_pk_bf16_f32 v113, v122, v123
    v_mfma_f32_16x16x32_bf16 v[84:87], v[172:175], v[28:31], v[84:87]
    ds_read_b128 v[164:167], v1 offset:640
    s_mov_b32 m0, 71392
    s_nop 0
    buffer_load_dwordx4 v8, s[16:19], s36 offen offset:3584 nt lds
    v_exp_f32 v126, v102
    v_exp_f32 v127, v103
    s_waitcnt lgkmcnt(12)
    v_mfma_f32_16x16x32_bf16 v[80:83], v[176:179], v[32:35], v[80:83]
    ds_read_b128 v[168:171], v1 offset:192
    s_add_u32 s36, s36, 4096
    s_mov_b32 m0, 76032
    s_nop 0
    buffer_load_dwordx4 v8, s[16:19], s36 offen offset:0 nt lds
    v_cvt_pk_bf16_f32 v114, v124, v125
    v_cvt_pk_bf16_f32 v115, v126, v127
    v_or3_b32 v9, v112, v113, v114
    v_mfma_f32_16x16x32_bf16 v[84:87], v[180:183], v[32:35], v[84:87]
    ds_read_b128 v[172:175], v1 offset:704
    s_mov_b32 m0, 76576
    s_nop 0
    buffer_load_dwordx4 v8, s[16:19], s36 offen offset:512 nt lds
    v_or_b32 v9, v9, v115
    v_and_b32 v9, s41, v9
    s_waitcnt lgkmcnt(12)
    v_mfma_f32_16x16x32_bf16 v[80:83], v[184:187], v[36:39], v[80:83]
    ds_read_b128 v[176:179], v1 offset:256
    s_mov_b32 m0, 77120
    s_nop 0
    buffer_load_dwordx4 v8, s[16:19], s36 offen offset:1024 nt lds
    v_cmp_ne_u32 vcc, 0, v9
    v_mfma_f32_16x16x32_bf16 v[84:87], v[188:191], v[36:39], v[84:87]
    ds_read_b128 v[180:183], v1 offset:768
    s_mov_b32 m0, 77664
    s_nop 0
    buffer_load_dwordx4 v8, s[16:19], s36 offen offset:1536 nt lds
    s_add_u32 s39, s39, 1
    s_cbranch_vccnz L_stub_sb_2
L_back_sb_2:
    s_waitcnt lgkmcnt(12)
    v_mfma_f32_16x16x32_bf16 v[80:83], v[192:195], v[40:43], v[80:83]
    ds_read_b128 v[184:187], v1 offset:320
    s_mov_b32 m0, 78208
    s_nop 0
    buffer_load_dwordx4 v8, s[16:19], s36 offen offset:2048 nt lds
    ds_write_b128 v2, v[112:115] offset:7168
    v_add_f32 v6, v6, v120
    v_mfma_f32_16x16x32_bf16 v[84:87], v[196:199], v[40:43], v[84:87]
    ds_read_b128 v[188:191], v1 offset:832
    s_mov_b32 m0, 78752
    s_nop 0
    buffer_load_dwordx4 v8, s[16:19], s36 offen offset:2560 nt lds
    v_add_f32 v6, v6, v121
    v_add_f32 v6, v6, v122
    v_add_f32 v6, v6, v123
    s_waitcnt lgkmcnt(13)
    v_mfma_f32_16x16x32_bf16 v[80:83], v[200:203], v[44:47], v[80:83]
    ds_read_b128 v[192:195], v1 offset:384
    s_mov_b32 m0, 79296
    s_nop 0
    buffer_load_dwordx4 v8, s[16:19], s36 offen offset:3072 nt lds
    v_add_f32 v6, v6, v124
    v_add_f32 v6, v6, v125
    v_mfma_f32_16x16x32_bf16 v[84:87], v[204:207], v[44:47], v[84:87]
    ds_read_b128 v[196:199], v1 offset:896
    s_mov_b32 m0, 79840
    s_nop 0
    buffer_load_dwordx4 v8, s[16:19], s36 offen offset:3584 nt lds
    s_add_u32 s36, s36, 12288
    v_add_f32 v6, v6, v126
    v_add_f32 v6, v6, v127
    s_waitcnt lgkmcnt(3)
    s_waitcnt vmcnt(16)
    s_barrier
    v_mfma_f32_16x16x32_bf16 v[96:99], v[144:147], v[16:19], v[136:139]
    ds_read_b128 v[200:203], v1 offset:448
    s_mov_b32 m0, 101376
    s_nop 0
    buffer_load_dwordx4 v8, s[16:19], s36 offen offset:0 nt lds
    v_mfma_f32_16x16x32_bf16 v[100:103], v[148:151], v[16:19], v[136:139]
    ds_read_b128 v[204:207], v1 offset:960
    s_mov_b32 m0, 101920
    s_nop 0
    buffer_load_dwordx4 v8, s[16:19], s36 offen offset:512 nt lds
    v_mfma_f32_16x16x32_bf16 v[96:99], v[152:155], v[20:23], v[96:99]
    v_add_u32 v1, 4294882816, v1
    ds_read_b128 v[144:147], v1 offset:0
    s_mov_b32 m0, 102464
    s_nop 0
    buffer_load_dwordx4 v8, s[16:19], s36 offen offset:1024 nt lds
    v_mfma_f32_16x16x32_bf16 v[100:103], v[156:159], v[20:23], v[100:103]
    ds_read_b128 v[148:151], v1 offset:512
    s_mov_b32 m0, 103008
    s_nop 0
    buffer_load_dwordx4 v8, s[16:19], s36 offen offset:1536 nt lds
    v_mfma_f32_16x16x32_bf16 v[96:99], v[160:163], v[24:27], v[96:99]
    ds_read_b128 v[152:155], v1 offset:64
    s_mov_b32 m0, 103552
    s_nop 0
    buffer_load_dwordx4 v8, s[16:19], s36 offen offset:2048 nt lds
    v_exp_f32 v120, v80
    v_exp_f32 v121, v81
    v_exp_f32 v122, v82
    v_mfma_f32_16x16x32_bf16 v[100:103], v[164:167], v[24:27], v[100:103]
    ds_read_b128 v[156:159], v1 offset:576
    s_mov_b32 m0, 104096
    s_nop 0
    buffer_load_dwordx4 v8, s[16:19], s36 offen offset:2560 nt lds
    v_exp_f32 v123, v83
    v_cvt_pk_bf16_f32 v112, v120, v121
    v_mfma_f32_16x16x32_bf16 v[96:99], v[168:171], v[28:31], v[96:99]
    ds_read_b128 v[160:163], v1 offset:128
    s_mov_b32 m0, 104640
    s_nop 0
    buffer_load_dwordx4 v8, s[16:19], s36 offen offset:3072 nt lds
    v_exp_f32 v124, v84
    v_exp_f32 v125, v85
    v_cvt_pk_bf16_f32 v113, v122, v123
    v_mfma_f32_16x16x32_bf16 v[100:103], v[172:175], v[28:31], v[100:103]
    ds_read_b128 v[164:167], v1 offset:640
    s_mov_b32 m0, 105184
    s_nop 0
    buffer_load_dwordx4 v8, s[16:19], s36 offen offset:3584 nt lds
    v_exp_f32 v126, v86
    v_exp_f32 v127, v87
    v_mfma_f32_16x16x32_bf16 v[96:99], v[176:179], v[32:35], v[96:99]
    ds_read_b128 v[168:171], v1 offset:192
    s_add_u32 s36, s36, 4096
    s_mov_b32 m0, 109824
    s_nop 0
    buffer_load_dwordx4 v8, s[16:19], s36 offen offset:0 nt lds
    v_cvt_pk_bf16_f32 v114, v124, v125
    v_cvt_pk_bf16_f32 v115, v126, v127
    v_or3_b32 v9, v112, v113, v114
    v_mfma_f32_16x16x32_bf16 v[100:103], v[180:183], v[32:35], v[100:103]
    ds_read_b128 v[172:175], v1 offset:704
    s_mov_b32 m0, 110368
    s_nop 0
    buffer_load_dwordx4 v8, s[16:19], s36 offen offset:512 nt lds
    v_or_b32 v9, v9, v115
    v_and_b32 v9, s41, v9
    s_waitcnt lgkmcnt(12)
    v_mfma_f32_16x16x32_bf16 v[96:99], v[184:187], v[36:39], v[96:99]
    ds_read_b128 v[176:179], v1 offset:256
    s_mov_b32 m0, 110912
    s_nop 0
    buffer_load_dwordx4 v8, s[16:19], s36 offen offset:1024 nt lds
    v_cmp_ne_u32 vcc, 0, v9
    v_mfma_f32_16x16x32_bf16 v[100:103], v[188:191], v[36:39], v[100:103]
    ds_read_b128 v[180:183], v1 offset:768
    s_mov_b32 m0, 111456
    s_nop 0
    buffer_load_dwordx4 v8, s[16:19], s36 offen offset:1536 nt lds
    s_add_u32 s39, s39, 1
    s_cbranch_vccnz L_stub_sb_3
L_back_sb_3:
    s_waitcnt lgkmcnt(12)
    v_mfma_f32_16x16x32_bf16 v[96:99], v[192:195], v[40:43], v[96:99]
    ds_read_b128 v[184:187], v1 offset:320
    s_mov_b32 m0, 112000
    s_nop 0
    buffer_load_dwordx4 v8, s[16:19], s36 offen offset:2048 nt lds
    ds_write_b128 v2, v[112:115] offset:0
    v_add_f32 v6, v6, v120
    v_mfma_f32_16x16x32_bf16 v[100:103], v[196:199], v[40:43], v[100:103]
    ds_read_b128 v[188:191], v1 offset:832
    s_mov_b32 m0, 112544
    s_nop 0
    buffer_load_dwordx4 v8, s[16:19], s36 offen offset:2560 nt lds
    v_add_f32 v6, v6, v121
    v_add_f32 v6, v6, v122
    v_add_f32 v6, v6, v123
    s_waitcnt lgkmcnt(13)
    v_mfma_f32_16x16x32_bf16 v[96:99], v[200:203], v[44:47], v[96:99]
    ds_read_b128 v[192:195], v1 offset:384
    s_mov_b32 m0, 113088
    s_nop 0
    buffer_load_dwordx4 v8, s[16:19], s36 offen offset:3072 nt lds
    v_add_f32 v6, v6, v124
    v_add_f32 v6, v6, v125
    v_mfma_f32_16x16x32_bf16 v[100:103], v[204:207], v[44:47], v[100:103]
    ds_read_b128 v[196:199], v1 offset:896
    s_mov_b32 m0, 113632
    s_nop 0
    buffer_load_dwordx4 v8, s[16:19], s36 offen offset:3584 nt lds
    s_add_u32 s36, s36, 12288
    v_add_f32 v6, v6, v126
    v_add_f32 v6, v6, v127
    s_waitcnt lgkmcnt(3)
    s_waitcnt vmcnt(16)
    s_barrier
    v_mfma_f32_16x16x32_bf16 v[80:83], v[144:147], v[16:19], v[136:139]
    ds_read_b128 v[200:203], v1 offset:448
    s_mov_b32 m0, 135168
    s_nop 0
    buffer_load_dwordx4 v8, s[16:19], s36 offen offset:0 nt lds
    v_mfma_f32_16x16x32_bf16 v[84:87], v[148:151], v[16:19], v[136:139]
    ds_read_b128 v[204:207], v1 offset:960
    s_mov_b32 m0, 135712
    s_nop 0
    buffer_load_dwordx4 v8, s[16:19], s36 offen offset:512 nt lds
    v_mfma_f32_16x16x32_bf16 v[80:83], v[152:155], v[20:23], v[80:83]
    v_add_u32 v1, 16896, v1
    ds_read_b128 v[144:147], v1 offset:0
    s_mov_b32 m0, 136256
    s_nop 0
    buffer_load_dwordx4 v8, s[16:19], s36 offen offset:1024 nt lds
    v_mfma_f32_16x16x32_bf16 v[84:87], v[156:159], v[20:23], v[84:87]
    ds_read_b128 v[148:151], v1 offset:512
    s_mov_b32 m0, 136800
    s_nop 0
    buffer_load_dwordx4 v8, s[16:19], s36 offen offset:1536 nt lds
    v_mfma_f32_16x16x32_bf16 v[80:83], v[160:163], v[24:27], v[80:83]
    ds_read_b128 v[152:155], v1 offset:64
    s_mov_b32 m0, 137344
    s_nop 0
    buffer_load_dwordx4 v8, s[16:19], s36 offen offset:2048 nt lds
    v_exp_f32 v120, v96
    v_exp_f32 v121, v97
    v_exp_f32 v122, v98
    v_mfma_f32_16x16x32_bf16 v[84:87], v[164:167], v[24:27], v[84:87]
    ds_read_b128 v[156:159], v1 offset:576
    s_mov_b32 m0, 137888
    s_nop 0
    buffer_load_dwordx4 v8, s[16:19], s36 offen offset:2560 nt lds
    v_exp_f32 v123, v99
    v_cvt_pk_bf16_f32 v112, v120, v121
    v_mfma_f32_16x16x32_bf16 v[80:83], v[168:171], v[28:31], v[80:83]
    ds_read_b128 v[160:163], v1 offset:128
    s_mov_b32 m0, 138432
    s_nop 0
    buffer_load_dwordx4 v8, s[16:19], s36 offen offset:3072 nt lds
    v_exp_f32 v124, v100
    v_exp_f32 v125, v101
    v_cvt_pk_bf16_f32 v113, v122, v123
    v_mfma_f32_16x16x32_bf16 v[84:87], v[172:175], v[28:31], v[84:87]
    ds_read_b128 v[164:167], v1 offset:640
    s_mov_b32 m0, 138976
    s_nop 0
    buffer_load_dwordx4 v8, s[16:19], s36 offen offset:3584 nt lds
    v_exp_f32 v126, v102
    v_exp_f32 v127, v103
    v_mfma_f32_16x16x32_bf16 v[80:83], v[176:179], v[32:35], v[80:83]
    ds_read_b128 v[168:171], v1 offset:192
    s_add_u32 s36, s36, 4096
    s_mov_b32 m0, 143616
    s_nop 0
    buffer_load_dwordx4 v8, s[16:19], s36 offen offset:0 nt lds
    v_cvt_pk_bf16_f32 v114, v124, v125
    v_cvt_pk_bf16_f32 v115, v126, v127
    v_or3_b32 v9, v112, v113, v114
    v_mfma_f32_16x16x32_bf16 v[84:87], v[180:183], v[32:35], v[84:87]
    ds_read_b128 v[172:175], v1 offset:704
    s_mov_b32 m0, 144160
    s_nop 0
    buffer_load_dwordx4 v8, s[16:19], s36 offen offset:512 nt lds
    v_or_b32 v9, v9, v115
    v_and_b32 v9, s41, v9
    s_waitcnt lgkmcnt(12)
    v_mfma_f32_16x16x32_bf16 v[80:83], v[184:187], v[36:39], v[80:83]
    ds_read_b128 v[176:179], v1 offset:256
    s_mov_b32 m0, 144704
    s_nop 0
    buffer_load_dwordx4 v8, s[16:19], s36 offen offset:1024 nt lds
    v_cmp_ne_u32 vcc, 0, v9
    v_mfma_f32_16x16x32_bf16 v[84:87], v[188:191], v[36:39], v[84:87]
    ds_read_b128 v[180:183], v1 offset:768
    s_mov_b32 m0, 145248
    s_nop 0
    buffer_load_dwordx4 v8, s[16:19], s36 offen offset:1536 nt lds
    s_add_u32 s39, s39, 1
    s_cbranch_vccnz L_stub_sb_4
L_back_sb_4:
    s_waitcnt lgkmcnt(12)
    v_mfma_f32_16x16x32_bf16 v[80:83], v[192:195], v[40:43], v[80:83]
    ds_read_b128 v[184:187], v1 offset:320
    s_mov_b32 m0, 145792
    s_nop 0
    buffer_load_dwordx4 v8, s[16:19], s36 offen offset:2048 nt lds
    ds_write_b128 v2, v[112:115] offset:7168
    v_add_f32 v6, v6, v120
    v_mfma_f32_16x16x32_bf16 v[84:87], v[196:199], v[40:43], v[84:87]
    ds_read_b128 v[188:191], v1 offset:832
    s_mov_b32 m0, 146336
    s_nop 0
    buffer_load_dwordx4 v8, s[16:19], s36 offen offset:2560 nt lds
    v_add_f32 v6, v6, v121
    v_add_f32 v6, v6, v122
    v_add_f32 v6, v6, v123
    s_waitcnt lgkmcnt(13)
    v_mfma_f32_16x16x32_bf16 v[80:83], v[200:203], v[44:47], v[80:83]
    ds_read_b128 v[192:195], v1 offset:384
    s_mov_b32 m0, 146880
    s_nop 0
    buffer_load_dwordx4 v8, s[16:19], s36 offen offset:3072 nt lds
    v_add_f32 v6, v6, v124
    v_add_f32 v6, v6, v125
    v_mfma_f32_16x16x32_bf16 v[84:87], v[204:207], v[44:47], v[84:87]
    ds_read_b128 v[196:199], v1 offset:896
    s_mov_b32 m0, 147424
    s_nop 0
    buffer_load_dwordx4 v8, s[16:19], s36 offen offset:3584 nt lds
    s_add_u32 s36, s36, 12288
    v_add_f32 v6, v6, v126
    v_add_f32 v6, v6, v127
    s_waitcnt lgkmcnt(3)
    s_waitcnt vmcnt(16)
    s_barrier
    s_mov_b32 s38, 14
L_sloopb:
    v_mfma_f32_16x16x32_bf16 v[96:99], v[144:147], v[16:19], v[136:139]
    ds_read_b128 v[200:203], v1 offset:448
    s_mov_b32 m0, 50688
    s_nop 0
    buffer_load_dwordx4 v8, s[16:19], s36 offen offset:0 nt lds
    v_mfma_f32_16x16x32_bf16 v[100:103], v[148:151], v[16:19], v[136:139]
    ds_read_b128 v[204:207], v1 offset:960
    s_mov_b32 m0, 51232
    s_nop 0
    buffer_load_dwordx4 v8, s[16:19], s36 offen offset:512 nt lds
    v_mfma_f32_16x16x32_bf16 v[96:99], v[152:155], v[20:23], v[96:99]
    v_add_u32 v1, 33792, v1
    ds_read_b128 v[144:147], v1 offset:0
    s_mov_b32 m0, 51776
    s_nop 0
    buffer_load_dwordx4 v8, s[16:19], s36 offen offset:1024 nt lds
    v_mfma_f32_16x16x32_bf16 v[100:103], v[156:159], v[20:23], v[100:103]
    ds_read_b128 v[148:151], v1 offset:512
    s_mov_b32 m0, 52320
    s_nop 0
    buffer_load_dwordx4 v8, s[16:19], s36 offen offset:1536 nt lds
    v_mfma_f32_16x16x32_bf16 v[96:99], v[160:163], v[24:27], v[96:99]
    ds_read_b128 v[152:155], v1 offset:64
    s_mov_b32 m0, 52864
    s_nop 0
    buffer_load_dwordx4 v8, s[16:19], s36 offen offset:2048 nt lds
    v_exp_f32 v120, v80
    v_exp_f32 v121, v81
    v_exp_f32 v122, v82
    v_mfma_f32_16x16x32_bf16 v[100:103], v[164:167], v[24:27], v[100:103]
    ds_read_b128 v[156:159], v1 offset:576
    s_mov_b32 m0, 53408
    s_nop 0
    buffer_load_dwordx4 v8, s[16:19], s36 offen offset:2560 nt lds
    v_exp_f32 v123, v83
    v_cvt_pk_bf16_f32 v112, v120, v121
    v_mfma_f32_16x16x32_bf16 v[96:99], v[168:171], v[28:31], v[96:99]
    ds_read_b128 v[160:163], v1 offset:128
    s_mov_b32 m0, 53952
    s_nop 0
    buffer_load_dwordx4 v8, s[16:19], s36 offen offset:3072 nt lds
    v_exp_f32 v124, v84
    v_exp_f32 v125, v85
    v_cvt_pk_bf16_f32 v113, v122, v123
    v_mfma_f32_16x16x32_bf16 v[100:103], v[172:175], v[28:31], v[100:103]
    ds_read_b128 v[164:167], v1 offset:640
    s_mov_b32 m0, 54496
    s_nop 0
    buffer_load_dwordx4 v8, s[16:19], s36 offen offset:3584 nt lds
    v_exp_f32 v126, v86
    v_exp_f32 v127, v87
    v_mfma_f32_16x16x32_bf16 v[96:99], v[176:179], v[32:35], v[96:99]
    ds_read_b128 v[168:171], v1 offset:192
    s_add_u32 s36, s36, 4096
    s_mov_b32 m0, 59136
    s_nop 0
    buffer_load_dwordx4 v8, s[16:19], s36 offen offset:0 nt lds
    v_cvt_pk_bf16_f32 v114, v124, v125
    v_cvt_pk_bf16_f32 v115, v126, v127
    v_or3_b32 v9, v112, v113, v114
    v_mfma_f32_16x16x32_bf16 v[100:103], v[180:183], v[32:35], v[100:103]
    ds_read_b128 v[172:175], v1 offset:704
    s_mov_b32 m0, 59680
    s_nop 0
    buffer_load_dwordx4 v8, s[16:19], s36 offen offset:512 nt lds
    v_or_b32 v9, v9, v115
    v_and_b32 v9, s41, v9
    s_waitcnt lgkmcnt(12)
    v_mfma_f32_16x16x32_bf16 v[96:99], v[184:187], v[36:39], v[96:99]
    ds_read_b128 v[176:179], v1 offset:256
    s_mov_b32 m0, 60224
    s_nop 0
    buffer_load_dwordx4 v8, s[16:19], s36 offen offset:1024 nt lds
    v_cmp_ne_u32 vcc, 0, v9
    v_mfma_f32_16x16x32_bf16 v[100:103], v[188:191], v[36:39], v[100:103]
    ds_read_b128 v[180:183], v1 offset:768
    s_mov_b32 m0, 60768
    s_nop 0
    buffer_load_dwordx4 v8, s[16:19], s36 offen offset:1536 nt lds
    s_add_u32 s39, s39, 1
    s_cbranch_vccnz L_stub_sb_5
L_back_sb_5:
    s_waitcnt lgkmcnt(12)
    v_mfma_f32_16x16x32_bf16 v[96:99], v[192:195], v[40:43], v[96:99]
    ds_read_b128 v[184:187], v1 offset:320
    s_mov_b32 m0, 61312
    s_nop 0
    buffer_load_dwordx4 v8, s[16:19], s36 offen offset:2048 nt lds
    ds_write_b128 v2, v[112:115] offset:0
    v_add_f32 v6, v6, v120
    v_mfma_f32_16x16x32_bf16 v[100:103], v[196:199], v[40:43], v[100:103]
    ds_read_b128 v[188:191], v1 offset:832
    s_mov_b32 m0, 61856
    s_nop 0
    buffer_load_dwordx4 v8, s[16:19], s36 offen offset:2560 nt lds
    v_add_f32 v6, v6, v121
    v_add_f32 v6, v6, v122
    v_add_f32 v6, v6, v123
    s_waitcnt lgkmcnt(13)
    v_mfma_f32_16x16x32_bf16 v[96:99], v[200:203], v[44:47], v[96:99]
    ds_read_b128 v[192:195], v1 offset:384
    s_mov_b32 m0, 62400
    s_nop 0
    buffer_load_dwordx4 v8, s[16:19], s36 offen offset:3072 nt lds
    v_add_f32 v6, v6, v124
    v_add_f32 v6, v6, v125
    v_mfma_f32_16x16x32_bf16 v[100:103], v[204:207], v[44:47], v[100:103]
    ds_read_b128 v[196:199], v1 offset:896
    s_mov_b32 m0, 62944
    s_nop 0
    buffer_load_dwordx4 v8, s[16:19], s36 offen offset:3584 nt lds
    s_add_u32 s36, s36, 12288
    v_add_f32 v6, v6, v126
    v_add_f32 v6, v6, v127
    s_waitcnt lgkmcnt(3)
    s_waitcnt vmcnt(16)
    s_barrier
    v_mfma_f32_16x16x32_bf16 v[80:83], v[144:147], v[16:19], v[136:139]
    ds_read_b128 v[200:203], v1 offset:448
    s_mov_b32 m0, 67584
    s_nop 0
    buffer_load_dwordx4 v8, s[16:19], s36 offen offset:0 nt lds
    v_mfma_f32_16x16x32_bf16 v[84:87], v[148:151], v[16:19], v[136:139]
    ds_read_b128 v[204:207], v1 offset:960
    s_mov_b32 m0, 68128
    s_nop 0
    buffer_load_dwordx4 v8, s[16:19], s36 offen offset:512 nt lds
    v_mfma_f32_16x16x32_bf16 v[80:83], v[152:155], v[20:23], v[80:83]
    v_add_u32 v1, 33792, v1
    ds_read_b128 v[144:147], v1 offset:0
    s_mov_b32 m0, 68672
    s_nop 0
    buffer_load_dwordx4 v8, s[16:19], s36 offen offset:1024 nt lds
    v_mfma_f32_16x16x32_bf16 v[84:87], v[156:159], v[20:23], v[84:87]
    ds_read_b128 v[148:151], v1 offset:512
    s_mov_b32 m0, 69216
    s_nop 0
    buffer_load_dwordx4 v8, s[16:19], s36 offen offset:1536 nt lds
    v_mfma_f32_16x16x32_bf16 v[80:83], v[160:163], v[24:27], v[80:83]
    ds_read_b128 v[152:155], v1 offset:64
    s_mov_b32 m0, 69760
    s_nop 0
    buffer_load_dwordx4 v8, s[16:19], s36 offen offset:2048 nt lds
    v_exp_f32 v120, v96
    v_exp_f32 v121, v97
    v_exp_f32 v122, v98
    v_mfma_f32_16x16x32_bf16 v[84:87], v[164:167], v[24:27], v[84:87]
    ds_read_b128 v[156:159], v1 offset:576
    s_mov_b32 m0, 70304
    s_nop 0
    buffer_load_dwordx4 v8, s[16:19], s36 offen offset:2560 nt lds
    v_exp_f32 v123, v99
    v_cvt_pk_bf16_f32 v112, v120, v121
    v_mfma_f32_16x16x32_bf16 v[80:83], v[168:171], v[28:31], v[80:83]
    ds_read_b128 v[160:163], v1 offset:128
    s_mov_b32 m0, 70848
    s_nop 0
    buffer_load_dwordx4 v8, s[16:19], s36 offen offset:3072 nt lds
    v_exp_f32 v124, v100
    v_exp_f32 v125, v101
    v_cvt_pk_bf16_f32 v113, v122, v123
    v_mfma_f32_16x16x32_bf16 v[84:87], v[172:175], v[28:31], v[84:87]
    ds_read_b128 v[164:167], v1 offset:640
    s_mov_b32 m0, 71392
    s_nop 0
    buffer_load_dwordx4 v8, s[16:19], s36 offen offset:3584 nt lds
    v_exp_f32 v126, v102
    v_exp_f32 v127, v103
    v_mfma_f32_16x16x32_bf16 v[80:83], v[176:179], v[32:35], v[80:83]
    ds_read_b128 v[168:171], v1 offset:192
    s_add_u32 s36, s36, 4096
    s_mov_b32 m0, 76032
    s_nop 0
    buffer_load_dwordx4 v8, s[16:19], s36 offen offset:0 nt lds
    v_cvt_pk_bf16_f32 v114, v124, v125
    v_cvt_pk_bf16_f32 v115, v126, v127
    v_or3_b32 v9, v112, v113, v114
    v_mfma_f32_16x16x32_bf16 v[84:87], v[180:183], v[32:35], v[84:87]
    ds_read_b128 v[172:175], v1 offset:704
    s_mov_b32 m0, 76576
    s_nop 0
    buffer_load_dwordx4 v8, s[16:19], s36 offen offset:512 nt lds
    v_or_b32 v9, v9, v115
    v_and_b32 v9, s41, v9
    s_waitcnt lgkmcnt(12)
    v_mfma_f32_16x16x32_bf16 v[80:83], v[184:187], v[36:39], v[80:83]
    ds_read_b128 v[176:179], v1 offset:256
    s_mov_b32 m0, 77120
    s_nop 0
    buffer_load_dwordx4 v8, s[16:19], s36 offen offset:1024 nt lds
    v_cmp_ne_u32 vcc, 0, v9
    v_mfma_f32_16x16x32_bf16 v[84:87], v[188:191], v[36:39], v[84:87]
    ds_read_b128 v[180:183], v1 offset:768
    s_mov_b32 m0, 77664
    s_nop 0
    buffer_load_dwordx4 v8, s[16:19], s36 offen offset:1536 nt lds
    s_add_u32 s39, s39, 1
    s_cbranch_vccnz L_stub_sb_6
L_back_sb_6:
    s_waitcnt lgkmcnt(12)
    v_mfma_f32_16x16x32_bf16 v[80:83], v[192:195], v[40:43], v[80:83]
    ds_read_b128 v[184:187], v1 offset:320
    s_mov_b32 m0, 78208
    s_nop 0
    buffer_load_dwordx4 v8, s[16:19], s36 offen offset:2048 nt lds
    ds_write_b128 v2, v[112:115] offset:7168
    v_add_f32 v6, v6, v120
    v_mfma_f32_16x16x32_bf16 v[84:87], v[196:199], v[40:43], v[84:87]
    ds_read_b128 v[188:191], v1 offset:832
    s_mov_b32 m0, 78752
    s_nop 0
    buffer_load_dwordx4 v8, s[16:19], s36 offen offset:2560 nt lds
    v_add_f32 v6, v6, v121
    v_add_f32 v6, v6, v122
    v_add_f32 v6, v6, v123
    s_waitcnt lgkmcnt(13)
    v_mfma_f32_16x16x32_bf16 v[80:83], v[200:203], v[44:47], v[80:83]
    ds_read_b128 v[192:195], v1 offset:384
    s_mov_b32 m0, 79296
    s_nop 0
    buffer_load_dwordx4 v8, s[16:19], s36 offen offset:3072 nt lds
    v_add_f32 v6, v6, v124
    v_add_f32 v6, v6, v125
    v_mfma_f32_16x16x32_bf16 v[84:87], v[204:207], v[44:47], v[84:87]
    ds_read_b128 v[196:199], v1 offset:896
    s_mov_b32 m0, 79840
    s_nop 0
    buffer_load_dwordx4 v8, s[16:19], s36 offen offset:3584 nt lds
    s_add_u32 s36, s36, 12288
    v_add_f32 v6, v6, v126
    v_add_f32 v6, v6, v127
    s_waitcnt lgkmcnt(3)
    s_waitcnt vmcnt(16)
    s_barrier
    v_mfma_f32_16x16x32_bf16 v[96:99], v[144:147], v[16:19], v[136:139]
    ds_read_b128 v[200:203], v1 offset:448
    s_mov_b32 m0, 101376
    s_nop 0
    buffer_load_dwordx4 v8, s[16:19], s36 offen offset:0 nt lds
    v_mfma_f32_16x16x32_bf16 v[100:103], v[148:151], v[16:19], v[136:139]
    ds_read_b128 v[204:207], v1 offset:960
    s_mov_b32 m0, 101920
    s_nop 0
    buffer_load_dwordx4 v8, s[16:19], s36 offen offset:512 nt lds
    v_mfma_f32_16x16x32_bf16 v[96:99], v[152:155], v[20:23], v[96:99]
    v_add_u32 v1, 4294882816, v1
    ds_read_b128 v[144:147], v1 offset:0
    s_mov_b32 m0, 102464
    s_nop 0
    buffer_load_dwordx4 v8, s[16:19], s36 offen offset:1024 nt lds
    v_mfma_f32_16x16x32_bf16 v[100:103], v[156:159], v[20:23], v[100:103]
    ds_read_b128 v[148:151], v1 offset:512
    s_mov_b32 m0, 103008
    s_nop 0
    buffer_load_dwordx4 v8, s[16:19], s36 offen offset:1536 nt lds
    v_mfma_f32_16x16x32_bf16 v[96:99], v[160:163], v[24:27], v[96:99]
    ds_read_b128 v[152:155], v1 offset:64
    s_mov_b32 m0, 103552
    s_nop 0
    buffer_load_dwordx4 v8, s[16:19], s36 offen offset:2048 nt lds
    v_exp_f32 v120, v80
    v_exp_f32 v121, v81
    v_exp_f32 v122, v82
    v_mfma_f32_16x16x32_bf16 v[100:103], v[164:167], v[24:27], v[100:103]
    ds_read_b128 v[156:159], v1 offset:576
    s_mov_b32 m0, 104096
    s_nop 0
    buffer_load_dwordx4 v8, s[16:19], s36 offen offset:2560 nt lds
    v_exp_f32 v123, v83
    v_cvt_pk_bf16_f32 v112, v120, v121
    v_mfma_f32_16x16x32_bf16 v[96:99], v[168:171], v[28:31], v[96:99]
    ds_read_b128 v[160:163], v1 offset:128
    s_mov_b32 m0, 104640
    s_nop 0
    buffer_load_dwordx4 v8, s[16:19], s36 offen offset:3072 nt lds
    v_exp_f32 v124, v84
    v_exp_f32 v125, v85
    v_cvt_pk_bf16_f32 v113, v122, v123
    v_mfma_f32_16x16x32_bf16 v[100:103], v[172:175], v[28:31], v[100:103]
    ds_read_b128 v[164:167], v1 offset:640
    s_mov_b32 m0, 105184
    s_nop 0
    buffer_load_dwordx4 v8, s[16:19], s36 offen offset:3584 nt lds
    v_exp_f32 v126, v86
    v_exp_f32 v127, v87
    v_mfma_f32_16x16x32_bf16 v[96:99], v[176:179], v[32:35], v[96:99]
    ds_read_b128 v[168:171], v1 offset:192
    s_add_u32 s36, s36, 4096
    s_mov_b32 m0, 109824
    s_nop 0
    buffer_load_dwordx4 v8, s[16:19], s36 offen offset:0 nt lds
    v_cvt_pk_bf16_f32 v114, v124, v125
    v_cvt_pk_bf16_f32 v115, v126, v127
    v_or3_b32 v9, v112, v113, v114
    v_mfma_f32_16x16x32_bf16 v[100:103], v[180:183], v[32:35], v[100:103]
    ds_read_b128 v[172:175], v1 offset:704
    s_mov_b32 m0, 110368
    s_nop 0
    buffer_load_dwordx4 v8, s[16:19], s36 offen offset:512 nt lds
    v_or_b32 v9, v9, v115
    v_and_b32 v9, s41, v9
    s_waitcnt lgkmcnt(12)
    v_mfma_f32_16x16x32_bf16 v[96:99], v[184:187], v[36:39], v[96:99]
    ds_read_b128 v[176:179], v1 offset:256
    s_mov_b32 m0, 110912
    s_nop 0
    buffer_load_dwordx4 v8, s[16:19], s36 offen offset:1024 nt lds
    v_cmp_ne_u32 vcc, 0, v9
    v_mfma_f32_16x16x32_bf16 v[100:103], v[188:191], v[36:39], v[100:103]
    ds_read_b128 v[180:183], v1 offset:768
    s_mov_b32 m0, 111456
    s_nop 0
    buffer_load_dwordx4 v8, s[16:19], s36 offen offset:1536 nt lds
    s_add_u32 s39, s39, 1
    s_cbranch_vccnz L_stub_sb_7
L_back_sb_7:
    s_waitcnt lgkmcnt(12)
    v_mfma_f32_16x16x32_bf16 v[96:99], v[192:195], v[40:43], v[96:99]
    ds_read_b128 v[184:187], v1 offset:320
    s_mov_b32 m0, 112000
    s_nop 0
    buffer_load_dwordx4 v8, s[16:19], s36 offen offset:2048 nt lds
    ds_write_b128 v2, v[112:115] offset:0
    v_add_f32 v6, v6, v120
    v_mfma_f32_16x16x32_bf16 v[100:103], v[196:199], v[40:43], v[100:103]
    ds_read_b128 v[188:191], v1 offset:832
    s_mov_b32 m0, 112544
    s_nop 0
    buffer_load_dwordx4 v8, s[16:19], s36 offen offset:2560 nt lds
    v_add_f32 v6, v6, v121
    v_add_f32 v6, v6, v122
    v_add_f32 v6, v6, v123
    s_waitcnt lgkmcnt(13)
    v_mfma_f32_16x16x32_bf16 v[96:99], v[200:203], v[44:47], v[96:99]
    ds_read_b128 v[192:195], v1 offset:384
    s_mov_b32 m0, 113088
    s_nop 0
    buffer_load_dwordx4 v8, s[16:19], s36 offen offset:3072 nt lds
    v_add_f32 v6, v6, v124
    v_add_f32 v6, v6, v125
    v_mfma_f32_16x16x32_bf16 v[100:103], v[204:207], v[44:47], v[100:103]
    ds_read_b128 v[196:199], v1 offset:896
    s_mov_b32 m0, 113632
    s_nop 0
    buffer_load_dwordx4 v8, s[16:19], s36 offen offset:3584 nt lds
    s_add_u32 s36, s36, 12288
    v_add_f32 v6, v6, v126
    v_add_f32 v6, v6, v127
    s_waitcnt lgkmcnt(3)
    s_waitcnt vmcnt(16)
    s_barrier
    v_mfma_f32_16x16x32_bf16 v[80:83], v[144:147], v[16:19], v[136:139]
    ds_read_b128 v[200:203], v1 offset:448
    s_mov_b32 m0, 135168
    s_nop 0
    buffer_load_dwordx4 v8, s[16:19], s36 offen offset:0 nt lds
    v_mfma_f32_16x16x32_bf16 v[84:87], v[148:151], v[16:19], v[136:139]
    ds_read_b128 v[204:207], v1 offset:960
    s_mov_b32 m0, 135712
    s_nop 0
    buffer_load_dwordx4 v8, s[16:19], s36 offen offset:512 nt lds
    v_mfma_f32_16x16x32_bf16 v[80:83], v[152:155], v[20:23], v[80:83]
    v_add_u32 v1, 16896, v1
    ds_read_b128 v[144:147], v1 offset:0
    s_mov_b32 m0, 136256
    s_nop 0
    buffer_load_dwordx4 v8, s[16:19], s36 offen offset:1024 nt lds
    v_mfma_f32_16x16x32_bf16 v[84:87], v[156:159], v[20:23], v[84:87]
    ds_read_b128 v[148:151], v1 offset:512
    s_mov_b32 m0, 136800
    s_nop 0
    buffer_load_dwordx4 v8, s[16:19], s36 offen offset:1536 nt lds
    v_mfma_f32_16x16x32_bf16 v[80:83], v[160:163], v[24:27], v[80:83]
    ds_read_b128 v[152:155], v1 offset:64
    s_mov_b32 m0, 137344
    s_nop 0
    buffer_load_dwordx4 v8, s[16:19], s36 offen offset:2048 nt lds
    v_exp_f32 v120, v96
    v_exp_f32 v121, v97
    v_exp_f32 v122, v98
    v_mfma_f32_16x16x32_bf16 v[84:87], v[164:167], v[24:27], v[84:87]
    ds_read_b128 v[156:159], v1 offset:576
    s_mov_b32 m0, 137888
    s_nop 0
    buffer_load_dwordx4 v8, s[16:19], s36 offen offset:2560 nt lds
    v_exp_f32 v123, v99
    v_cvt_pk_bf16_f32 v112, v120, v121
    v_mfma_f32_16x16x32_bf16 v[80:83], v[168:171], v[28:31], v[80:83]
    ds_read_b128 v[160:163], v1 offset:128
    s_mov_b32 m0, 138432
    s_nop 0
    buffer_load_dwordx4 v8, s[16:19], s36 offen offset:3072 nt lds
    v_exp_f32 v124, v100
    v_exp_f32 v125, v101
    v_cvt_pk_bf16_f32 v113, v122, v123
    v_mfma_f32_16x16x32_bf16 v[84:87], v[172:175], v[28:31], v[84:87]
    ds_read_b128 v[164:167], v1 offset:640
    s_mov_b32 m0, 138976
    s_nop 0
    buffer_load_dwordx4 v8, s[16:19], s36 offen offset:3584 nt lds
    v_exp_f32 v126, v102
    v_exp_f32 v127, v103
    v_mfma_f32_16x16x32_bf16 v[80:83], v[176:179], v[32:35], v[80:83]
    ds_read_b128 v[168:171], v1 offset:192
    s_add_u32 s36, s36, 4096
    s_mov_b32 m0, 143616
    s_nop 0
    buffer_load_dwordx4 v8, s[16:19], s36 offen offset:0 nt lds
    v_cvt_pk_bf16_f32 v114, v124, v125
    v_cvt_pk_bf16_f32 v115, v126, v127
    v_or3_b32 v9, v112, v113, v114
    v_mfma_f32_16x16x32_bf16 v[84:87], v[180:183], v[32:35], v[84:87]
    ds_read_b128 v[172:175], v1 offset:704
    s_mov_b32 m0, 144160
    s_nop 0
    buffer_load_dwordx4 v8, s[16:19], s36 offen offset:512 nt lds
    v_or_b32 v9, v9, v115
    v_and_b32 v9, s41, v9
    s_waitcnt lgkmcnt(12)
    v_mfma_f32_16x16x32_bf16 v[80:83], v[184:187], v[36:39], v[80:83]
    ds_read_b128 v[176:179], v1 offset:256
    s_mov_b32 m0, 144704
    s_nop 0
    buffer_load_dwordx4 v8, s[16:19], s36 offen offset:1024 nt lds
    v_cmp_ne_u32 vcc, 0, v9
    v_mfma_f32_16x16x32_bf16 v[84:87], v[188:191], v[36:39], v[84:87]
    ds_read_b128 v[180:183], v1 offset:768
    s_mov_b32 m0, 145248
    s_nop 0
    buffer_load_dwordx4 v8, s[16:19], s36 offen offset:1536 nt lds
    s_add_u32 s39, s39, 1
    s_cbranch_vccnz L_stub_sb_8
L_back_sb_8:
    s_waitcnt lgkmcnt(12)
    v_mfma_f32_16x16x32_bf16 v[80:83], v[192:195], v[40:43], v[80:83]
    ds_read_b128 v[184:187], v1 offset:320
    s_mov_b32 m0, 145792
    s_nop 0
    buffer_load_dwordx4 v8, s[16:19], s36 offen offset:2048 nt lds
    ds_write_b128 v2, v[112:115] offset:7168
    v_add_f32 v6, v6, v120
    v_mfma_f32_16x16x32_bf16 v[84:87], v[196:199], v[40:43], v[84:87]
    ds_read_b128 v[188:191], v1 offset:832
    s_mov_b32 m0, 146336
    s_nop 0
    buffer_load_dwordx4 v8, s[16:19], s36 offen offset:2560 nt lds
    v_add_f32 v6, v6, v121
    v_add_f32 v6, v6, v122
    v_add_f32 v6, v6, v123
    s_waitcnt lgkmcnt(13)
    v_mfma_f32_16x16x32_bf16 v[80:83], v[200:203], v[44:47], v[80:83]
    ds_read_b128 v[192:195], v1 offset:384
    s_mov_b32 m0, 146880
    s_nop 0
    buffer_load_dwordx4 v8, s[16:19], s36 offen offset:3072 nt lds
    v_add_f32 v6, v6, v124
    v_add_f32 v6, v6, v125
    v_mfma_f32_16x16x32_bf16 v[84:87], v[204:207], v[44:47], v[84:87]
    ds_read_b128 v[196:199], v1 offset:896
    s_mov_b32 m0, 147424
    s_nop 0
    buffer_load_dwordx4 v8, s[16:19], s36 offen offset:3584 nt lds
    s_add_u32 s36, s36, 12288
    v_add_f32 v6, v6, v126
    v_add_f32 v6, v6, v127
    s_waitcnt lgkmcnt(3)
    s_waitcnt vmcnt(16)
    s_barrier
    s_sub_u32 s38, s38, 1
    s_cmp_lg_u32 s38, 0
    s_cbranch_scc1 L_sloopb
    v_mfma_f32_16x16x32_bf16 v[96:99], v[144:147], v[16:19], v[136:139]
    ds_read_b128 v[200:203], v1 offset:448
    v_mfma_f32_16x16x32_bf16 v[100:103], v[148:151], v[16:19], v[136:139]
    ds_read_b128 v[204:207], v1 offset:960
    v_mfma_f32_16x16x32_bf16 v[96:99], v[152:155], v[20:23], v[96:99]
    v_add_u32 v1, 33792, v1
    ds_read_b128 v[144:147], v1 offset:0
    v_mfma_f32_16x16x32_bf16 v[100:103], v[156:159], v[20:23], v[100:103]
    ds_read_b128 v[148:151], v1 offset:512
    v_mfma_f32_16x16x32_bf16 v[96:99], v[160:163], v[24:27], v[96:99]
    ds_read_b128 v[152:155], v1 offset:64
    v_exp_f32 v120, v80
    v_exp_f32 v121, v81
    v_exp_f32 v122, v82
    v_mfma_f32_16x16x32_bf16 v[100:103], v[164:167], v[24:27], v[100:103]
    ds_read_b128 v[156:159], v1 offset:576
    v_exp_f32 v123, v83
    v_cvt_pk_bf16_f32 v112, v120, v121
    v_mfma_f32_16x16x32_bf16 v[96:99], v[168:171], v[28:31], v[96:99]
    ds_read_b128 v[160:163], v1 offset:128
    v_exp_f32 v124, v84
    v_exp_f32 v125, v85
    v_cvt_pk_bf16_f32 v113, v122, v123
    v_mfma_f32_16x16x32_bf16 v[100:103], v[172:175], v[28:31], v[100:103]
    ds_read_b128 v[164:167], v1 offset:640
    v_exp_f32 v126, v86
    v_exp_f32 v127, v87
    v_mfma_f32_16x16x32_bf16 v[96:99], v[176:179], v[32:35], v[96:99]
    ds_read_b128 v[168:171], v1 offset:192
    v_cvt_pk_bf16_f32 v114, v124, v125
    v_cvt_pk_bf16_f32 v115, v126, v127
    v_or3_b32 v9, v112, v113, v114
    v_mfma_f32_16x16x32_bf16 v[100:103], v[180:183], v[32:35], v[100:103]
    ds_read_b128 v[172:175], v1 offset:704
    v_or_b32 v9, v9, v115
    v_and_b32 v9, s41, v9
    s_waitcnt lgkmcnt(12)
    v_mfma_f32_16x16x32_bf16 v[96:99], v[184:187], v[36:39], v[96:99]
    ds_read_b128 v[176:179], v1 offset:256
    v_cmp_ne_u32 vcc, 0, v9
    v_mfma_f32_16x16x32_bf16 v[100:103], v[188:191], v[36:39], v[100:103]
    ds_read_b128 v[180:183], v1 offset:768
    s_add_u32 s39, s39, 1
    s_cbranch_vccnz L_stub_sb_61
L_back_sb_61:
    s_waitcnt lgkmcnt(12)
    v_mfma_f32_16x16x32_bf16 v[96:99], v[192:195], v[40:43], v[96:99]
    ds_read_b128 v[184:187], v1 offset:320
    ds_write_b128 v2, v[112:115] offset:0
    v_add_f32 v6, v6, v120
    v_mfma_f32_16x16x32_bf16 v[100:103], v[196:199], v[40:43], v[100:103]
    ds_read_b128 v[188:191], v1 offset:832
    v_add_f32 v6, v6, v121
    v_add_f32 v6, v6, v122
    v_add_f32 v6, v6, v123
    s_waitcnt lgkmcnt(13)
    v_mfma_f32_16x16x32_bf16 v[96:99], v[200:203], v[44:47], v[96:99]
    ds_read_b128 v[192:195], v1 offset:384
    v_add_f32 v6, v6, v124
    v_add_f32 v6, v6, v125
    v_mfma_f32_16x16x32_bf16 v[100:103], v[204:207], v[44:47], v[100:103]
    ds_read_b128 v[196:199], v1 offset:896
    v_add_f32 v6, v6, v126
    v_add_f32 v6, v6, v127
    s_waitcnt lgkmcnt(3)
    s_waitcnt vmcnt(0)
    s_barrier
    v_mfma_f32_16x16x32_bf16 v[80:83], v[144:147], v[16:19], v[136:139]
    ds_read_b128 v[200:203], v1 offset:448
    v_mfma_f32_16x16x32_bf16 v[84:87], v[148:151], v[16:19], v[136:139]
    ds_read_b128 v[204:207], v1 offset:960
    v_mfma_f32_16x16x32_bf16 v[80:83], v[152:155], v[20:23], v[80:83]
    v_add_u32 v1, 33792, v1
    ds_read_b128 v[144:147], v1 offset:0
    v_mfma_f32_16x16x32_bf16 v[84:87], v[156:159], v[20:23], v[84:87]
    ds_read_b128 v[148:151], v1 offset:512
    v_mfma_f32_16x16x32_bf16 v[80:83], v[160:163], v[24:27], v[80:83]
    ds_read_b128 v[152:155], v1 offset:64
    v_exp_f32 v120, v96
    v_exp_f32 v121, v97
    v_exp_f32 v122, v98
    v_mfma_f32_16x16x32_bf16 v[84:87], v[164:167], v[24:27], v[84:87]
    ds_read_b128 v[156:159], v1 offset:576
    v_exp_f32 v123, v99
    v_cvt_pk_bf16_f32 v112, v120, v121
    v_mfma_f32_16x16x32_bf16 v[80:83], v[168:171], v[28:31], v[80:83]
    ds_read_b128 v[160:163], v1 offset:128
    v_exp_f32 v124, v100
    v_exp_f32 v125, v101
    v_cvt_pk_bf16_f32 v113, v122, v123
    v_mfma_f32_16x16x32_bf16 v[84:87], v[172:175], v[28:31], v[84:87]
    ds_read_b128 v[164:167], v1 offset:640
    v_exp_f32 v126, v102
    v_exp_f32 v127, v103
    v_mfma_f32_16x16x32_bf16 v[80:83], v[176:179], v[32:35], v[80:83]
    ds_read_b128 v[168:171], v1 offset:192
    v_cvt_pk_bf16_f32 v114, v124, v125
    v_cvt_pk_bf16_f32 v115, v126, v127
    v_or3_b32 v9, v112, v113, v114
    v_mfma_f32_16x16x32_bf16 v[84:87], v[180:183], v[32:35], v[84:87]
    ds_read_b128 v[172:175], v1 offset:704
    v_or_b32 v9, v9, v115
    v_and_b32 v9, s41, v9
    s_waitcnt lgkmcnt(12)
    v_mfma_f32_16x16x32_bf16 v[80:83], v[184:187], v[36:39], v[80:83]
    ds_read_b128 v[176:179], v1 offset:256
    v_cmp_ne_u32 vcc, 0, v9
    v_mfma_f32_16x16x32_bf16 v[84:87], v[188:191], v[36:39], v[84:87]
    ds_read_b128 v[180:183], v1 offset:768
    s_add_u32 s39, s39, 1
    s_cbranch_vccnz L_stub_sb_62
L_back_sb_62:
    s_waitcnt lgkmcnt(12)
    v_mfma_f32_16x16x32_bf16 v[80:83], v[192:195], v[40:43], v[80:83]
    ds_read_b128 v[184:187], v1 offset:320
    ds_write_b128 v2, v[112:115] offset:7168
    v_add_f32 v6, v6, v120
    v_mfma_f32_16x16x32_bf16 v[84:87], v[196:199], v[40:43], v[84:87]
    ds_read_b128 v[188:191], v1 offset:832
    v_add_f32 v6, v6, v121
    v_add_f32 v6, v6, v122
    v_add_f32 v6, v6, v123
    s_waitcnt lgkmcnt(13)
    v_mfma_f32_16x16x32_bf16 v[80:83], v[200:203], v[44:47], v[80:83]
    ds_read_b128 v[192:195], v1 offset:384
    v_add_f32 v6, v6, v124
    v_add_f32 v6, v6, v125
    v_mfma_f32_16x16x32_bf16 v[84:87], v[204:207], v[44:47], v[84:87]
    ds_read_b128 v[196:199], v1 offset:896
    v_add_f32 v6, v6, v126
    v_add_f32 v6, v6, v127
    s_waitcnt lgkmcnt(3)
    s_barrier
    v_mfma_f32_16x16x32_bf16 v[96:99], v[144:147], v[16:19], v[136:139]
    ds_read_b128 v[200:203], v1 offset:448
    v_mfma_f32_16x16x32_bf16 v[100:103], v[148:151], v[16:19], v[136:139]
    ds_read_b128 v[204:207], v1 offset:960
    v_mfma_f32_16x16x32_bf16 v[96:99], v[152:155], v[20:23], v[96:99]
    v_mfma_f32_16x16x32_bf16 v[100:103], v[156:159], v[20:23], v[100:103]
    v_mfma_f32_16x16x32_bf16 v[96:99], v[160:163], v[24:27], v[96:99]
    v_exp_f32 v120, v80
    v_exp_f32 v121, v81
    v_exp_f32 v122, v82
    v_mfma_f32_16x16x32_bf16 v[100:103], v[164:167], v[24:27], v[100:103]
    v_exp_f32 v123, v83
    v_cvt_pk_bf16_f32 v112, v120, v121
    v_mfma_f32_16x16x32_bf16 v[96:99], v[168:171], v[28:31], v[96:99]
    v_exp_f32 v124, v84
    v_exp_f32 v125, v85
    v_cvt_pk_bf16_f32 v113, v122, v123
    v_mfma_f32_16x16x32_bf16 v[100:103], v[172:175], v[28:31], v[100:103]
    v_exp_f32 v126, v86
    v_exp_f32 v127, v87
    v_mfma_f32_16x16x32_bf16 v[96:99], v[176:179], v[32:35], v[96:99]
    v_cvt_pk_bf16_f32 v114, v124, v125
    v_cvt_pk_bf16_f32 v115, v126, v127
    v_or3_b32 v9, v112, v113, v114
    v_mfma_f32_16x16x32_bf16 v[100:103], v[180:183], v[32:35], v[100:103]
    v_or_b32 v9, v9, v115
    v_and_b32 v9, s41, v9
    s_waitcnt lgkmcnt(4)
    v_mfma_f32_16x16x32_bf16 v[96:99], v[184:187], v[36:39], v[96:99]
    v_cmp_ne_u32 vcc, 0, v9
    v_mfma_f32_16x16x32_bf16 v[100:103], v[188:191], v[36:39], v[100:103]
    s_add_u32 s39, s39, 1
    s_cbranch_vccnz L_stub_sb_63
L_back_sb_63:
    s_waitcnt lgkmcnt(2)
    v_mfma_f32_16x16x32_bf16 v[96:99], v[192:195], v[40:43], v[96:99]
    ds_write_b128 v2, v[112:115] offset:0
    v_add_f32 v6, v6, v120
    v_mfma_f32_16x16x32_bf16 v[100:103], v[196:199], v[40:43], v[100:103]
    v_add_f32 v6, v6, v121
    v_add_f32 v6, v6, v122
    v_add_f32 v6, v6, v123
    s_waitcnt lgkmcnt(1)
    v_mfma_f32_16x16x32_bf16 v[96:99], v[200:203], v[44:47], v[96:99]
    v_add_f32 v6, v6, v124
    v_add_f32 v6, v6, v125
    v_mfma_f32_16x16x32_bf16 v[100:103], v[204:207], v[44:47], v[100:103]
    v_add_f32 v6, v6, v126
    v_add_f32 v6, v6, v127
    s_waitcnt lgkmcnt(0)
    s_nop 7
    s_barrier
    v_exp_f32 v120, v96
    v_exp_f32 v121, v97
    v_exp_f32 v122, v98
    v_exp_f32 v123, v99
    v_cvt_pk_bf16_f32 v112, v120, v121
    v_exp_f32 v124, v100
    v_exp_f32 v125, v101
    v_cvt_pk_bf16_f32 v113, v122, v123
    v_exp_f32 v126, v102
    v_exp_f32 v127, v103
    v_cvt_pk_bf16_f32 v114, v124, v125
    v_cvt_pk_bf16_f32 v115, v126, v127
    v_or3_b32 v9, v112, v113, v114
    v_or_b32 v9, v9, v115
    v_and_b32 v9, s41, v9
    v_cmp_ne_u32 vcc, 0, v9
    s_add_u32 s39, s39, 1
    s_cbranch_vccnz L_stub_sb_64
L_back_sb_64:
    ds_write_b128 v2, v[112:115] offset:7168
    v_add_f32 v6, v6, v120
    v_add_f32 v6, v6, v121
    v_add_f32 v6, v6, v122
    v_add_f32 v6, v6, v123
    v_add_f32 v6, v6, v124
    v_add_f32 v6, v6, v125
    v_add_f32 v6, v6, v126
    v_add_f32 v6, v6, v127
    v_mov_b32 v9, v6
    s_nop 1
    v_permlane16_swap_b32 v6, v9
    v_add_f32 v6, v6, v9
    v_mov_b32 v9, v6
    s_nop 1
    v_permlane32_swap_b32 v6, v9
    v_add_f32 v6, v6, v9
    v_rcp_f32 v6, v6
    s_nop 0
    ds_write_b32 v3, v6 offset:1024
    s_waitcnt lgkmcnt(0)
    s_barrier
    s_lshr_b32 s44, s2, 5
    s_lshl_b32 s44, s44, 5
    v_mov_b32 v6, s44
    s_and_b32 s42, s2, 4
    s_lshl_b32 s42, 0x0f0f0f0f, s42
    s_mov_b32 s45, 0x8000
L_poll0:
    global_load_dword v7, v6, s[56:57] sc1
    s_waitcnt vmcnt(0)
    v_readfirstlane_b32 s44, v7
    s_nop 4
    s_and_b32 s44, s44, s42
    s_cmp_eq_u32 s44, s42
    s_cbranch_scc1 L_polled0
    s_sleep 2
    s_sub_u32 s45, s45, 1
    s_cmp_lg_u32 s45, 0
    s_cbranch_scc1 L_poll0
L_polled0:
L_sjoin:
    s_barrier
    v_lshlrev_b32 v3, 4, v0
    v_and_b32 v2, 15, v0
    v_lshlrev_b32 v2, 2, v2
    v_add_u32 v2, 161536, v2
    ds_read_b32 v4, v2 offset:0
    ds_read_b32 v5, v2 offset:64
    ds_read_b32 v6, v2 offset:128
    ds_read_b32 v7, v2 offset:192
    v_lshrrev_b32 v1, 2, v0
    v_mul_u32_u24 v1, 1056, v1
    v_and_b32 v2, 3, v0
    v_lshl_add_u32 v1, v2, 3, v1
    s_lshl_b32 s42, s33, 5
    v_add_u32 v1, s42, v1
    s_lshl_b32 s42, s32, 11
    v_add_u32 v2, s42, v3
    s_mov_b32 s48, s6
    s_setprio 1
    v_add_u32 v1, 50688, v1
    ds_read_b64_tr_b16 v[12:13], v1 offset:0
    ds_read_b64_tr_b16 v[14:15], v1 offset:128
    ds_read_b128 v[72:75], v3 offset:16896
    ds_read_b128 v[104:107], v3 offset:25088
    ds_read_b128 v[136:139], v3 offset:33792
    ds_read_b128 v[168:171], v3 offset:41984
    ds_read_b64_tr_b16 v[16:17], v1 offset:256
    ds_read_b64_tr_b16 v[18:19], v1 offset:384
    ds_read_b128 v[76:79], v3 offset:17920
    ds_read_b128 v[108:111], v3 offset:26112
    ds_read_b128 v[140:143], v3 offset:34816
    ds_read_b128 v[172:175], v3 offset:43008
    ds_read_b64_tr_b16 v[20:21], v1 offset:512
    ds_read_b64_tr_b16 v[22:23], v1 offset:640
    ds_read_b64_tr_b16 v[24:25], v1 offset:768
    ds_read_b64_tr_b16 v[26:27], v1 offset:896
    s_waitcnt lgkmcnt(13)
    v_mfma_f32_16x16x32_bf16 v[40:43], v[12:15], v[72:75], 0
    s_waitcnt lgkmcnt(12)
    v_mfma_f32_16x16x32_bf16 v[44:47], v[12:15], v[104:107], 0
    s_waitcnt lgkmcnt(11)
    v_mfma_f32_16x16x32_bf16 v[48:51], v[12:15], v[136:139], 0
    s_waitcnt lgkmcnt(10)
    v_mfma_f32_16x16x32_bf16 v[52:55], v[12:15], v[168:171], 0
    ds_read_b128 v[80:83], v3 offset:18944
    ds_read_b128 v[112:115], v3 offset:27136
    ds_read_b128 v[144:147], v3 offset:35840
    ds_read_b128 v[176:179], v3 offset:44032
    v_add_u32 v1, 16896, v1
    ds_read_b64_tr_b16 v[12:13], v1 offset:0
    ds_read_b64_tr_b16 v[14:15], v1 offset:128
    s_waitcnt lgkmcnt(13)
    v_mfma_f32_16x16x32_bf16 v[40:43], v[16:19], v[76:79], v[40:43]
    s_waitcnt lgkmcnt(12)
    v_mfma_f32_16x16x32_bf16 v[44:47], v[16:19], v[108:111], v[44:47]
    s_waitcnt lgkmcnt(11)
    v_mfma_f32_16x16x32_bf16 v[48:51], v[16:19], v[140:143], v[48:51]
    s_waitcnt lgkmcnt(10)
    v_mfma_f32_16x16x32_bf16 v[52:55], v[16:19], v[172:175], v[52:55]
    ds_read_b128 v[84:87], v3 offset:19968
    ds_read_b128 v[116:119], v3 offset:28160
    ds_read_b128 v[148:151], v3 offset:36864
    ds_read_b128 v[180:183], v3 offset:45056
    ds_read_b64_tr_b16 v[16:17], v1 offset:256
    ds_read_b64_tr_b16 v[18:19], v1 offset:384
    s_waitcnt lgkmcnt(11)
    v_mfma_f32_16x16x32_bf16 v[40:43], v[20:23], v[80:83], v[40:43]
    s_waitcnt lgkmcnt(10)
    v_mfma_f32_16x16x32_bf16 v[44:47], v[20:23], v[112:115], v[44:47]
    s_waitcnt lgkmcnt(9)
    v_mfma_f32_16x16x32_bf16 v[48:51], v[20:23], v[144:147], v[48:51]
    s_waitcnt lgkmcnt(8)
    v_mfma_f32_16x16x32_bf16 v[52:55], v[20:23], v[176:179], v[52:55]
    ds_read_b128 v[88:91], v3 offset:20992
    ds_read_b128 v[120:123], v3 offset:29184
    ds_read_b128 v[152:155], v3 offset:37888
    ds_read_b128 v[184:187], v3 offset:46080
    ds_read_b64_tr_b16 v[20:21], v1 offset:512
    ds_read_b64_tr_b16 v[22:23], v1 offset:640
    s_waitcnt lgkmcnt(11)
    v_mfma_f32_16x16x32_bf16 v[40:43], v[24:27], v[84:87], v[40:43]
    s_waitcnt lgkmcnt(10)
    v_mfma_f32_16x16x32_bf16 v[44:47], v[24:27], v[116:119], v[44:47]
    s_waitcnt lgkmcnt(9)
    v_mfma_f32_16x16x32_bf16 v[48:51], v[24:27], v[148:151], v[48:51]
    s_waitcnt lgkmcnt(8)
    v_mfma_f32_16x16x32_bf16 v[52:55], v[24:27], v[180:183], v[52:55]
    ds_read_b128 v[92:95], v3 offset:22016
    ds_read_b128 v[124:127], v3 offset:30208
    ds_read_b128 v[156:159], v3 offset:38912
    ds_read_b128 v[188:191], v3 offset:47104
    ds_read_b64_tr_b16 v[24:25], v1 offset:768
    ds_read_b64_tr_b16 v[26:27], v1 offset:896
    s_waitcnt lgkmcnt(11)
    v_mfma_f32_16x16x32_bf16 v[40:43], v[12:15], v[88:91], v[40:43]
    s_waitcnt lgkmcnt(10)
    v_mfma_f32_16x16x32_bf16 v[44:47], v[12:15], v[120:123], v[44:47]
    s_waitcnt lgkmcnt(9)
    v_mfma_f32_16x16x32_bf16 v[48:51], v[12:15], v[152:155], v[48:51]
    s_waitcnt lgkmcnt(8)
    v_mfma_f32_16x16x32_bf16 v[52:55], v[12:15], v[184:187], v[52:55]
    ds_read_b128 v[96:99], v3 offset:23040
    ds_read_b128 v[128:131], v3 offset:31232
    ds_read_b128 v[160:163], v3 offset:39936
    ds_read_b128 v[192:195], v3 offset:48128
    v_add_u32 v1, 33792, v1
    ds_read_b64_tr_b16 v[12:13], v1 offset:0
    ds_read_b64_tr_b16 v[14:15], v1 offset:128
    s_waitcnt lgkmcnt(11)
    v_mfma_f32_16x16x32_bf16 v[40:43], v[16:19], v[92:95], v[40:43]
    s_waitcnt lgkmcnt(10)
    v_mfma_f32_16x16x32_bf16 v[44:47], v[16:19], v[124:127], v[44:47]
    s_waitcnt lgkmcnt(9)
    v_mfma_f32_16x16x32_bf16 v[48:51], v[16:19], v[156:159], v[48:51]
    s_waitcnt lgkmcnt(8)
    v_mfma_f32_16x16x32_bf16 v[52:55], v[16:19], v[188:191], v[52:55]
    ds_read_b128 v[100:103], v3 offset:24064
    ds_read_b128 v[132:135], v3 offset:32256
    ds_read_b128 v[164:167], v3 offset:40960
    ds_read_b128 v[196:199], v3 offset:49152
    ds_read_b64_tr_b16 v[16:17], v1 offset:256
    ds_read_b64_tr_b16 v[18:19], v1 offset:384
    s_waitcnt lgkmcnt(11)
    v_mfma_f32_16x16x32_bf16 v[40:43], v[20:23], v[96:99], v[40:43]
    s_waitcnt lgkmcnt(10)
    v_mfma_f32_16x16x32_bf16 v[44:47], v[20:23], v[128:131], v[44:47]
    s_waitcnt lgkmcnt(9)
    v_mfma_f32_16x16x32_bf16 v[48:51], v[20:23], v[160:163], v[48:51]
    s_waitcnt lgkmcnt(8)
    v_mfma_f32_16x16x32_bf16 v[52:55], v[20:23], v[192:195], v[52:55]
    ds_read_b64_tr_b16 v[20:21], v1 offset:512
    ds_read_b64_tr_b16 v[22:23], v1 offset:640
    s_waitcnt lgkmcnt(7)
    v_mfma_f32_16x16x32_bf16 v[40:43], v[24:27], v[100:103], v[40:43]
    s_waitcnt lgkmcnt(6)
    v_mfma_f32_16x16x32_bf16 v[44:47], v[24:27], v[132:135], v[44:47]
    s_waitcnt lgkmcnt(5)
    v_mfma_f32_16x16x32_bf16 v[48:51], v[24:27], v[164:167], v[48:51]
    s_waitcnt lgkmcnt(4)
    v_mfma_f32_16x16x32_bf16 v[52:55], v[24:27], v[196:199], v[52:55]
    ds_read_b64_tr_b16 v[24:25], v1 offset:768
    ds_read_b64_tr_b16 v[26:27], v1 offset:896
    s_barrier
    v_mfma_f32_16x16x32_bf16 v[56:59], v[12:15], v[72:75], 0
    v_mfma_f32_16x16x32_bf16 v[60:63], v[12:15], v[104:107], 0
    v_mfma_f32_16x16x32_bf16 v[64:67], v[12:15], v[136:139], 0
    v_mfma_f32_16x16x32_bf16 v[68:71], v[12:15], v[168:171], 0
    v_add_u32 v1, 33792, v1
    ds_read_b64_tr_b16 v[12:13], v1 offset:0
    ds_read_b64_tr_b16 v[14:15], v1 offset:128
    s_waitcnt lgkmcnt(6)
    v_mfma_f32_16x16x32_bf16 v[56:59], v[16:19], v[76:79], v[56:59]
    v_mul_f32 v40, v4, v40
    v_mul_f32 v41, v4, v41
    v_mul_f32 v42, v4, v42
    v_mul_f32 v43, v4, v43
    v_mfma_f32_16x16x32_bf16 v[60:63], v[16:19], v[108:111], v[60:63]
    v_cvt_pk_bf16_f32 v28, v40, v41
    v_cvt_pk_bf16_f32 v29, v42, v43
    v_mul_f32 v44, v5, v44
    v_mfma_f32_16x16x32_bf16 v[64:67], v[16:19], v[140:143], v[64:67]
    v_mul_f32 v45, v5, v45
    v_mul_f32 v46, v5, v46
    v_mul_f32 v47, v5, v47
    v_mfma_f32_16x16x32_bf16 v[68:71], v[16:19], v[172:175], v[68:71]
    ds_read_b64_tr_b16 v[16:17], v1 offset:256
    ds_read_b64_tr_b16 v[18:19], v1 offset:384
    v_cvt_pk_bf16_f32 v30, v44, v45
    v_cvt_pk_bf16_f32 v31, v46, v47
    v_mul_f32 v48, v6, v48
    s_waitcnt lgkmcnt(6)
    v_mfma_f32_16x16x32_bf16 v[56:59], v[20:23], v[80:83], v[56:59]
    v_mul_f32 v49, v6, v49
    v_mul_f32 v50, v6, v50
    v_mul_f32 v51, v6, v51
    v_mfma_f32_16x16x32_bf16 v[60:63], v[20:23], v[112:115], v[60:63]
    v_cvt_pk_bf16_f32 v32, v48, v49
    v_cvt_pk_bf16_f32 v33, v50, v51
    v_mul_f32 v52, v7, v52
    v_mfma_f32_16x16x32_bf16 v[64:67], v[20:23], v[144:147], v[64:67]
    v_mul_f32 v53, v7, v53
    v_mul_f32 v54, v7, v54
    v_mul_f32 v55, v7, v55
    v_mfma_f32_16x16x32_bf16 v[68:71], v[20:23], v[176:179], v[68:71]
    ds_read_b64_tr_b16 v[20:21], v1 offset:512
    ds_read_b64_tr_b16 v[22:23], v1 offset:640
    v_cvt_pk_bf16_f32 v34, v52, v53
    v_cvt_pk_bf16_f32 v35, v54, v55
    s_lshl_b32 s42, s48, 14
    s_add_u32 s48, s48, 1
    buffer_store_dwordx4 v[28:31], v2, s[28:31], s42 offen sc1
    buffer_store_dwordx4 v[32:35], v2, s[28:31], s42 offen offset:1024 sc1
    s_cmp_eq_u32 s48, 7
    s_cselect_b32 s48, 0, s48
    s_waitcnt lgkmcnt(6)
    v_mfma_f32_16x16x32_bf16 v[56:59], v[24:27], v[84:87], v[56:59]
    v_mfma_f32_16x16x32_bf16 v[60:63], v[24:27], v[116:119], v[60:63]
    v_mfma_f32_16x16x32_bf16 v[64:67], v[24:27], v[148:151], v[64:67]
    v_mfma_f32_16x16x32_bf16 v[68:71], v[24:27], v[180:183], v[68:71]
    ds_read_b64_tr_b16 v[24:25], v1 offset:768
    ds_read_b64_tr_b16 v[26:27], v1 offset:896
    s_waitcnt lgkmcnt(6)
    v_mfma_f32_16x16x32_bf16 v[56:59], v[12:15], v[88:91], v[56:59]
    v_mfma_f32_16x16x32_bf16 v[60:63], v[12:15], v[120:123], v[60:63]
    v_mfma_f32_16x16x32_bf16 v[64:67], v[12:15], v[152:155], v[64:67]
    v_mfma_f32_16x16x32_bf16 v[68:71], v[12:15], v[184:187], v[68:71]
    v_add_u32 v1, 4294916608, v1
    ds_read_b64_tr_b16 v[12:13], v1 offset:0
    ds_read_b64_tr_b16 v[14:15], v1 offset:128
    s_waitcnt lgkmcnt(6)
    v_mfma_f32_16x16x32_bf16 v[56:59], v[16:19], v[92:95], v[56:59]
    v_mfma_f32_16x16x32_bf16 v[60:63], v[16:19], v[124:127], v[60:63]
    v_mfma_f32_16x16x32_bf16 v[64:67], v[16:19], v[156:159], v[64:67]
    v_mfma_f32_16x16x32_bf16 v[68:71], v[16:19], v[188:191], v[68:71]
    ds_read_b64_tr_b16 v[16:17], v1 offset:256
    ds_read_b64_tr_b16 v[18:19], v1 offset:384
    s_waitcnt lgkmcnt(6)
    v_mfma_f32_16x16x32_bf16 v[56:59], v[20:23], v[96:99], v[56:59]
    v_mfma_f32_16x16x32_bf16 v[60:63], v[20:23], v[128:131], v[60:63]
    v_mfma_f32_16x16x32_bf16 v[64:67], v[20:23], v[160:163], v[64:67]
    v_mfma_f32_16x16x32_bf16 v[68:71], v[20:23], v[192:195], v[68:71]
    ds_read_b64_tr_b16 v[20:21], v1 offset:512
    ds_read_b64_tr_b16 v[22:23], v1 offset:640
    s_waitcnt lgkmcnt(6)
    v_mfma_f32_16x16x32_bf16 v[56:59], v[24:27], v[100:103], v[56:59]
    v_mfma_f32_16x16x32_bf16 v[60:63], v[24:27], v[132:135], v[60:63]
    v_mfma_f32_16x16x32_bf16 v[64:67], v[24:27], v[164:167], v[64:67]
    v_mfma_f32_16x16x32_bf16 v[68:71], v[24:27], v[196:199], v[68:71]
    ds_read_b64_tr_b16 v[24:25], v1 offset:768
    ds_read_b64_tr_b16 v[26:27], v1 offset:896
    s_barrier
    s_waitcnt lgkmcnt(6)
    v_mfma_f32_16x16x32_bf16 v[40:43], v[12:15], v[72:75], 0
    v_mfma_f32_16x16x32_bf16 v[44:47], v[12:15], v[104:107], 0
    v_mfma_f32_16x16x32_bf16 v[48:51], v[12:15], v[136:139], 0
    v_mfma_f32_16x16x32_bf16 v[52:55], v[12:15], v[168:171], 0
    v_add_u32 v1, 4294882816, v1
    ds_read_b64_tr_b16 v[12:13], v1 offset:0
    ds_read_b64_tr_b16 v[14:15], v1 offset:128
    s_waitcnt lgkmcnt(6)
    v_mfma_f32_16x16x32_bf16 v[40:43], v[16:19], v[76:79], v[40:43]
    v_mul_f32 v56, v4, v56
    v_mul_f32 v57, v4, v57
    v_mul_f32 v58, v4, v58
    v_mul_f32 v59, v4, v59
    v_mfma_f32_16x16x32_bf16 v[44:47], v[16:19], v[108:111], v[44:47]
    v_cvt_pk_bf16_f32 v28, v56, v57
    v_cvt_pk_bf16_f32 v29, v58, v59
    v_mul_f32 v60, v5, v60
    v_mfma_f32_16x16x32_bf16 v[48:51], v[16:19], v[140:143], v[48:51]
    v_mul_f32 v61, v5, v61
    v_mul_f32 v62, v5, v62
    v_mul_f32 v63, v5, v63
    v_mfma_f32_16x16x32_bf16 v[52:55], v[16:19], v[172:175], v[52:55]
    ds_read_b64_tr_b16 v[16:17], v1 offset:256
    ds_read_b64_tr_b16 v[18:19], v1 offset:384
    v_cvt_pk_bf16_f32 v30, v60, v61
    v_cvt_pk_bf16_f32 v31, v62, v63
    v_mul_f32 v64, v6, v64
    s_waitcnt lgkmcnt(6)
    v_mfma_f32_16x16x32_bf16 v[40:43], v[20:23], v[80:83], v[40:43]
    v_mul_f32 v65, v6, v65
    v_mul_f32 v66, v6, v66
    v_mul_f32 v67, v6, v67
    v_mfma_f32_16x16x32_bf16 v[44:47], v[20:23], v[112:115], v[44:47]
    v_cvt_pk_bf16_f32 v32, v64, v65
    v_cvt_pk_bf16_f32 v33, v66, v67
    v_mul_f32 v68, v7, v68
    v_mfma_f32_16x16x32_bf16 v[48:51], v[20:23], v[144:147], v[48:51]
    v_mul_f32 v69, v7, v69
    v_mul_f32 v70, v7, v70
    v_mul_f32 v71, v7, v71
    v_mfma_f32_16x16x32_bf16 v[52:55], v[20:23], v[176:179], v[52:55]
    ds_read_b64_tr_b16 v[20:21], v1 offset:512
    ds_read_b64_tr_b16 v[22:23], v1 offset:640
    v_cvt_pk_bf16_f32 v34, v68, v69
    v_cvt_pk_bf16_f32 v35, v70, v71
    s_lshl_b32 s42, s48, 14
    s_add_u32 s48, s48, 1
    buffer_store_dwordx4 v[28:31], v2, s[28:31], s42 offen sc1
    buffer_store_dwordx4 v[32:35], v2, s[28:31], s42 offen offset:1024 sc1
    s_cmp_eq_u32 s48, 7
    s_cselect_b32 s48, 0, s48
    s_waitcnt lgkmcnt(6)
    v_mfma_f32_16x16x32_bf16 v[40:43], v[24:27], v[84:87], v[40:43]
    v_mfma_f32_16x16x32_bf16 v[44:47], v[24:27], v[116:119], v[44:47]
    v_mfma_f32_16x16x32_bf16 v[48:51], v[24:27], v[148:151], v[48:51]
    v_mfma_f32_16x16x32_bf16 v[52:55], v[24:27], v[180:183], v[52:55]
    ds_read_b64_tr_b16 v[24:25], v1 offset:768
    ds_read_b64_tr_b16 v[26:27], v1 offset:896
    s_waitcnt lgkmcnt(6)
    v_mfma_f32_16x16x32_bf16 v[40:43], v[12:15], v[88:91], v[40:43]
    v_mfma_f32_16x16x32_bf16 v[44:47], v[12:15], v[120:123], v[44:47]
    v_mfma_f32_16x16x32_bf16 v[48:51], v[12:15], v[152:155], v[48:51]
    v_mfma_f32_16x16x32_bf16 v[52:55], v[12:15], v[184:187], v[52:55]
    v_add_u32 v1, 118272, v1
    ds_read_b64_tr_b16 v[12:13], v1 offset:0
    ds_read_b64_tr_b16 v[14:15], v1 offset:128
    s_waitcnt lgkmcnt(6)
    v_mfma_f32_16x16x32_bf16 v[40:43], v[16:19], v[92:95], v[40:43]
    v_mfma_f32_16x16x32_bf16 v[44:47], v[16:19], v[124:127], v[44:47]
    v_mfma_f32_16x16x32_bf16 v[48:51], v[16:19], v[156:159], v[48:51]
    v_mfma_f32_16x16x32_bf16 v[52:55], v[16:19], v[188:191], v[52:55]
    ds_read_b64_tr_b16 v[16:17], v1 offset:256
    ds_read_b64_tr_b16 v[18:19], v1 offset:384
    s_waitcnt lgkmcnt(6)
    v_mfma_f32_16x16x32_bf16 v[40:43], v[20:23], v[96:99], v[40:43]
    v_mfma_f32_16x16x32_bf16 v[44:47], v[20:23], v[128:131], v[44:47]
    v_mfma_f32_16x16x32_bf16 v[48:51], v[20:23], v[160:163], v[48:51]
    v_mfma_f32_16x16x32_bf16 v[52:55], v[20:23], v[192:195], v[52:55]
    ds_read_b64_tr_b16 v[20:21], v1 offset:512
    ds_read_b64_tr_b16 v[22:23], v1 offset:640
    s_waitcnt lgkmcnt(6)
    v_mfma_f32_16x16x32_bf16 v[40:43], v[24:27], v[100:103], v[40:43]
    v_mfma_f32_16x16x32_bf16 v[44:47], v[24:27], v[132:135], v[44:47]
    v_mfma_f32_16x16x32_bf16 v[48:51], v[24:27], v[164:167], v[48:51]
    v_mfma_f32_16x16x32_bf16 v[52:55], v[24:27], v[196:199], v[52:55]
    ds_read_b64_tr_b16 v[24:25], v1 offset:768
    ds_read_b64_tr_b16 v[26:27], v1 offset:896
    s_barrier
    s_waitcnt lgkmcnt(6)
    v_mfma_f32_16x16x32_bf16 v[56:59], v[12:15], v[72:75], 0
    v_mfma_f32_16x16x32_bf16 v[60:63], v[12:15], v[104:107], 0
    v_mfma_f32_16x16x32_bf16 v[64:67], v[12:15], v[136:139], 0
    v_mfma_f32_16x16x32_bf16 v[68:71], v[12:15], v[168:171], 0
    v_add_u32 v1, 4294865920, v1
    ds_read_b64_tr_b16 v[12:13], v1 offset:0
    ds_read_b64_tr_b16 v[14:15], v1 offset:128
    s_waitcnt lgkmcnt(6)
    v_mfma_f32_16x16x32_bf16 v[56:59], v[16:19], v[76:79], v[56:59]
    v_mul_f32 v40, v4, v40
    v_mul_f32 v41, v4, v41
    v_mul_f32 v42, v4, v42
    v_mul_f32 v43, v4, v43
    v_mfma_f32_16x16x32_bf16 v[60:63], v[16:19], v[108:111], v[60:63]
    v_cvt_pk_bf16_f32 v28, v40, v41
    v_cvt_pk_bf16_f32 v29, v42, v43
    v_mul_f32 v44, v5, v44
    v_mfma_f32_16x16x32_bf16 v[64:67], v[16:19], v[140:143], v[64:67]
    v_mul_f32 v45, v5, v45
    v_mul_f32 v46, v5, v46
    v_mul_f32 v47, v5, v47
    v_mfma_f32_16x16x32_bf16 v[68:71], v[16:19], v[172:175], v[68:71]
    ds_read_b64_tr_b16 v[16:17], v1 offset:256
    ds_read_b64_tr_b16 v[18:19], v1 offset:384
    v_cvt_pk_bf16_f32 v30, v44, v45
    v_cvt_pk_bf16_f32 v31, v46, v47
    v_mul_f32 v48, v6, v48
    s_waitcnt lgkmcnt(6)
    v_mfma_f32_16x16x32_bf16 v[56:59], v[20:23], v[80:83], v[56:59]
    v_mul_f32 v49, v6, v49
    v_mul_f32 v50, v6, v50
    v_mul_f32 v51, v6, v51
    v_mfma_f32_16x16x32_bf16 v[60:63], v[20:23], v[112:115], v[60:63]
    v_cvt_pk_bf16_f32 v32, v48, v49
    v_cvt_pk_bf16_f32 v33, v50, v51
    v_mul_f32 v52, v7, v52
    v_mfma_f32_16x16x32_bf16 v[64:67], v[20:23], v[144:147], v[64:67]
    v_mul_f32 v53, v7, v53
    v_mul_f32 v54, v7, v54
    v_mul_f32 v55, v7, v55
    v_mfma_f32_16x16x32_bf16 v[68:71], v[20:23], v[176:179], v[68:71]
    ds_read_b64_tr_b16 v[20:21], v1 offset:512
    ds_read_b64_tr_b16 v[22:23], v1 offset:640
    v_cvt_pk_bf16_f32 v34, v52, v53
    v_cvt_pk_bf16_f32 v35, v54, v55
    s_lshl_b32 s42, s48, 14
    s_add_u32 s48, s48, 1
    buffer_store_dwordx4 v[28:31], v2, s[28:31], s42 offen sc1
    buffer_store_dwordx4 v[32:35], v2, s[28:31], s42 offen offset:1024 sc1
    s_cmp_eq_u32 s48, 7
    s_cselect_b32 s48, 0, s48
    s_waitcnt lgkmcnt(6)
    v_mfma_f32_16x16x32_bf16 v[56:59], v[24:27], v[84:87], v[56:59]
    v_mfma_f32_16x16x32_bf16 v[60:63], v[24:27], v[116:119], v[60:63]
    v_mfma_f32_16x16x32_bf16 v[64:67], v[24:27], v[148:151], v[64:67]
    v_mfma_f32_16x16x32_bf16 v[68:71], v[24:27], v[180:183], v[68:71]
    ds_read_b64_tr_b16 v[24:25], v1 offset:768
    ds_read_b64_tr_b16 v[26:27], v1 offset:896
    s_waitcnt lgkmcnt(6)
    v_mfma_f32_16x16x32_bf16 v[56:59], v[12:15], v[88:91], v[56:59]
    v_mfma_f32_16x16x32_bf16 v[60:63], v[12:15], v[120:123], v[60:63]
    v_mfma_f32_16x16x32_bf16 v[64:67], v[12:15], v[152:155], v[64:67]
    v_mfma_f32_16x16x32_bf16 v[68:71], v[12:15], v[184:187], v[68:71]
    v_add_u32 v1, 16896, v1
    ds_read_b64_tr_b16 v[12:13], v1 offset:0
    ds_read_b64_tr_b16 v[14:15], v1 offset:128
    s_waitcnt lgkmcnt(6)
    v_mfma_f32_16x16x32_bf16 v[56:59], v[16:19], v[92:95], v[56:59]
    v_mfma_f32_16x16x32_bf16 v[60:63], v[16:19], v[124:127], v[60:63]
    v_mfma_f32_16x16x32_bf16 v[64:67], v[16:19], v[156:159], v[64:67]
    v_mfma_f32_16x16x32_bf16 v[68:71], v[16:19], v[188:191], v[68:71]
    ds_read_b64_tr_b16 v[16:17], v1 offset:256
    ds_read_b64_tr_b16 v[18:19], v1 offset:384
    s_waitcnt lgkmcnt(6)
    v_mfma_f32_16x16x32_bf16 v[56:59], v[20:23], v[96:99], v[56:59]
    v_mfma_f32_16x16x32_bf16 v[60:63], v[20:23], v[128:131], v[60:63]
    v_mfma_f32_16x16x32_bf16 v[64:67], v[20:23], v[160:163], v[64:67]
    v_mfma_f32_16x16x32_bf16 v[68:71], v[20:23], v[192:195], v[68:71]
    ds_read_b64_tr_b16 v[20:21], v1 offset:512
    ds_read_b64_tr_b16 v[22:23], v1 offset:640
    s_waitcnt lgkmcnt(6)
    v_mfma_f32_16x16x32_bf16 v[56:59], v[24:27], v[100:103], v[56:59]
    v_mfma_f32_16x16x32_bf16 v[60:63], v[24:27], v[132:135], v[60:63]
    v_mfma_f32_16x16x32_bf16 v[64:67], v[24:27], v[164:167], v[64:67]
    v_mfma_f32_16x16x32_bf16 v[68:71], v[24:27], v[196:199], v[68:71]
    ds_read_b64_tr_b16 v[24:25], v1 offset:768
    ds_read_b64_tr_b16 v[26:27], v1 offset:896
    s_waitcnt vmcnt(2)
    s_barrier
    s_cmp_lg_u32 s32, 3
    s_cbranch_scc1 L_nofl1
    s_lshl_b32 s42, s5, 5
    s_add_u32 s42, s42, s4
    s_lshl_b32 s42, s42, 2
    s_add_u32 s42, s42, 31457280
    v_mov_b32 v10, s42
    v_mov_b32 v11, 1
    s_mov_b64 exec, 1
    global_store_dword v10, v11, s[58:59] sc1
    s_mov_b64 exec, -1
L_nofl1:
    s_waitcnt lgkmcnt(6)
    v_mfma_f32_16x16x32_bf16 v[40:43], v[12:15], v[72:75], 0
    v_mfma_f32_16x16x32_bf16 v[44:47], v[12:15], v[104:107], 0
    v_mfma_f32_16x16x32_bf16 v[48:51], v[12:15], v[136:139], 0
    v_mfma_f32_16x16x32_bf16 v[52:55], v[12:15], v[168:171], 0
    v_add_u32 v1, 16896, v1
    ds_read_b64_tr_b16 v[12:13], v1 offset:0
    ds_read_b64_tr_b16 v[14:15], v1 offset:128
    s_waitcnt lgkmcnt(6)
    v_mfma_f32_16x16x32_bf16 v[40:43], v[16:19], v[76:79], v[40:43]
    v_mul_f32 v56, v4, v56
    v_mul_f32 v57, v4, v57
    v_mul_f32 v58, v4, v58
    v_mul_f32 v59, v4, v59
    v_mfma_f32_16x16x32_bf16 v[44:47], v[16:19], v[108:111], v[44:47]
    v_cvt_pk_bf16_f32 v28, v56, v57
    v_cvt_pk_bf16_f32 v29, v58, v59
    v_mul_f32 v60, v5, v60
    v_mfma_f32_16x16x32_bf16 v[48:51], v[16:19], v[140:143], v[48:51]
    v_mul_f32 v61, v5, v61
    v_mul_f32 v62, v5, v62
    v_mul_f32 v63, v5, v63
    v_mfma_f32_16x16x32_bf16 v[52:55], v[16:19], v[172:175], v[52:55]
    ds_read_b64_tr_b16 v[16:17], v1 offset:256
    ds_read_b64_tr_b16 v[18:19], v1 offset:384
    v_cvt_pk_bf16_f32 v30, v60, v61
    v_cvt_pk_bf16_f32 v31, v62, v63
    v_mul_f32 v64, v6, v64
    s_waitcnt lgkmcnt(6)
    v_mfma_f32_16x16x32_bf16 v[40:43], v[20:23], v[80:83], v[40:43]
    v_mul_f32 v65, v6, v65
    v_mul_f32 v66, v6, v66
    v_mul_f32 v67, v6, v67
    v_mfma_f32_16x16x32_bf16 v[44:47], v[20:23], v[112:115], v[44:47]
    v_cvt_pk_bf16_f32 v32, v64, v65
    v_cvt_pk_bf16_f32 v33, v66, v67
    v_mul_f32 v68, v7, v68
    v_mfma_f32_16x16x32_bf16 v[48:51], v[20:23], v[144:147], v[48:51]
    v_mul_f32 v69, v7, v69
    v_mul_f32 v70, v7, v70
    v_mul_f32 v71, v7, v71
    v_mfma_f32_16x16x32_bf16 v[52:55], v[20:23], v[176:179], v[52:55]
    ds_read_b64_tr_b16 v[20:21], v1 offset:512
    ds_read_b64_tr_b16 v[22:23], v1 offset:640
    v_cvt_pk_bf16_f32 v34, v68, v69
    v_cvt_pk_bf16_f32 v35, v70, v71
    s_lshl_b32 s42, s48, 14
    s_add_u32 s48, s48, 1
    buffer_store_dwordx4 v[28:31], v2, s[28:31], s42 offen sc1
    buffer_store_dwordx4 v[32:35], v2, s[28:31], s42 offen offset:1024 sc1
    s_cmp_eq_u32 s48, 7
    s_cselect_b32 s48, 0, s48
    s_waitcnt lgkmcnt(6)
    v_mfma_f32_16x16x32_bf16 v[40:43], v[24:27], v[84:87], v[40:43]
    v_mfma_f32_16x16x32_bf16 v[44:47], v[24:27], v[116:119], v[44:47]
    v_mfma_f32_16x16x32_bf16 v[48:51], v[24:27], v[148:151], v[48:51]
    v_mfma_f32_16x16x32_bf16 v[52:55], v[24:27], v[180:183], v[52:55]
    ds_read_b64_tr_b16 v[24:25], v1 offset:768
    ds_read_b64_tr_b16 v[26:27], v1 offset:896
    s_waitcnt lgkmcnt(6)
    v_mfma_f32_16x16x32_bf16 v[40:43], v[12:15], v[88:91], v[40:43]
    v_mfma_f32_16x16x32_bf16 v[44:47], v[12:15], v[120:123], v[44:47]
    v_mfma_f32_16x16x32_bf16 v[48:51], v[12:15], v[152:155], v[48:51]
    v_mfma_f32_16x16x32_bf16 v[52:55], v[12:15], v[184:187], v[52:55]
    v_add_u32 v1, 16896, v1
    ds_read_b64_tr_b16 v[12:13], v1 offset:0
    ds_read_b64_tr_b16 v[14:15], v1 offset:128
    s_waitcnt lgkmcnt(6)
    v_mfma_f32_16x16x32_bf16 v[40:43], v[16:19], v[92:95], v[40:43]
    v_mfma_f32_16x16x32_bf16 v[44:47], v[16:19], v[124:127], v[44:47]
    v_mfma_f32_16x16x32_bf16 v[48:51], v[16:19], v[156:159], v[48:51]
    v_mfma_f32_16x16x32_bf16 v[52:55], v[16:19], v[188:191], v[52:55]
    ds_read_b64_tr_b16 v[16:17], v1 offset:256
    ds_read_b64_tr_b16 v[18:19], v1 offset:384
    s_waitcnt lgkmcnt(6)
    v_mfma_f32_16x16x32_bf16 v[40:43], v[20:23], v[96:99], v[40:43]
    v_mfma_f32_16x16x32_bf16 v[44:47], v[20:23], v[128:131], v[44:47]
    v_mfma_f32_16x16x32_bf16 v[48:51], v[20:23], v[160:163], v[48:51]
    v_mfma_f32_16x16x32_bf16 v[52:55], v[20:23], v[192:195], v[52:55]
    ds_read_b64_tr_b16 v[20:21], v1 offset:512
    ds_read_b64_tr_b16 v[22:23], v1 offset:640
    s_waitcnt lgkmcnt(6)
    v_mfma_f32_16x16x32_bf16 v[40:43], v[24:27], v[100:103], v[40:43]
    v_mfma_f32_16x16x32_bf16 v[44:47], v[24:27], v[132:135], v[44:47]
    v_mfma_f32_16x16x32_bf16 v[48:51], v[24:27], v[164:167], v[48:51]
    v_mfma_f32_16x16x32_bf16 v[52:55], v[24:27], v[196:199], v[52:55]
    ds_read_b64_tr_b16 v[24:25], v1 offset:768
    ds_read_b64_tr_b16 v[26:27], v1 offset:896
    s_barrier
    s_waitcnt lgkmcnt(6)
    v_mfma_f32_16x16x32_bf16 v[56:59], v[12:15], v[72:75], 0
    v_mfma_f32_16x16x32_bf16 v[60:63], v[12:15], v[104:107], 0
    v_mfma_f32_16x16x32_bf16 v[64:67], v[12:15], v[136:139], 0
    v_mfma_f32_16x16x32_bf16 v[68:71], v[12:15], v[168:171], 0
    v_add_u32 v1, 33792, v1
    ds_read_b64_tr_b16 v[12:13], v1 offset:0
    ds_read_b64_tr_b16 v[14:15], v1 offset:128
    s_waitcnt lgkmcnt(6)
    v_mfma_f32_16x16x32_bf16 v[56:59], v[16:19], v[76:79], v[56:59]
    v_mul_f32 v40, v4, v40
    v_mul_f32 v41, v4, v41
    v_mul_f32 v42, v4, v42
    v_mul_f32 v43, v4, v43
    v_mfma_f32_16x16x32_bf16 v[60:63], v[16:19], v[108:111], v[60:63]
    v_cvt_pk_bf16_f32 v28, v40, v41
    v_cvt_pk_bf16_f32 v29, v42, v43
    v_mul_f32 v44, v5, v44
    v_mfma_f32_16x16x32_bf16 v[64:67], v[16:19], v[140:143], v[64:67]
    v_mul_f32 v45, v5, v45
    v_mul_f32 v46, v5, v46
    v_mul_f32 v47, v5, v47
    v_mfma_f32_16x16x32_bf16 v[68:71], v[16:19], v[172:175], v[68:71]
    ds_read_b64_tr_b16 v[16:17], v1 offset:256
    ds_read_b64_tr_b16 v[18:19], v1 offset:384
    v_cvt_pk_bf16_f32 v30, v44, v45
    v_cvt_pk_bf16_f32 v31, v46, v47
    v_mul_f32 v48, v6, v48
    s_waitcnt lgkmcnt(6)
    v_mfma_f32_16x16x32_bf16 v[56:59], v[20:23], v[80:83], v[56:59]
    v_mul_f32 v49, v6, v49
    v_mul_f32 v50, v6, v50
    v_mul_f32 v51, v6, v51
    v_mfma_f32_16x16x32_bf16 v[60:63], v[20:23], v[112:115], v[60:63]
    v_cvt_pk_bf16_f32 v32, v48, v49
    v_cvt_pk_bf16_f32 v33, v50, v51
    v_mul_f32 v52, v7, v52
    v_mfma_f32_16x16x32_bf16 v[64:67], v[20:23], v[144:147], v[64:67]
    v_mul_f32 v53, v7, v53
    v_mul_f32 v54, v7, v54
    v_mul_f32 v55, v7, v55
    v_mfma_f32_16x16x32_bf16 v[68:71], v[20:23], v[176:179], v[68:71]
    ds_read_b64_tr_b16 v[20:21], v1 offset:512
    ds_read_b64_tr_b16 v[22:23], v1 offset:640
    v_cvt_pk_bf16_f32 v34, v52, v53
    v_cvt_pk_bf16_f32 v35, v54, v55
    s_lshl_b32 s42, s48, 14
    s_add_u32 s48, s48, 1
    buffer_store_dwordx4 v[28:31], v2, s[28:31], s42 offen sc1
    buffer_store_dwordx4 v[32:35], v2, s[28:31], s42 offen offset:1024 sc1
    s_cmp_eq_u32 s48, 7
    s_cselect_b32 s48, 0, s48
    s_waitcnt lgkmcnt(6)
    v_mfma_f32_16x16x32_bf16 v[56:59], v[24:27], v[84:87], v[56:59]
    v_mfma_f32_16x16x32_bf16 v[60:63], v[24:27], v[116:119], v[60:63]
    v_mfma_f32_16x16x32_bf16 v[64:67], v[24:27], v[148:151], v[64:67]
    v_mfma_f32_16x16x32_bf16 v[68:71], v[24:27], v[180:183], v[68:71]
    ds_read_b64_tr_b16 v[24:25], v1 offset:768
    ds_read_b64_tr_b16 v[26:27], v1 offset:896
    s_waitcnt lgkmcnt(6)
    v_mfma_f32_16x16x32_bf16 v[56:59], v[12:15], v[88:91], v[56:59]
    v_mfma_f32_16x16x32_bf16 v[60:63], v[12:15], v[120:123], v[60:63]
    v_mfma_f32_16x16x32_bf16 v[64:67], v[12:15], v[152:155], v[64:67]
    v_mfma_f32_16x16x32_bf16 v[68:71], v[12:15], v[184:187], v[68:71]
    v_add_u32 v1, 33792, v1
    ds_read_b64_tr_b16 v[12:13], v1 offset:0
    ds_read_b64_tr_b16 v[14:15], v1 offset:128
    s_waitcnt lgkmcnt(6)
    v_mfma_f32_16x16x32_bf16 v[56:59], v[16:19], v[92:95], v[56:59]
    v_mfma_f32_16x16x32_bf16 v[60:63], v[16:19], v[124:127], v[60:63]
    v_mfma_f32_16x16x32_bf16 v[64:67], v[16:19], v[156:159], v[64:67]
    v_mfma_f32_16x16x32_bf16 v[68:71], v[16:19], v[188:191], v[68:71]
    ds_read_b64_tr_b16 v[16:17], v1 offset:256
    ds_read_b64_tr_b16 v[18:19], v1 offset:384
    s_waitcnt lgkmcnt(6)
    v_mfma_f32_16x16x32_bf16 v[56:59], v[20:23], v[96:99], v[56:59]
    v_mfma_f32_16x16x32_bf16 v[60:63], v[20:23], v[128:131], v[60:63]
    v_mfma_f32_16x16x32_bf16 v[64:67], v[20:23], v[160:163], v[64:67]
    v_mfma_f32_16x16x32_bf16 v[68:71], v[20:23], v[192:195], v[68:71]
    ds_read_b64_tr_b16 v[20:21], v1 offset:512
    ds_read_b64_tr_b16 v[22:23], v1 offset:640
    s_waitcnt lgkmcnt(6)
    v_mfma_f32_16x16x32_bf16 v[56:59], v[24:27], v[100:103], v[56:59]
    v_mfma_f32_16x16x32_bf16 v[60:63], v[24:27], v[132:135], v[60:63]
    v_mfma_f32_16x16x32_bf16 v[64:67], v[24:27], v[164:167], v[64:67]
    v_mfma_f32_16x16x32_bf16 v[68:71], v[24:27], v[196:199], v[68:71]
    ds_read_b64_tr_b16 v[24:25], v1 offset:768
    ds_read_b64_tr_b16 v[26:27], v1 offset:896
    s_barrier
    s_waitcnt lgkmcnt(6)
    v_mfma_f32_16x16x32_bf16 v[40:43], v[12:15], v[72:75], 0
    v_mfma_f32_16x16x32_bf16 v[44:47], v[12:15], v[104:107], 0
    v_mfma_f32_16x16x32_bf16 v[48:51], v[12:15], v[136:139], 0
    v_mfma_f32_16x16x32_bf16 v[52:55], v[12:15], v[168:171], 0
    v_add_u32 v1, 4294916608, v1
    ds_read_b64_tr_b16 v[12:13], v1 offset:0
    ds_read_b64_tr_b16 v[14:15], v1 offset:128
    s_waitcnt lgkmcnt(6)
    v_mfma_f32_16x16x32_bf16 v[40:43], v[16:19], v[76:79], v[40:43]
    v_mul_f32 v56, v4, v56
    v_mul_f32 v57, v4, v57
    v_mul_f32 v58, v4, v58
    v_mul_f32 v59, v4, v59
    v_mfma_f32_16x16x32_bf16 v[44:47], v[16:19], v[108:111], v[44:47]
    v_cvt_pk_bf16_f32 v28, v56, v57
    v_cvt_pk_bf16_f32 v29, v58, v59
    v_mul_f32 v60, v5, v60
    v_mfma_f32_16x16x32_bf16 v[48:51], v[16:19], v[140:143], v[48:51]
    v_mul_f32 v61, v5, v61
    v_mul_f32 v62, v5, v62
    v_mul_f32 v63, v5, v63
    v_mfma_f32_16x16x32_bf16 v[52:55], v[16:19], v[172:175], v[52:55]
    ds_read_b64_tr_b16 v[16:17], v1 offset:256
    ds_read_b64_tr_b16 v[18:19], v1 offset:384
    v_cvt_pk_bf16_f32 v30, v60, v61
    v_cvt_pk_bf16_f32 v31, v62, v63
    v_mul_f32 v64, v6, v64
    s_waitcnt lgkmcnt(6)
    v_mfma_f32_16x16x32_bf16 v[40:43], v[20:23], v[80:83], v[40:43]
    v_mul_f32 v65, v6, v65
    v_mul_f32 v66, v6, v66
    v_mul_f32 v67, v6, v67
    v_mfma_f32_16x16x32_bf16 v[44:47], v[20:23], v[112:115], v[44:47]
    v_cvt_pk_bf16_f32 v32, v64, v65
    v_cvt_pk_bf16_f32 v33, v66, v67
    v_mul_f32 v68, v7, v68
    v_mfma_f32_16x16x32_bf16 v[48:51], v[20:23], v[144:147], v[48:51]
    v_mul_f32 v69, v7, v69
    v_mul_f32 v70, v7, v70
    v_mul_f32 v71, v7, v71
    v_mfma_f32_16x16x32_bf16 v[52:55], v[20:23], v[176:179], v[52:55]
    ds_read_b64_tr_b16 v[20:21], v1 offset:512
    ds_read_b64_tr_b16 v[22:23], v1 offset:640
    v_cvt_pk_bf16_f32 v34, v68, v69
    v_cvt_pk_bf16_f32 v35, v70, v71
    s_lshl_b32 s42, s48, 14
    s_add_u32 s48, s48, 1
    buffer_store_dwordx4 v[28:31], v2, s[28:31], s42 offen sc1
    buffer_store_dwordx4 v[32:35], v2, s[28:31], s42 offen offset:1024 sc1
    s_cmp_eq_u32 s48, 7
    s_cselect_b32 s48, 0, s48
    s_waitcnt lgkmcnt(6)
    v_mfma_f32_16x16x32_bf16 v[40:43], v[24:27], v[84:87], v[40:43]
    v_mfma_f32_16x16x32_bf16 v[44:47], v[24:27], v[116:119], v[44:47]
    v_mfma_f32_16x16x32_bf16 v[48:51], v[24:27], v[148:151], v[48:51]
    v_mfma_f32_16x16x32_bf16 v[52:55], v[24:27], v[180:183], v[52:55]
    ds_read_b64_tr_b16 v[24:25], v1 offset:768
    ds_read_b64_tr_b16 v[26:27], v1 offset:896
    s_waitcnt lgkmcnt(6)
    v_mfma_f32_16x16x32_bf16 v[40:43], v[12:15], v[88:91], v[40:43]
    v_mfma_f32_16x16x32_bf16 v[44:47], v[12:15], v[120:123], v[44:47]
    v_mfma_f32_16x16x32_bf16 v[48:51], v[12:15], v[152:155], v[48:51]
    v_mfma_f32_16x16x32_bf16 v[52:55], v[12:15], v[184:187], v[52:55]
    s_waitcnt lgkmcnt(4)
    v_mfma_f32_16x16x32_bf16 v[40:43], v[16:19], v[92:95], v[40:43]
    v_mfma_f32_16x16x32_bf16 v[44:47], v[16:19], v[124:127], v[44:47]
    v_mfma_f32_16x16x32_bf16 v[48:51], v[16:19], v[156:159], v[48:51]
    v_mfma_f32_16x16x32_bf16 v[52:55], v[16:19], v[188:191], v[52:55]
    s_waitcnt lgkmcnt(2)
    v_mfma_f32_16x16x32_bf16 v[40:43], v[20:23], v[96:99], v[40:43]
    v_mfma_f32_16x16x32_bf16 v[44:47], v[20:23], v[128:131], v[44:47]
    v_mfma_f32_16x16x32_bf16 v[48:51], v[20:23], v[160:163], v[48:51]
    v_mfma_f32_16x16x32_bf16 v[52:55], v[20:23], v[192:195], v[52:55]
    s_waitcnt lgkmcnt(0)
    v_mfma_f32_16x16x32_bf16 v[40:43], v[24:27], v[100:103], v[40:43]
    v_mfma_f32_16x16x32_bf16 v[44:47], v[24:27], v[132:135], v[44:47]
    v_mfma_f32_16x16x32_bf16 v[48:51], v[24:27], v[164:167], v[48:51]
    v_mfma_f32_16x16x32_bf16 v[52:55], v[24:27], v[196:199], v[52:55]
    s_nop 7
    v_mul_f32 v40, v4, v40
    v_mul_f32 v41, v4, v41
    v_mul_f32 v42, v4, v42
    v_mul_f32 v43, v4, v43
    v_cvt_pk_bf16_f32 v28, v40, v41
    v_cvt_pk_bf16_f32 v29, v42, v43
    v_mul_f32 v44, v5, v44
    v_mul_f32 v45, v5, v45
    v_mul_f32 v46, v5, v46
    v_mul_f32 v47, v5, v47
    v_cvt_pk_bf16_f32 v30, v44, v45
    v_cvt_pk_bf16_f32 v31, v46, v47
    v_mul_f32 v48, v6, v48
    v_mul_f32 v49, v6, v49
    v_mul_f32 v50, v6, v50
    v_mul_f32 v51, v6, v51
    v_cvt_pk_bf16_f32 v32, v48, v49
    v_cvt_pk_bf16_f32 v33, v50, v51
    v_mul_f32 v52, v7, v52
    v_mul_f32 v53, v7, v53
    v_mul_f32 v54, v7, v54
    v_mul_f32 v55, v7, v55
    v_cvt_pk_bf16_f32 v34, v52, v53
    v_cvt_pk_bf16_f32 v35, v54, v55
    s_lshl_b32 s42, s48, 14
    s_add_u32 s48, s48, 1
    buffer_store_dwordx4 v[28:31], v2, s[28:31], s42 offen sc1
    buffer_store_dwordx4 v[32:35], v2, s[28:31], s42 offen offset:1024 sc1
    s_cmp_eq_u32 s48, 7
    s_cselect_b32 s48, 0, s48
L_final:
    s_load_dwordx2 s[12:13], s[0:1], 80
    s_add_u32 s7, s6, s32
    s_cmp_ge_u32 s7, 7
    s_cselect_b32 s16, 7, 0
    s_sub_u32 s7, s7, s16
    s_lshl_b32 s7, s7, 4
    s_add_u32 s7, s7, s4
    s_mul_i32 s17, s5, 1835008
    s_lshl_b32 s18, s7, 10
    s_add_u32 s17, s17, s18
    s_add_u32 s8, s58, s17
    s_addc_u32 s9, s59, 0
    s_mov_b32 s10, 1721344
    s_mov_b32 s11, 0x20000
    v_lshlrev_b32 v12, 4, v0
    s_lshl_b32 s42, s5, 7
    s_add_u32 s42, s42, 31457280
    v_and_b32 v13, 15, v0
    v_lshl_add_u32 v14, v13, 2, s42
    s_cmp_ge_u32 s32, 2
    s_cbranch_scc1 L_late
    s_mov_b32 s45, 0x8000
L_poll1:
    global_load_dword v15, v14, s[58:59] sc1
    s_waitcnt vmcnt(0)
    v_cmp_gt_u32 vcc, 1, v15
    s_nop 4
    s_cmp_eq_u64 vcc, 0
    s_cbranch_scc1 L_polled1
    s_sleep 2
    s_sub_u32 s45, s45, 1
    s_cmp_lg_u32 s45, 0
    s_cbranch_scc1 L_poll1
L_polled1:
    s_mov_b32 s19, 0
    s_and_b32 s25, s7, 9
    s_cmp_eq_u32 s25, 9
    s_cselect_b32 exec_hi, 0, -1
    buffer_load_dwordx4 v[80:83], v12, s[8:11], s19 offen sc1
    s_add_u32 s19, s19, 114688
    buffer_load_dwordx4 v[84:87], v12, s[8:11], s19 offen sc1
    s_add_u32 s19, s19, 114688
    buffer_load_dwordx4 v[88:91], v12, s[8:11], s19 offen sc1
    s_add_u32 s19, s19, 114688
    buffer_load_dwordx4 v[92:95], v12, s[8:11], s19 offen sc1
    s_add_u32 s19, s19, 114688
    buffer_load_dwordx4 v[96:99], v12, s[8:11], s19 offen sc1
    s_add_u32 s19, s19, 114688
    buffer_load_dwordx4 v[100:103], v12, s[8:11], s19 offen sc1
    s_add_u32 s19, s19, 114688
    buffer_load_dwordx4 v[104:107], v12, s[8:11], s19 offen sc1
    s_add_u32 s19, s19, 114688
    buffer_load_dwordx4 v[108:111], v12, s[8:11], s19 offen sc1
    s_add_u32 s19, s19, 114688
    buffer_load_dwordx4 v[112:115], v12, s[8:11], s19 offen sc1
    s_add_u32 s19, s19, 114688
    buffer_load_dwordx4 v[116:119], v12, s[8:11], s19 offen sc1
    s_add_u32 s19, s19, 114688
    buffer_load_dwordx4 v[120:123], v12, s[8:11], s19 offen sc1
    s_add_u32 s19, s19, 114688
    buffer_load_dwordx4 v[124:127], v12, s[8:11], s19 offen sc1
    s_add_u32 s19, s19, 114688
    buffer_load_dwordx4 v[128:131], v12, s[8:11], s19 offen sc1
    s_add_u32 s19, s19, 114688
    buffer_load_dwordx4 v[132:135], v12, s[8:11], s19 offen sc1
    s_add_u32 s19, s19, 114688
    buffer_load_dwordx4 v[136:139], v12, s[8:11], s19 offen sc1
    s_add_u32 s19, s19, 114688
    buffer_load_dwordx4 v[140:143], v12, s[8:11], s19 offen sc1
    s_branch L_z1
L_late:
    s_waitcnt vmcnt(0)
L_z1:
    s_barrier
    s_cmp_lg_u32 s32, 7
    s_cbranch_scc1 L_nopoll
    s_lshl_b32 s42, s5, 5
    s_add_u32 s42, s42, s4
    s_lshl_b32 s42, s42, 2
    s_add_u32 s42, s42, 31457280
    v_mov_b32 v10, s42
    v_mov_b32 v11, 2
    s_mov_b64 exec, 1
    global_store_dword v10, v11, s[58:59] sc1
    s_mov_b64 exec, -1
    s_mov_b32 s45, 0x8000
L_poll2:
    global_load_dword v15, v14, s[58:59] sc1
    s_waitcnt vmcnt(0)
    v_cmp_gt_u32 vcc, 2, v15
    s_nop 4
    s_cmp_eq_u64 vcc, 0
    s_cbranch_scc1 L_polled2
    s_sleep 2
    s_sub_u32 s45, s45, 1
    s_cmp_lg_u32 s45, 0
    s_cbranch_scc1 L_poll2
L_polled2:
L_nopoll:
    s_bfe_u32 s20, s7, 0x10003
    s_lshl_b32 s20, s20, 1
    s_and_b32 s21, s7, 1
    s_add_u32 s20, s20, s21
    s_and_b32 s22, s5, 7
    s_mul_i32 s22, s22, 112
    s_lshl_b32 s23, s20, 5
    s_add_u32 s22, s22, s23
    v_add_u32 v3, s22, v13
    v_mul_u32_u24 v3, 1792, v3
    s_lshr_b32 s22, s5, 3
    s_mul_i32 s22, s22, 896
    s_lshr_b32 s23, s7, 4
    s_lshl_b32 s23, s23, 7
    s_add_u32 s22, s22, s23
    s_bfe_u32 s23, s7, 0x20001
    s_lshl_b32 s23, s23, 5
    s_add_u32 s22, s22, s23
    v_lshrrev_b32 v4, 4, v0
    v_lshl_add_u32 v3, v4, 3, v3
    v_add_u32 v3, s22, v3
    s_mov_b32 s24, 28672
    s_cmp_eq_u32 s20, 3
    s_cselect_b32 s24, 16, s24
    s_mov_b32 s26, 0x3f80
    s_mov_b32 s27, 0x3f800000
    s_waitcnt lgkmcnt(0)
    s_mov_b32 s14, 1605632
    s_mov_b32 s15, 0x20000
    s_barrier
    s_cmp_eq_u32 s32, 7
    s_cbranch_scc1 L_done
    s_cmp_lt_u32 s32, 2
    s_cbranch_scc1 L_sum
    s_mov_b32 s19, 0
    s_and_b32 s25, s7, 9
    s_cmp_eq_u32 s25, 9
    s_cselect_b32 exec_hi, 0, -1
    buffer_load_dwordx4 v[80:83], v12, s[8:11], s19 offen sc1
    s_add_u32 s19, s19, 114688
    buffer_load_dwordx4 v[84:87], v12, s[8:11], s19 offen sc1
    s_add_u32 s19, s19, 114688
    buffer_load_dwordx4 v[88:91], v12, s[8:11], s19 offen sc1
    s_add_u32 s19, s19, 114688
    buffer_load_dwordx4 v[92:95], v12, s[8:11], s19 offen sc1
    s_add_u32 s19, s19, 114688
    buffer_load_dwordx4 v[96:99], v12, s[8:11], s19 offen sc1
    s_add_u32 s19, s19, 114688
    buffer_load_dwordx4 v[100:103], v12, s[8:11], s19 offen sc1
    s_add_u32 s19, s19, 114688
    buffer_load_dwordx4 v[104:107], v12, s[8:11], s19 offen sc1
    s_add_u32 s19, s19, 114688
    buffer_load_dwordx4 v[108:111], v12, s[8:11], s19 offen sc1
    s_add_u32 s19, s19, 114688
    buffer_load_dwordx4 v[112:115], v12, s[8:11], s19 offen sc1
    s_add_u32 s19, s19, 114688
    buffer_load_dwordx4 v[116:119], v12, s[8:11], s19 offen sc1
    s_add_u32 s19, s19, 114688
    buffer_load_dwordx4 v[120:123], v12, s[8:11], s19 offen sc1
    s_add_u32 s19, s19, 114688
    buffer_load_dwordx4 v[124:127], v12, s[8:11], s19 offen sc1
    s_add_u32 s19, s19, 114688
    buffer_load_dwordx4 v[128:131], v12, s[8:11], s19 offen sc1
    s_add_u32 s19, s19, 114688
    buffer_load_dwordx4 v[132:135], v12, s[8:11], s19 offen sc1
    s_add_u32 s19, s19, 114688
    buffer_load_dwordx4 v[136:139], v12, s[8:11], s19 offen sc1
    s_add_u32 s19, s19, 114688
    buffer_load_dwordx4 v[140:143], v12, s[8:11], s19 offen sc1
L_sum:
    s_waitcnt vmcnt(15)
    v_lshlrev_b32 v72, 16, v80
    v_and_b32 v73, 0xffff0000, v80
    v_lshlrev_b32 v74, 16, v81
    v_and_b32 v75, 0xffff0000, v81
    v_lshlrev_b32 v76, 16, v82
    v_and_b32 v77, 0xffff0000, v82
    v_lshlrev_b32 v78, 16, v83
    v_and_b32 v79, 0xffff0000, v83
    s_waitcnt vmcnt(14)
    v_dot2_f32_bf16 v72, v84, s26, v72
    v_dot2_f32_bf16 v73, v84, s27, v73
    v_dot2_f32_bf16 v74, v85, s26, v74
    v_dot2_f32_bf16 v75, v85, s27, v75
    v_dot2_f32_bf16 v76, v86, s26, v76
    v_dot2_f32_bf16 v77, v86, s27, v77
    v_dot2_f32_bf16 v78, v87, s26, v78
    v_dot2_f32_bf16 v79, v87, s27, v79
    s_waitcnt vmcnt(13)
    v_dot2_f32_bf16 v72, v88, s26, v72
    v_dot2_f32_bf16 v73, v88, s27, v73
    v_dot2_f32_bf16 v74, v89, s26, v74
    v_dot2_f32_bf16 v75, v89, s27, v75
    v_dot2_f32_bf16 v76, v90, s26, v76
    v_dot2_f32_bf16 v77, v90, s27, v77
    v_dot2_f32_bf16 v78, v91, s26, v78
    v_dot2_f32_bf16 v79, v91, s27, v79
    s_waitcnt vmcnt(12)
    v_dot2_f32_bf16 v72, v92, s26, v72
    v_dot2_f32_bf16 v73, v92, s27, v73
    v_dot2_f32_bf16 v74, v93, s26, v74
    v_dot2_f32_bf16 v75, v93, s27, v75
    v_dot2_f32_bf16 v76, v94, s26, v76
    v_dot2_f32_bf16 v77, v94, s27, v77
    v_dot2_f32_bf16 v78, v95, s26, v78
    v_dot2_f32_bf16 v79, v95, s27, v79
    s_waitcnt vmcnt(11)
    v_dot2_f32_bf16 v72, v96, s26, v72
    v_dot2_f32_bf16 v73, v96, s27, v73
    v_dot2_f32_bf16 v74, v97, s26, v74
    v_dot2_f32_bf16 v75, v97, s27, v75
    v_dot2_f32_bf16 v76, v98, s26, v76
    v_dot2_f32_bf16 v77, v98, s27, v77
    v_dot2_f32_bf16 v78, v99, s26, v78
    v_dot2_f32_bf16 v79, v99, s27, v79
    s_waitcnt vmcnt(10)
    v_dot2_f32_bf16 v72, v100, s26, v72
    v_dot2_f32_bf16 v73, v100, s27, v73
    v_dot2_f32_bf16 v74, v101, s26, v74
    v_dot2_f32_bf16 v75, v101, s27, v75
    v_dot2_f32_bf16 v76, v102, s26, v76
    v_dot2_f32_bf16 v77, v102, s27, v77
    v_dot2_f32_bf16 v78, v103, s26, v78
    v_dot2_f32_bf16 v79, v103, s27, v79
    s_waitcnt vmcnt(9)
    v_dot2_f32_bf16 v72, v104, s26, v72
    v_dot2_f32_bf16 v73, v104, s27, v73
    v_dot2_f32_bf16 v74, v105, s26, v74
    v_dot2_f32_bf16 v75, v105, s27, v75
    v_dot2_f32_bf16 v76, v106, s26, v76
    v_dot2_f32_bf16 v77, v106, s27, v77
    v_dot2_f32_bf16 v78, v107, s26, v78
    v_dot2_f32_bf16 v79, v107, s27, v79
    s_waitcnt vmcnt(8)
    v_dot2_f32_bf16 v72, v108, s26, v72
    v_dot2_f32_bf16 v73, v108, s27, v73
    v_dot2_f32_bf16 v74, v109, s26, v74
    v_dot2_f32_bf16 v75, v109, s27, v75
    v_dot2_f32_bf16 v76, v110, s26, v76
    v_dot2_f32_bf16 v77, v110, s27, v77
    v_dot2_f32_bf16 v78, v111, s26, v78
    v_dot2_f32_bf16 v79, v111, s27, v79
    s_waitcnt vmcnt(7)
    v_dot2_f32_bf16 v72, v112, s26, v72
    v_dot2_f32_bf16 v73, v112, s27, v73
    v_dot2_f32_bf16 v74, v113, s26, v74
    v_dot2_f32_bf16 v75, v113, s27, v75
    v_dot2_f32_bf16 v76, v114, s26, v76
    v_dot2_f32_bf16 v77, v114, s27, v77
    v_dot2_f32_bf16 v78, v115, s26, v78
    v_dot2_f32_bf16 v79, v115, s27, v79
    s_waitcnt vmcnt(6)
    v_dot2_f32_bf16 v72, v116, s26, v72
    v_dot2_f32_bf16 v73, v116, s27, v73
    v_dot2_f32_bf16 v74, v117, s26, v74
    v_dot2_f32_bf16 v75, v117, s27, v75
    v_dot2_f32_bf16 v76, v118, s26, v76
    v_dot2_f32_bf16 v77, v118, s27, v77
    v_dot2_f32_bf16 v78, v119, s26, v78
    v_dot2_f32_bf16 v79, v119, s27, v79
    s_waitcnt vmcnt(5)
    v_dot2_f32_bf16 v72, v120, s26, v72
    v_dot2_f32_bf16 v73, v120, s27, v73
    v_dot2_f32_bf16 v74, v121, s26, v74
    v_dot2_f32_bf16 v75, v121, s27, v75
    v_dot2_f32_bf16 v76, v122, s26, v76
    v_dot2_f32_bf16 v77, v122, s27, v77
    v_dot2_f32_bf16 v78, v123, s26, v78
    v_dot2_f32_bf16 v79, v123, s27, v79
    s_waitcnt vmcnt(4)
    v_dot2_f32_bf16 v72, v124, s26, v72
    v_dot2_f32_bf16 v73, v124, s27, v73
    v_dot2_f32_bf16 v74, v125, s26, v74
    v_dot2_f32_bf16 v75, v125, s27, v75
    v_dot2_f32_bf16 v76, v126, s26, v76
    v_dot2_f32_bf16 v77, v126, s27, v77
    v_dot2_f32_bf16 v78, v127, s26, v78
    v_dot2_f32_bf16 v79, v127, s27, v79
    s_waitcnt vmcnt(3)
    v_dot2_f32_bf16 v72, v128, s26, v72
    v_dot2_f32_bf16 v73, v128, s27, v73
    v_dot2_f32_bf16 v74, v129, s26, v74
    v_dot2_f32_bf16 v75, v129, s27, v75
    v_dot2_f32_bf16 v76, v130, s26, v76
    v_dot2_f32_bf16 v77, v130, s27, v77
    v_dot2_f32_bf16 v78, v131, s26, v78
    v_dot2_f32_bf16 v79, v131, s27, v79
    s_waitcnt vmcnt(2)
    v_dot2_f32_bf16 v72, v132, s26, v72
    v_dot2_f32_bf16 v73, v132, s27, v73
    v_dot2_f32_bf16 v74, v133, s26, v74
    v_dot2_f32_bf16 v75, v133, s27, v75
    v_dot2_f32_bf16 v76, v134, s26, v76
    v_dot2_f32_bf16 v77, v134, s27, v77
    v_dot2_f32_bf16 v78, v135, s26, v78
    v_dot2_f32_bf16 v79, v135, s27, v79
    s_waitcnt vmcnt(1)
    v_dot2_f32_bf16 v72, v136, s26, v72
    v_dot2_f32_bf16 v73, v136, s27, v73
    v_dot2_f32_bf16 v74, v137, s26, v74
    v_dot2_f32_bf16 v75, v137, s27, v75
    v_dot2_f32_bf16 v76, v138, s26, v76
    v_dot2_f32_bf16 v77, v138, s27, v77
    v_dot2_f32_bf16 v78, v139, s26, v78
    v_dot2_f32_bf16 v79, v139, s27, v79
    s_waitcnt vmcnt(0)
    v_dot2_f32_bf16 v72, v140, s26, v72
    v_dot2_f32_bf16 v73, v140, s27, v73
    v_dot2_f32_bf16 v74, v141, s26, v74
    v_dot2_f32_bf16 v75, v141, s27, v75
    v_dot2_f32_bf16 v76, v142, s26, v76
    v_dot2_f32_bf16 v77, v142, s27, v77
    v_dot2_f32_bf16 v78, v143, s26, v78
    v_dot2_f32_bf16 v79, v143, s27, v79
    s_nop 2
    v_cvt_pk_bf16_f32 v16, v72, v73
    v_cvt_pk_bf16_f32 v17, v74, v75
    v_cvt_pk_bf16_f32 v18, v76, v77
    v_cvt_pk_bf16_f32 v19, v78, v79
    buffer_store_dwordx2 v[16:17], v3, s[12:15], 0 offen
    buffer_store_dwordx2 v[18:19], v3, s[12:15], s24 offen
L_rlast:
    s_endpgm
L_owave:
    s_setprio 1
    s_waitcnt vmcnt(6)
    s_waitcnt lgkmcnt(0)
    s_barrier
    v_add_u32 v3, 101376, v3
    v_add_u32 v4, 101376, v4
    v_add_u32 v5, 118272, v5
    s_lshl_b32 s52, s33, 12
    s_mul_i32 s43, s33, 28672
    s_lshl_b32 s45, s33, 16
    ds_read_b64_tr_b16 v[16:17], v5 offset:0
    ds_read_b64_tr_b16 v[18:19], v5 offset:512
    ds_read_b64_tr_b16 v[20:21], v5 offset:8
    ds_read_b64_tr_b16 v[22:23], v5 offset:520
    ds_read_b128 v[32:35], v3 offset:0
    ds_read_b128 v[36:39], v3 offset:2048
    ds_read_b128 v[40:43], v3 offset:4096
    ds_read_b128 v[44:47], v3 offset:6144
    ds_read_b128 v[48:51], v3 offset:8192
    ds_read_b128 v[52:55], v3 offset:10240
    ds_read_b128 v[56:59], v3 offset:12288
    ds_read_b64_tr_b16 v[24:25], v5 offset:16896
    ds_read_b64_tr_b16 v[26:27], v5 offset:17408
    ds_read_b64_tr_b16 v[28:29], v5 offset:16904
    ds_read_b64_tr_b16 v[30:31], v5 offset:17416
    s_waitcnt lgkmcnt(10)
    v_mfma_f32_16x16x32_bf16 v[96:99], v[16:19], v[32:35], 0
    v_mfma_f32_16x16x32_bf16 v[100:103], v[20:23], v[32:35], 0
    ds_read_b128 v[60:63], v4 offset:0
    s_waitcnt lgkmcnt(10)
    v_mfma_f32_16x16x32_bf16 v[104:107], v[16:19], v[36:39], 0
    v_mfma_f32_16x16x32_bf16 v[108:111], v[20:23], v[36:39], 0
    ds_read_b128 v[64:67], v4 offset:2048
    s_waitcnt lgkmcnt(10)
    v_mfma_f32_16x16x32_bf16 v[112:115], v[16:19], v[40:43], 0
    v_mfma_f32_16x16x32_bf16 v[116:119], v[20:23], v[40:43], 0
    ds_read_b128 v[68:71], v4 offset:4096
    s_add_u32 m0, s52, 0
    s_add_u32 s44, s49, s43
    buffer_load_dwordx4 v1, s[8:11], s44 offen lds
    s_waitcnt lgkmcnt(10)
    v_mfma_f32_16x16x32_bf16 v[120:123], v[16:19], v[44:47], 0
    v_mfma_f32_16x16x32_bf16 v[124:127], v[20:23], v[44:47], 0
    ds_read_b128 v[72:75], v4 offset:6144
    s_add_u32 m0, s52, 1024
    s_add_u32 s44, s44, 7168
    buffer_load_dwordx4 v1, s[8:11], s44 offen lds
    s_waitcnt lgkmcnt(10)
    v_mfma_f32_16x16x32_bf16 v[128:131], v[16:19], v[48:51], 0
    v_mfma_f32_16x16x32_bf16 v[132:135], v[20:23], v[48:51], 0
    ds_read_b128 v[76:79], v4 offset:8192
    s_add_u32 m0, s52, 2048
    s_add_u32 s44, s44, 7168
    buffer_load_dwordx4 v1, s[8:11], s44 offen lds
    s_waitcnt lgkmcnt(10)
    v_mfma_f32_16x16x32_bf16 v[136:139], v[16:19], v[52:55], 0
    v_mfma_f32_16x16x32_bf16 v[140:143], v[20:23], v[52:55], 0
    ds_read_b128 v[80:83], v4 offset:10240
    s_add_u32 m0, s52, 3072
    s_add_u32 s44, s44, 7168
    buffer_load_dwordx4 v1, s[8:11], s44 offen lds
    s_waitcnt lgkmcnt(10)
    v_mfma_f32_16x16x32_bf16 v[144:147], v[16:19], v[56:59], 0
    v_mfma_f32_16x16x32_bf16 v[148:151], v[20:23], v[56:59], 0
    ds_read_b128 v[84:87], v4 offset:12288
    s_add_u32 m0, s35, 16896
    s_add_u32 s44, s47, s45
    buffer_load_dwordx4 v2, s[12:15], s44 offen lds
    s_add_u32 m0, s35, 17952
    s_add_u32 s44, s44, 8192
    buffer_load_dwordx4 v2, s[12:15], s44 offen lds
    s_add_u32 m0, s35, 19008
    s_add_u32 s44, s44, 8192
    buffer_load_dwordx4 v2, s[12:15], s44 offen lds
    s_add_u32 m0, s35, 20064
    s_add_u32 s44, s44, 8192
    buffer_load_dwordx4 v2, s[12:15], s44 offen lds
    s_add_u32 m0, s35, 33792
    s_add_u32 s44, s44, 237568
    buffer_load_dwordx4 v2, s[12:15], s44 offen lds
    s_add_u32 m0, s35, 34848
    s_add_u32 s44, s44, 8192
    buffer_load_dwordx4 v2, s[12:15], s44 offen lds
    s_add_u32 m0, s35, 35904
    s_add_u32 s44, s44, 8192
    buffer_load_dwordx4 v2, s[12:15], s44 offen lds
    s_add_u32 m0, s35, 36960
    s_add_u32 s44, s44, 8192
    buffer_load_dwordx4 v2, s[12:15], s44 offen lds
    s_add_u32 s47, s47, 524288
    s_add_u32 s49, s49, 128
    s_cmp_eq_u32 s49, 896
    s_cselect_b32 s47, 0, s47
    s_cselect_b32 s49, 0, s49
    s_waitcnt vmcnt(12)
    s_waitcnt lgkmcnt(0)
    s_barrier
    v_add_u32 v3, 4294916608, v3
    v_add_u32 v4, 4294916608, v4
    v_add_u32 v5, 4294916608, v5
    v_mfma_f32_16x16x32_bf16 v[96:99], v[24:27], v[60:63], v[96:99]
    v_mfma_f32_16x16x32_bf16 v[100:103], v[28:31], v[60:63], v[100:103]
    ds_read_b64_tr_b16 v[16:17], v5 offset:0
    ds_read_b64_tr_b16 v[18:19], v5 offset:512
    ds_read_b64_tr_b16 v[20:21], v5 offset:8
    ds_read_b64_tr_b16 v[22:23], v5 offset:520
    v_mfma_f32_16x16x32_bf16 v[104:107], v[24:27], v[64:67], v[104:107]
    v_mfma_f32_16x16x32_bf16 v[108:111], v[28:31], v[64:67], v[108:111]
    ds_read_b128 v[32:35], v3 offset:0
    v_mfma_f32_16x16x32_bf16 v[112:115], v[24:27], v[68:71], v[112:115]
    v_mfma_f32_16x16x32_bf16 v[116:119], v[28:31], v[68:71], v[116:119]
    ds_read_b128 v[36:39], v3 offset:2048
    s_add_u32 m0, s52, 101376
    s_add_u32 s44, s49, s43
    buffer_load_dwordx4 v1, s[8:11], s44 offen lds
    v_mfma_f32_16x16x32_bf16 v[120:123], v[24:27], v[72:75], v[120:123]
    v_mfma_f32_16x16x32_bf16 v[124:127], v[28:31], v[72:75], v[124:127]
    ds_read_b128 v[40:43], v3 offset:4096
    s_add_u32 m0, s52, 102400
    s_add_u32 s44, s44, 7168
    buffer_load_dwordx4 v1, s[8:11], s44 offen lds
    v_mfma_f32_16x16x32_bf16 v[128:131], v[24:27], v[76:79], v[128:131]
    v_mfma_f32_16x16x32_bf16 v[132:135], v[28:31], v[76:79], v[132:135]
    ds_read_b128 v[44:47], v3 offset:6144
    s_add_u32 m0, s52, 103424
    s_add_u32 s44, s44, 7168
    buffer_load_dwordx4 v1, s[8:11], s44 offen lds
    v_mfma_f32_16x16x32_bf16 v[136:139], v[24:27], v[80:83], v[136:139]
    v_mfma_f32_16x16x32_bf16 v[140:143], v[28:31], v[80:83], v[140:143]
    ds_read_b128 v[48:51], v3 offset:8192
    s_add_u32 m0, s52, 104448
    s_add_u32 s44, s44, 7168
    buffer_load_dwordx4 v1, s[8:11], s44 offen lds
    v_mfma_f32_16x16x32_bf16 v[144:147], v[24:27], v[84:87], v[144:147]
    v_mfma_f32_16x16x32_bf16 v[148:151], v[28:31], v[84:87], v[148:151]
    ds_read_b128 v[52:55], v3 offset:10240
    s_add_u32 m0, s35, 118272
    s_add_u32 s44, s47, s45
    buffer_load_dwordx4 v2, s[12:15], s44 offen lds
    ds_read_b128 v[56:59], v3 offset:12288
    ds_read_b64_tr_b16 v[24:25], v5 offset:16896
    ds_read_b64_tr_b16 v[26:27], v5 offset:17408
    ds_read_b64_tr_b16 v[28:29], v5 offset:16904
    ds_read_b64_tr_b16 v[30:31], v5 offset:17416
    s_waitcnt lgkmcnt(10)
    v_mfma_f32_16x16x32_bf16 v[96:99], v[16:19], v[32:35], v[96:99]
    v_mfma_f32_16x16x32_bf16 v[100:103], v[20:23], v[32:35], v[100:103]
    ds_read_b128 v[60:63], v4 offset:0
    s_add_u32 m0, s35, 119328
    s_add_u32 s44, s44, 8192
    buffer_load_dwordx4 v2, s[12:15], s44 offen lds
    s_waitcnt lgkmcnt(10)
    v_mfma_f32_16x16x32_bf16 v[104:107], v[16:19], v[36:39], v[104:107]
    v_mfma_f32_16x16x32_bf16 v[108:111], v[20:23], v[36:39], v[108:111]
    ds_read_b128 v[64:67], v4 offset:2048
    s_add_u32 m0, s35, 120384
    s_add_u32 s44, s44, 8192
    buffer_load_dwordx4 v2, s[12:15], s44 offen lds
    s_waitcnt lgkmcnt(10)
    v_mfma_f32_16x16x32_bf16 v[112:115], v[16:19], v[40:43], v[112:115]
    v_mfma_f32_16x16x32_bf16 v[116:119], v[20:23], v[40:43], v[116:119]
    ds_read_b128 v[68:71], v4 offset:4096
    s_add_u32 m0, s35, 121440
    s_add_u32 s44, s44, 8192
    buffer_load_dwordx4 v2, s[12:15], s44 offen lds
    s_waitcnt lgkmcnt(10)
    v_mfma_f32_16x16x32_bf16 v[120:123], v[16:19], v[44:47], v[120:123]
    v_mfma_f32_16x16x32_bf16 v[124:127], v[20:23], v[44:47], v[124:127]
    ds_read_b128 v[72:75], v4 offset:6144
    s_add_u32 m0, s35, 135168
    s_add_u32 s44, s44, 237568
    buffer_load_dwordx4 v2, s[12:15], s44 offen lds
    s_waitcnt lgkmcnt(10)
    v_mfma_f32_16x16x32_bf16 v[128:131], v[16:19], v[48:51], v[128:131]
    v_mfma_f32_16x16x32_bf16 v[132:135], v[20:23], v[48:51], v[132:135]
    ds_read_b128 v[76:79], v4 offset:8192
    s_add_u32 m0, s35, 136224
    s_add_u32 s44, s44, 8192
    buffer_load_dwordx4 v2, s[12:15], s44 offen lds
    s_waitcnt lgkmcnt(10)
    v_mfma_f32_16x16x32_bf16 v[136:139], v[16:19], v[52:55], v[136:139]
    v_mfma_f32_16x16x32_bf16 v[140:143], v[20:23], v[52:55], v[140:143]
    ds_read_b128 v[80:83], v4 offset:10240
    s_add_u32 m0, s35, 137280
    s_add_u32 s44, s44, 8192
    buffer_load_dwordx4 v2, s[12:15], s44 offen lds
    s_waitcnt lgkmcnt(10)
    v_mfma_f32_16x16x32_bf16 v[144:147], v[16:19], v[56:59], v[144:147]
    v_mfma_f32_16x16x32_bf16 v[148:151], v[20:23], v[56:59], v[148:151]
    ds_read_b128 v[84:87], v4 offset:12288
    s_add_u32 m0, s35, 138336
    s_add_u32 s44, s44, 8192
    buffer_load_dwordx4 v2, s[12:15], s44 offen lds
    s_add_u32 s47, s47, 524288
    s_add_u32 s49, s49, 128
    s_cmp_eq_u32 s49, 896
    s_cselect_b32 s47, 0, s47
    s_cselect_b32 s49, 0, s49
    s_waitcnt vmcnt(12)
    s_waitcnt lgkmcnt(0)
    s_barrier
    v_add_u32 v3, 4294916608, v3
    v_add_u32 v4, 4294916608, v4
    v_add_u32 v5, 4294916608, v5
    v_mfma_f32_16x16x32_bf16 v[96:99], v[24:27], v[60:63], v[96:99]
    v_mfma_f32_16x16x32_bf16 v[100:103], v[28:31], v[60:63], v[100:103]
    ds_read_b64_tr_b16 v[16:17], v5 offset:0
    ds_read_b64_tr_b16 v[18:19], v5 offset:512
    ds_read_b64_tr_b16 v[20:21], v5 offset:8
    ds_read_b64_tr_b16 v[22:23], v5 offset:520
    v_mfma_f32_16x16x32_bf16 v[104:107], v[24:27], v[64:67], v[104:107]
    v_mfma_f32_16x16x32_bf16 v[108:111], v[28:31], v[64:67], v[108:111]
    ds_read_b128 v[32:35], v3 offset:0
    v_mfma_f32_16x16x32_bf16 v[112:115], v[24:27], v[68:71], v[112:115]
    v_mfma_f32_16x16x32_bf16 v[116:119], v[28:31], v[68:71], v[116:119]
    ds_read_b128 v[36:39], v3 offset:2048
    s_add_u32 m0, s52, 50688
    s_add_u32 s44, s49, s43
    buffer_load_dwordx4 v1, s[8:11], s44 offen lds
    v_mfma_f32_16x16x32_bf16 v[120:123], v[24:27], v[72:75], v[120:123]
    v_mfma_f32_16x16x32_bf16 v[124:127], v[28:31], v[72:75], v[124:127]
    ds_read_b128 v[40:43], v3 offset:4096
    s_add_u32 m0, s52, 51712
    s_add_u32 s44, s44, 7168
    buffer_load_dwordx4 v1, s[8:11], s44 offen lds
    v_mfma_f32_16x16x32_bf16 v[128:131], v[24:27], v[76:79], v[128:131]
    v_mfma_f32_16x16x32_bf16 v[132:135], v[28:31], v[76:79], v[132:135]
    ds_read_b128 v[44:47], v3 offset:6144
    s_add_u32 m0, s52, 52736
    s_add_u32 s44, s44, 7168
    buffer_load_dwordx4 v1, s[8:11], s44 offen lds
    v_mfma_f32_16x16x32_bf16 v[136:139], v[24:27], v[80:83], v[136:139]
    v_mfma_f32_16x16x32_bf16 v[140:143], v[28:31], v[80:83], v[140:143]
    ds_read_b128 v[48:51], v3 offset:8192
    s_add_u32 m0, s52, 53760
    s_add_u32 s44, s44, 7168
    buffer_load_dwordx4 v1, s[8:11], s44 offen lds
    v_mfma_f32_16x16x32_bf16 v[144:147], v[24:27], v[84:87], v[144:147]
    v_mfma_f32_16x16x32_bf16 v[148:151], v[28:31], v[84:87], v[148:151]
    ds_read_b128 v[52:55], v3 offset:10240
    s_add_u32 m0, s35, 67584
    s_add_u32 s44, s47, s45
    buffer_load_dwordx4 v2, s[12:15], s44 offen lds
    ds_read_b128 v[56:59], v3 offset:12288
    ds_read_b64_tr_b16 v[24:25], v5 offset:16896
    ds_read_b64_tr_b16 v[26:27], v5 offset:17408
    ds_read_b64_tr_b16 v[28:29], v5 offset:16904
    ds_read_b64_tr_b16 v[30:31], v5 offset:17416
    s_waitcnt lgkmcnt(10)
    v_mfma_f32_16x16x32_bf16 v[96:99], v[16:19], v[32:35], v[96:99]
    v_mfma_f32_16x16x32_bf16 v[100:103], v[20:23], v[32:35], v[100:103]
    ds_read_b128 v[60:63], v4 offset:0
    s_add_u32 m0, s35, 68640
    s_add_u32 s44, s44, 8192
    buffer_load_dwordx4 v2, s[12:15], s44 offen lds
    s_waitcnt lgkmcnt(10)
    v_mfma_f32_16x16x32_bf16 v[104:107], v[16:19], v[36:39], v[104:107]
    v_mfma_f32_16x16x32_bf16 v[108:111], v[20:23], v[36:39], v[108:111]
    ds_read_b128 v[64:67], v4 offset:2048
    s_add_u32 m0, s35, 69696
    s_add_u32 s44, s44, 8192
    buffer_load_dwordx4 v2, s[12:15], s44 offen lds
    s_waitcnt lgkmcnt(10)
    v_mfma_f32_16x16x32_bf16 v[112:115], v[16:19], v[40:43], v[112:115]
    v_mfma_f32_16x16x32_bf16 v[116:119], v[20:23], v[40:43], v[116:119]
    ds_read_b128 v[68:71], v4 offset:4096
    s_add_u32 m0, s35, 70752
    s_add_u32 s44, s44, 8192
    buffer_load_dwordx4 v2, s[12:15], s44 offen lds
    s_waitcnt lgkmcnt(10)
    v_mfma_f32_16x16x32_bf16 v[120:123], v[16:19], v[44:47], v[120:123]
    v_mfma_f32_16x16x32_bf16 v[124:127], v[20:23], v[44:47], v[124:127]
    ds_read_b128 v[72:75], v4 offset:6144
    s_add_u32 m0, s35, 84480
    s_add_u32 s44, s44, 237568
    buffer_load_dwordx4 v2, s[12:15], s44 offen lds
    s_waitcnt lgkmcnt(10)
    v_mfma_f32_16x16x32_bf16 v[128:131], v[16:19], v[48:51], v[128:131]
    v_mfma_f32_16x16x32_bf16 v[132:135], v[20:23], v[48:51], v[132:135]
    ds_read_b128 v[76:79], v4 offset:8192
    s_add_u32 m0, s35, 85536
    s_add_u32 s44, s44, 8192
    buffer_load_dwordx4 v2, s[12:15], s44 offen lds
    s_waitcnt lgkmcnt(10)
    v_mfma_f32_16x16x32_bf16 v[136:139], v[16:19], v[52:55], v[136:139]
    v_mfma_f32_16x16x32_bf16 v[140:143], v[20:23], v[52:55], v[140:143]
    ds_read_b128 v[80:83], v4 offset:10240
    s_add_u32 m0, s35, 86592
    s_add_u32 s44, s44, 8192
    buffer_load_dwordx4 v2, s[12:15], s44 offen lds
    s_waitcnt lgkmcnt(10)
    v_mfma_f32_16x16x32_bf16 v[144:147], v[16:19], v[56:59], v[144:147]
    v_mfma_f32_16x16x32_bf16 v[148:151], v[20:23], v[56:59], v[148:151]
    ds_read_b128 v[84:87], v4 offset:12288
    s_add_u32 m0, s35, 87648
    s_add_u32 s44, s44, 8192
    buffer_load_dwordx4 v2, s[12:15], s44 offen lds
    s_add_u32 s47, s47, 524288
    s_add_u32 s49, s49, 128
    s_cmp_eq_u32 s49, 896
    s_cselect_b32 s47, 0, s47
    s_cselect_b32 s49, 0, s49
    s_waitcnt vmcnt(12)
    s_waitcnt lgkmcnt(0)
    s_barrier
    v_add_u32 v3, 101376, v3
    v_add_u32 v4, 101376, v4
    v_add_u32 v5, 101376, v5
    v_mfma_f32_16x16x32_bf16 v[96:99], v[24:27], v[60:63], v[96:99]
    v_mfma_f32_16x16x32_bf16 v[100:103], v[28:31], v[60:63], v[100:103]
    ds_read_b64_tr_b16 v[16:17], v5 offset:0
    ds_read_b64_tr_b16 v[18:19], v5 offset:512
    ds_read_b64_tr_b16 v[20:21], v5 offset:8
    ds_read_b64_tr_b16 v[22:23], v5 offset:520
    v_mfma_f32_16x16x32_bf16 v[104:107], v[24:27], v[64:67], v[104:107]
    v_mfma_f32_16x16x32_bf16 v[108:111], v[28:31], v[64:67], v[108:111]
    ds_read_b128 v[32:35], v3 offset:0
    v_mfma_f32_16x16x32_bf16 v[112:115], v[24:27], v[68:71], v[112:115]
    v_mfma_f32_16x16x32_bf16 v[116:119], v[28:31], v[68:71], v[116:119]
    ds_read_b128 v[36:39], v3 offset:2048
    s_add_u32 m0, s52, 0
    s_add_u32 s44, s49, s43
    buffer_load_dwordx4 v1, s[8:11], s44 offen lds
    v_mfma_f32_16x16x32_bf16 v[120:123], v[24:27], v[72:75], v[120:123]
    v_mfma_f32_16x16x32_bf16 v[124:127], v[28:31], v[72:75], v[124:127]
    ds_read_b128 v[40:43], v3 offset:4096
    s_add_u32 m0, s52, 1024
    s_add_u32 s44, s44, 7168
    buffer_load_dwordx4 v1, s[8:11], s44 offen lds
    v_mfma_f32_16x16x32_bf16 v[128:131], v[24:27], v[76:79], v[128:131]
    v_mfma_f32_16x16x32_bf16 v[132:135], v[28:31], v[76:79], v[132:135]
    ds_read_b128 v[44:47], v3 offset:6144
    s_add_u32 m0, s52, 2048
    s_add_u32 s44, s44, 7168
    buffer_load_dwordx4 v1, s[8:11], s44 offen lds
    v_mfma_f32_16x16x32_bf16 v[136:139], v[24:27], v[80:83], v[136:139]
    v_mfma_f32_16x16x32_bf16 v[140:143], v[28:31], v[80:83], v[140:143]
    ds_read_b128 v[48:51], v3 offset:8192
    s_add_u32 m0, s52, 3072
    s_add_u32 s44, s44, 7168
    buffer_load_dwordx4 v1, s[8:11], s44 offen lds
    v_mfma_f32_16x16x32_bf16 v[144:147], v[24:27], v[84:87], v[144:147]
    v_mfma_f32_16x16x32_bf16 v[148:151], v[28:31], v[84:87], v[148:151]
    ds_read_b128 v[52:55], v3 offset:10240
    s_add_u32 m0, s35, 16896
    s_add_u32 s44, s47, s45
    buffer_load_dwordx4 v2, s[12:15], s44 offen lds
    ds_read_b128 v[56:59], v3 offset:12288
    ds_read_b64_tr_b16 v[24:25], v5 offset:16896
    ds_read_b64_tr_b16 v[26:27], v5 offset:17408
    ds_read_b64_tr_b16 v[28:29], v5 offset:16904
    ds_read_b64_tr_b16 v[30:31], v5 offset:17416
    s_waitcnt lgkmcnt(10)
    v_mfma_f32_16x16x32_bf16 v[96:99], v[16:19], v[32:35], v[96:99]
    v_mfma_f32_16x16x32_bf16 v[100:103], v[20:23], v[32:35], v[100:103]
    ds_read_b128 v[60:63], v4 offset:0
    s_add_u32 m0, s35, 17952
    s_add_u32 s44, s44, 8192
    buffer_load_dwordx4 v2, s[12:15], s44 offen lds
    s_waitcnt lgkmcnt(10)
    v_mfma_f32_16x16x32_bf16 v[104:107], v[16:19], v[36:39], v[104:107]
    v_mfma_f32_16x16x32_bf16 v[108:111], v[20:23], v[36:39], v[108:111]
    ds_read_b128 v[64:67], v4 offset:2048
    s_add_u32 m0, s35, 19008
    s_add_u32 s44, s44, 8192
    buffer_load_dwordx4 v2, s[12:15], s44 offen lds
    s_waitcnt lgkmcnt(10)
    v_mfma_f32_16x16x32_bf16 v[112:115], v[16:19], v[40:43], v[112:115]
    v_mfma_f32_16x16x32_bf16 v[116:119], v[20:23], v[40:43], v[116:119]
    ds_read_b128 v[68:71], v4 offset:4096
    s_add_u32 m0, s35, 20064
    s_add_u32 s44, s44, 8192
    buffer_load_dwordx4 v2, s[12:15], s44 offen lds
    s_waitcnt lgkmcnt(10)
    v_mfma_f32_16x16x32_bf16 v[120:123], v[16:19], v[44:47], v[120:123]
    v_mfma_f32_16x16x32_bf16 v[124:127], v[20:23], v[44:47], v[124:127]
    ds_read_b128 v[72:75], v4 offset:6144
    s_add_u32 m0, s35, 33792
    s_add_u32 s44, s44, 237568
    buffer_load_dwordx4 v2, s[12:15], s44 offen lds
    s_waitcnt lgkmcnt(10)
    v_mfma_f32_16x16x32_bf16 v[128:131], v[16:19], v[48:51], v[128:131]
    v_mfma_f32_16x16x32_bf16 v[132:135], v[20:23], v[48:51], v[132:135]
    ds_read_b128 v[76:79], v4 offset:8192
    s_add_u32 m0, s35, 34848
    s_add_u32 s44, s44, 8192
    buffer_load_dwordx4 v2, s[12:15], s44 offen lds
    s_waitcnt lgkmcnt(10)
    v_mfma_f32_16x16x32_bf16 v[136:139], v[16:19], v[52:55], v[136:139]
    v_mfma_f32_16x16x32_bf16 v[140:143], v[20:23], v[52:55], v[140:143]
    ds_read_b128 v[80:83], v4 offset:10240
    s_add_u32 m0, s35, 35904
    s_add_u32 s44, s44, 8192
    buffer_load_dwordx4 v2, s[12:15], s44 offen lds
    s_waitcnt lgkmcnt(10)
    v_mfma_f32_16x16x32_bf16 v[144:147], v[16:19], v[56:59], v[144:147]
    v_mfma_f32_16x16x32_bf16 v[148:151], v[20:23], v[56:59], v[148:151]
    ds_read_b128 v[84:87], v4 offset:12288
    s_add_u32 m0, s35, 36960
    s_add_u32 s44, s44, 8192
    buffer_load_dwordx4 v2, s[12:15], s44 offen lds
    s_add_u32 s47, s47, 524288
    s_add_u32 s49, s49, 128
    s_cmp_eq_u32 s49, 896
    s_cselect_b32 s47, 0, s47
    s_cselect_b32 s49, 0, s49
    s_waitcnt vmcnt(12)
    s_waitcnt lgkmcnt(0)
    s_barrier
    v_add_u32 v3, 4294916608, v3
    v_add_u32 v4, 4294916608, v4
    v_add_u32 v5, 4294916608, v5
    v_mfma_f32_16x16x32_bf16 v[96:99], v[24:27], v[60:63], v[96:99]
    v_mfma_f32_16x16x32_bf16 v[100:103], v[28:31], v[60:63], v[100:103]
    ds_read_b64_tr_b16 v[16:17], v5 offset:0
    ds_read_b64_tr_b16 v[18:19], v5 offset:512
    ds_read_b64_tr_b16 v[20:21], v5 offset:8
    ds_read_b64_tr_b16 v[22:23], v5 offset:520
    v_mfma_f32_16x16x32_bf16 v[104:107], v[24:27], v[64:67], v[104:107]
    v_mfma_f32_16x16x32_bf16 v[108:111], v[28:31], v[64:67], v[108:111]
    ds_read_b128 v[32:35], v3 offset:0
    v_mfma_f32_16x16x32_bf16 v[112:115], v[24:27], v[68:71], v[112:115]
    v_mfma_f32_16x16x32_bf16 v[116:119], v[28:31], v[68:71], v[116:119]
    ds_read_b128 v[36:39], v3 offset:2048
    s_add_u32 m0, s52, 101376
    s_add_u32 s44, s49, s43
    buffer_load_dwordx4 v1, s[8:11], s44 offen lds
    v_mfma_f32_16x16x32_bf16 v[120:123], v[24:27], v[72:75], v[120:123]
    v_mfma_f32_16x16x32_bf16 v[124:127], v[28:31], v[72:75], v[124:127]
    ds_read_b128 v[40:43], v3 offset:4096
    s_add_u32 m0, s52, 102400
    s_add_u32 s44, s44, 7168
    buffer_load_dwordx4 v1, s[8:11], s44 offen lds
    v_mfma_f32_16x16x32_bf16 v[128:131], v[24:27], v[76:79], v[128:131]
    v_mfma_f32_16x16x32_bf16 v[132:135], v[28:31], v[76:79], v[132:135]
    ds_read_b128 v[44:47], v3 offset:6144
    s_add_u32 m0, s52, 103424
    s_add_u32 s44, s44, 7168
    buffer_load_dwordx4 v1, s[8:11], s44 offen lds
    v_mfma_f32_16x16x32_bf16 v[136:139], v[24:27], v[80:83], v[136:139]
    v_mfma_f32_16x16x32_bf16 v[140:143], v[28:31], v[80:83], v[140:143]
    ds_read_b128 v[48:51], v3 offset:8192
    s_add_u32 m0, s52, 104448
    s_add_u32 s44, s44, 7168
    buffer_load_dwordx4 v1, s[8:11], s44 offen lds
    v_mfma_f32_16x16x32_bf16 v[144:147], v[24:27], v[84:87], v[144:147]
    v_mfma_f32_16x16x32_bf16 v[148:151], v[28:31], v[84:87], v[148:151]
    ds_read_b128 v[52:55], v3 offset:10240
    s_add_u32 m0, s35, 118272
    s_add_u32 s44, s47, s45
    buffer_load_dwordx4 v2, s[12:15], s44 offen lds
    ds_read_b128 v[56:59], v3 offset:12288
    ds_read_b64_tr_b16 v[24:25], v5 offset:16896
    ds_read_b64_tr_b16 v[26:27], v5 offset:17408
    ds_read_b64_tr_b16 v[28:29], v5 offset:16904
    ds_read_b64_tr_b16 v[30:31], v5 offset:17416
    s_waitcnt lgkmcnt(10)
    v_mfma_f32_16x16x32_bf16 v[96:99], v[16:19], v[32:35], v[96:99]
    v_mfma_f32_16x16x32_bf16 v[100:103], v[20:23], v[32:35], v[100:103]
    ds_read_b128 v[60:63], v4 offset:0
    s_add_u32 m0, s35, 119328
    s_add_u32 s44, s44, 8192
    buffer_load_dwordx4 v2, s[12:15], s44 offen lds
    s_waitcnt lgkmcnt(10)
    v_mfma_f32_16x16x32_bf16 v[104:107], v[16:19], v[36:39], v[104:107]
    v_mfma_f32_16x16x32_bf16 v[108:111], v[20:23], v[36:39], v[108:111]
    ds_read_b128 v[64:67], v4 offset:2048
    s_add_u32 m0, s35, 120384
    s_add_u32 s44, s44, 8192
    buffer_load_dwordx4 v2, s[12:15], s44 offen lds
    s_waitcnt lgkmcnt(10)
    v_mfma_f32_16x16x32_bf16 v[112:115], v[16:19], v[40:43], v[112:115]
    v_mfma_f32_16x16x32_bf16 v[116:119], v[20:23], v[40:43], v[116:119]
    ds_read_b128 v[68:71], v4 offset:4096
    s_add_u32 m0, s35, 121440
    s_add_u32 s44, s44, 8192
    buffer_load_dwordx4 v2, s[12:15], s44 offen lds
    s_waitcnt lgkmcnt(10)
    v_mfma_f32_16x16x32_bf16 v[120:123], v[16:19], v[44:47], v[120:123]
    v_mfma_f32_16x16x32_bf16 v[124:127], v[20:23], v[44:47], v[124:127]
    ds_read_b128 v[72:75], v4 offset:6144
    s_add_u32 m0, s35, 135168
    s_add_u32 s44, s44, 237568
    buffer_load_dwordx4 v2, s[12:15], s44 offen lds
    s_waitcnt lgkmcnt(10)
    v_mfma_f32_16x16x32_bf16 v[128:131], v[16:19], v[48:51], v[128:131]
    v_mfma_f32_16x16x32_bf16 v[132:135], v[20:23], v[48:51], v[132:135]
    ds_read_b128 v[76:79], v4 offset:8192
    s_add_u32 m0, s35, 136224
    s_add_u32 s44, s44, 8192
    buffer_load_dwordx4 v2, s[12:15], s44 offen lds
    s_waitcnt lgkmcnt(10)
    v_mfma_f32_16x16x32_bf16 v[136:139], v[16:19], v[52:55], v[136:139]
    v_mfma_f32_16x16x32_bf16 v[140:143], v[20:23], v[52:55], v[140:143]
    ds_read_b128 v[80:83], v4 offset:10240
    s_add_u32 m0, s35, 137280
    s_add_u32 s44, s44, 8192
    buffer_load_dwordx4 v2, s[12:15], s44 offen lds
    s_waitcnt lgkmcnt(10)
    v_mfma_f32_16x16x32_bf16 v[144:147], v[16:19], v[56:59], v[144:147]
    v_mfma_f32_16x16x32_bf16 v[148:151], v[20:23], v[56:59], v[148:151]
    ds_read_b128 v[84:87], v4 offset:12288
    s_add_u32 m0, s35, 138336
    s_add_u32 s44, s44, 8192
    buffer_load_dwordx4 v2, s[12:15], s44 offen lds
    s_add_u32 s47, s47, 524288
    s_add_u32 s49, s49, 128
    s_cmp_eq_u32 s49, 896
    s_cselect_b32 s47, 0, s47
    s_cselect_b32 s49, 0, s49
    s_waitcnt vmcnt(12)
    s_waitcnt lgkmcnt(0)
    s_barrier
    v_add_u32 v3, 4294916608, v3
    v_add_u32 v4, 4294916608, v4
    v_add_u32 v5, 4294916608, v5
    s_lshl_b32 s45, s32, 10
    s_mul_i32 s43, s32, 2112
    v_mfma_f32_16x16x32_bf16 v[96:99], v[24:27], v[60:63], v[96:99]
    v_mfma_f32_16x16x32_bf16 v[100:103], v[28:31], v[60:63], v[100:103]
    ds_read_b64_tr_b16 v[16:17], v5 offset:0
    ds_read_b64_tr_b16 v[18:19], v5 offset:512
    ds_read_b64_tr_b16 v[20:21], v5 offset:8
    ds_read_b64_tr_b16 v[22:23], v5 offset:520
    s_add_u32 m0, s43, 50688
    s_add_u32 s44, s45, 0
    buffer_load_dwordx4 v8, s[16:19], s44 offen offset:0 nt lds
    v_mfma_f32_16x16x32_bf16 v[104:107], v[24:27], v[64:67], v[104:107]
    v_mfma_f32_16x16x32_bf16 v[108:111], v[28:31], v[64:67], v[108:111]
    ds_read_b128 v[32:35], v3 offset:0
    s_add_u32 m0, s43, 51232
    s_add_u32 s44, s45, 0
    buffer_load_dwordx4 v8, s[16:19], s44 offen offset:512 nt lds
    v_mfma_f32_16x16x32_bf16 v[112:115], v[24:27], v[68:71], v[112:115]
    v_mfma_f32_16x16x32_bf16 v[116:119], v[28:31], v[68:71], v[116:119]
    ds_read_b128 v[36:39], v3 offset:2048
    v_mfma_f32_16x16x32_bf16 v[120:123], v[24:27], v[72:75], v[120:123]
    v_mfma_f32_16x16x32_bf16 v[124:127], v[28:31], v[72:75], v[124:127]
    ds_read_b128 v[40:43], v3 offset:4096
    s_add_u32 m0, s43, 67584
    s_add_u32 s44, s45, 16384
    buffer_load_dwordx4 v8, s[16:19], s44 offen offset:0 nt lds
    v_mfma_f32_16x16x32_bf16 v[128:131], v[24:27], v[76:79], v[128:131]
    v_mfma_f32_16x16x32_bf16 v[132:135], v[28:31], v[76:79], v[132:135]
    ds_read_b128 v[44:47], v3 offset:6144
    v_mfma_f32_16x16x32_bf16 v[136:139], v[24:27], v[80:83], v[136:139]
    v_mfma_f32_16x16x32_bf16 v[140:143], v[28:31], v[80:83], v[140:143]
    ds_read_b128 v[48:51], v3 offset:8192
    s_add_u32 m0, s43, 68128
    s_add_u32 s44, s45, 16384
    buffer_load_dwordx4 v8, s[16:19], s44 offen offset:512 nt lds
    v_mfma_f32_16x16x32_bf16 v[144:147], v[24:27], v[84:87], v[144:147]
    v_mfma_f32_16x16x32_bf16 v[148:151], v[28:31], v[84:87], v[148:151]
    ds_read_b128 v[52:55], v3 offset:10240
    s_add_u32 m0, s43, 84480
    s_add_u32 s44, s45, 0
    buffer_load_dwordx4 v8, s[20:23], s44 offen offset:0 nt lds
    ds_read_b128 v[56:59], v3 offset:12288
    ds_read_b64_tr_b16 v[24:25], v5 offset:16896
    ds_read_b64_tr_b16 v[26:27], v5 offset:17408
    ds_read_b64_tr_b16 v[28:29], v5 offset:16904
    ds_read_b64_tr_b16 v[30:31], v5 offset:17416
    s_waitcnt lgkmcnt(10)
    v_mfma_f32_16x16x32_bf16 v[96:99], v[16:19], v[32:35], v[96:99]
    v_mfma_f32_16x16x32_bf16 v[100:103], v[20:23], v[32:35], v[100:103]
    ds_read_b128 v[60:63], v4 offset:0
    s_waitcnt lgkmcnt(10)
    v_mfma_f32_16x16x32_bf16 v[104:107], v[16:19], v[36:39], v[104:107]
    v_mfma_f32_16x16x32_bf16 v[108:111], v[20:23], v[36:39], v[108:111]
    ds_read_b128 v[64:67], v4 offset:2048
    s_add_u32 m0, s43, 85024
    s_add_u32 s44, s45, 0
    buffer_load_dwordx4 v8, s[20:23], s44 offen offset:512 nt lds
    s_waitcnt lgkmcnt(10)
    v_mfma_f32_16x16x32_bf16 v[112:115], v[16:19], v[40:43], v[112:115]
    v_mfma_f32_16x16x32_bf16 v[116:119], v[20:23], v[40:43], v[116:119]
    ds_read_b128 v[68:71], v4 offset:4096
    s_waitcnt lgkmcnt(10)
    v_mfma_f32_16x16x32_bf16 v[120:123], v[16:19], v[44:47], v[120:123]
    v_mfma_f32_16x16x32_bf16 v[124:127], v[20:23], v[44:47], v[124:127]
    ds_read_b128 v[72:75], v4 offset:6144
    s_waitcnt lgkmcnt(10)
    v_mfma_f32_16x16x32_bf16 v[128:131], v[16:19], v[48:51], v[128:131]
    v_mfma_f32_16x16x32_bf16 v[132:135], v[20:23], v[48:51], v[132:135]
    ds_read_b128 v[76:79], v4 offset:8192
    s_waitcnt lgkmcnt(10)
    v_mfma_f32_16x16x32_bf16 v[136:139], v[16:19], v[52:55], v[136:139]
    v_mfma_f32_16x16x32_bf16 v[140:143], v[20:23], v[52:55], v[140:143]
    ds_read_b128 v[80:83], v4 offset:10240
    s_waitcnt lgkmcnt(10)
    v_mfma_f32_16x16x32_bf16 v[144:147], v[16:19], v[56:59], v[144:147]
    v_mfma_f32_16x16x32_bf16 v[148:151], v[20:23], v[56:59], v[148:151]
    ds_read_b128 v[84:87], v4 offset:12288
    s_waitcnt vmcnt(6)
    s_waitcnt lgkmcnt(0)
    s_barrier
    v_add_u32 v3, 101376, v3
    v_add_u32 v4, 101376, v4
    v_add_u32 v5, 101376, v5
    v_mfma_f32_16x16x32_bf16 v[96:99], v[24:27], v[60:63], v[96:99]
    v_mfma_f32_16x16x32_bf16 v[100:103], v[28:31], v[60:63], v[100:103]
    ds_read_b64_tr_b16 v[16:17], v5 offset:0
    ds_read_b64_tr_b16 v[18:19], v5 offset:512
    ds_read_b64_tr_b16 v[20:21], v5 offset:8
    ds_read_b64_tr_b16 v[22:23], v5 offset:520
    v_mfma_f32_16x16x32_bf16 v[104:107], v[24:27], v[64:67], v[104:107]
    v_mfma_f32_16x16x32_bf16 v[108:111], v[28:31], v[64:67], v[108:111]
    ds_read_b128 v[32:35], v3 offset:0
    v_mfma_f32_16x16x32_bf16 v[112:115], v[24:27], v[68:71], v[112:115]
    v_mfma_f32_16x16x32_bf16 v[116:119], v[28:31], v[68:71], v[116:119]
    ds_read_b128 v[36:39], v3 offset:2048
    v_mfma_f32_16x16x32_bf16 v[120:123], v[24:27], v[72:75], v[120:123]
    v_mfma_f32_16x16x32_bf16 v[124:127], v[28:31], v[72:75], v[124:127]
    ds_read_b128 v[40:43], v3 offset:4096
    v_mfma_f32_16x16x32_bf16 v[128:131], v[24:27], v[76:79], v[128:131]
    v_mfma_f32_16x16x32_bf16 v[132:135], v[28:31], v[76:79], v[132:135]
    ds_read_b128 v[44:47], v3 offset:6144
    v_mfma_f32_16x16x32_bf16 v[136:139], v[24:27], v[80:83], v[136:139]
    v_mfma_f32_16x16x32_bf16 v[140:143], v[28:31], v[80:83], v[140:143]
    ds_read_b128 v[48:51], v3 offset:8192
    v_mfma_f32_16x16x32_bf16 v[144:147], v[24:27], v[84:87], v[144:147]
    v_mfma_f32_16x16x32_bf16 v[148:151], v[28:31], v[84:87], v[148:151]
    ds_read_b128 v[52:55], v3 offset:10240
    ds_read_b128 v[56:59], v3 offset:12288
    ds_read_b64_tr_b16 v[24:25], v5 offset:16896
    ds_read_b64_tr_b16 v[26:27], v5 offset:17408
    ds_read_b64_tr_b16 v[28:29], v5 offset:16904
    ds_read_b64_tr_b16 v[30:31], v5 offset:17416
    s_waitcnt lgkmcnt(10)
    v_mfma_f32_16x16x32_bf16 v[96:99], v[16:19], v[32:35], v[96:99]
    v_mfma_f32_16x16x32_bf16 v[100:103], v[20:23], v[32:35], v[100:103]
    ds_read_b128 v[60:63], v4 offset:0
    s_waitcnt lgkmcnt(10)
    v_mfma_f32_16x16x32_bf16 v[104:107], v[16:19], v[36:39], v[104:107]
    v_mfma_f32_16x16x32_bf16 v[108:111], v[20:23], v[36:39], v[108:111]
    ds_read_b128 v[64:67], v4 offset:2048
    s_waitcnt lgkmcnt(10)
    v_mfma_f32_16x16x32_bf16 v[112:115], v[16:19], v[40:43], v[112:115]
    v_mfma_f32_16x16x32_bf16 v[116:119], v[20:23], v[40:43], v[116:119]
    ds_read_b128 v[68:71], v4 offset:4096
    s_waitcnt lgkmcnt(10)
    v_mfma_f32_16x16x32_bf16 v[120:123], v[16:19], v[44:47], v[120:123]
    v_mfma_f32_16x16x32_bf16 v[124:127], v[20:23], v[44:47], v[124:127]
    ds_read_b128 v[72:75], v4 offset:6144
    s_waitcnt lgkmcnt(10)
    v_mfma_f32_16x16x32_bf16 v[128:131], v[16:19], v[48:51], v[128:131]
    v_mfma_f32_16x16x32_bf16 v[132:135], v[20:23], v[48:51], v[132:135]
    ds_read_b128 v[76:79], v4 offset:8192
    s_waitcnt lgkmcnt(10)
    v_mfma_f32_16x16x32_bf16 v[136:139], v[16:19], v[52:55], v[136:139]
    v_mfma_f32_16x16x32_bf16 v[140:143], v[20:23], v[52:55], v[140:143]
    ds_read_b128 v[80:83], v4 offset:10240
    s_waitcnt lgkmcnt(10)
    v_mfma_f32_16x16x32_bf16 v[144:147], v[16:19], v[56:59], v[144:147]
    v_mfma_f32_16x16x32_bf16 v[148:151], v[20:23], v[56:59], v[148:151]
    ds_read_b128 v[84:87], v4 offset:12288
    v_lshlrev_b32 v6, 4, v0
    s_lshl_b32 s42, s32, 10
    v_add_u32 v6, s42, v6
    s_waitcnt lgkmcnt(6)
    v_mfma_f32_16x16x32_bf16 v[96:99], v[24:27], v[60:63], v[96:99]
    v_mfma_f32_16x16x32_bf16 v[100:103], v[28:31], v[60:63], v[100:103]
    s_waitcnt lgkmcnt(5)
    v_mfma_f32_16x16x32_bf16 v[104:107], v[24:27], v[64:67], v[104:107]
    v_mfma_f32_16x16x32_bf16 v[108:111], v[28:31], v[64:67], v[108:111]
    s_waitcnt lgkmcnt(4)
    v_mfma_f32_16x16x32_bf16 v[112:115], v[24:27], v[68:71], v[112:115]
    v_mfma_f32_16x16x32_bf16 v[116:119], v[28:31], v[68:71], v[116:119]
    s_waitcnt lgkmcnt(3)
    v_mfma_f32_16x16x32_bf16 v[120:123], v[24:27], v[72:75], v[120:123]
    v_mfma_f32_16x16x32_bf16 v[124:127], v[28:31], v[72:75], v[124:127]
    v_pk_mul_f32 v[96:97], v[96:97], s[40:41] op_sel_hi:[1,0]
    v_pk_mul_f32 v[98:99], v[98:99], s[40:41] op_sel_hi:[1,0]
    v_pk_mul_f32 v[100:101], v[100:101], s[40:41] op_sel_hi:[1,0]
    v_pk_mul_f32 v[102:103], v[102:103], s[40:41] op_sel_hi:[1,0]
    v_cvt_pk_bf16_f32 v152, v96, v97
    v_cvt_pk_bf16_f32 v153, v98, v99
    v_cvt_pk_bf16_f32 v154, v100, v101
    v_cvt_pk_bf16_f32 v155, v102, v103
    ds_write_b128 v6, v[152:155] offset:0
    s_waitcnt lgkmcnt(3)
    v_mfma_f32_16x16x32_bf16 v[128:131], v[24:27], v[76:79], v[128:131]
    v_mfma_f32_16x16x32_bf16 v[132:135], v[28:31], v[76:79], v[132:135]
    v_pk_mul_f32 v[104:105], v[104:105], s[40:41] op_sel_hi:[1,0]
    v_pk_mul_f32 v[106:107], v[106:107], s[40:41] op_sel_hi:[1,0]
    v_pk_mul_f32 v[108:109], v[108:109], s[40:41] op_sel_hi:[1,0]
    v_pk_mul_f32 v[110:111], v[110:111], s[40:41] op_sel_hi:[1,0]
    v_cvt_pk_bf16_f32 v156, v104, v105
    v_cvt_pk_bf16_f32 v157, v106, v107
    v_cvt_pk_bf16_f32 v158, v108, v109
    v_cvt_pk_bf16_f32 v159, v110, v111
    ds_write_b128 v6, v[156:159] offset:8192
    s_waitcnt lgkmcnt(3)
    v_mfma_f32_16x16x32_bf16 v[136:139], v[24:27], v[80:83], v[136:139]
    v_mfma_f32_16x16x32_bf16 v[140:143], v[28:31], v[80:83], v[140:143]
    v_pk_mul_f32 v[112:113], v[112:113], s[40:41] op_sel_hi:[1,0]
    v_pk_mul_f32 v[114:115], v[114:115], s[40:41] op_sel_hi:[1,0]
    v_pk_mul_f32 v[116:117], v[116:117], s[40:41] op_sel_hi:[1,0]
    v_pk_mul_f32 v[118:119], v[118:119], s[40:41] op_sel_hi:[1,0]
    v_cvt_pk_bf16_f32 v160, v112, v113
    v_cvt_pk_bf16_f32 v161, v114, v115
    v_cvt_pk_bf16_f32 v162, v116, v117
    v_cvt_pk_bf16_f32 v163, v118, v119
    ds_write_b128 v6, v[160:163] offset:16896
    s_waitcnt lgkmcnt(3)
    v_mfma_f32_16x16x32_bf16 v[144:147], v[24:27], v[84:87], v[144:147]
    v_mfma_f32_16x16x32_bf16 v[148:151], v[28:31], v[84:87], v[148:151]
    v_pk_mul_f32 v[120:121], v[120:121], s[40:41] op_sel_hi:[1,0]
    v_pk_mul_f32 v[122:123], v[122:123], s[40:41] op_sel_hi:[1,0]
    v_pk_mul_f32 v[124:125], v[124:125], s[40:41] op_sel_hi:[1,0]
    v_pk_mul_f32 v[126:127], v[126:127], s[40:41] op_sel_hi:[1,0]
    v_cvt_pk_bf16_f32 v164, v120, v121
    v_cvt_pk_bf16_f32 v165, v122, v123
    v_cvt_pk_bf16_f32 v166, v124, v125
    v_cvt_pk_bf16_f32 v167, v126, v127
    ds_write_b128 v6, v[164:167] offset:25088
    v_pk_mul_f32 v[128:129], v[128:129], s[40:41] op_sel_hi:[1,0]
    v_pk_mul_f32 v[130:131], v[130:131], s[40:41] op_sel_hi:[1,0]
    v_pk_mul_f32 v[132:133], v[132:133], s[40:41] op_sel_hi:[1,0]
    v_pk_mul_f32 v[134:135], v[134:135], s[40:41] op_sel_hi:[1,0]
    v_cvt_pk_bf16_f32 v168, v128, v129
    v_cvt_pk_bf16_f32 v169, v130, v131
    v_cvt_pk_bf16_f32 v170, v132, v133
    v_cvt_pk_bf16_f32 v171, v134, v135
    ds_write_b128 v6, v[168:171] offset:33792
    v_pk_mul_f32 v[136:137], v[136:137], s[40:41] op_sel_hi:[1,0]
    v_pk_mul_f32 v[138:139], v[138:139], s[40:41] op_sel_hi:[1,0]
    v_pk_mul_f32 v[140:141], v[140:141], s[40:41] op_sel_hi:[1,0]
    v_pk_mul_f32 v[142:143], v[142:143], s[40:41] op_sel_hi:[1,0]
    v_cvt_pk_bf16_f32 v172, v136, v137
    v_cvt_pk_bf16_f32 v173, v138, v139
    v_cvt_pk_bf16_f32 v174, v140, v141
    v_cvt_pk_bf16_f32 v175, v142, v143
    ds_write_b128 v6, v[172:175] offset:41984
    v_pk_mul_f32 v[144:145], v[144:145], s[40:41] op_sel_hi:[1,0]
    v_pk_mul_f32 v[146:147], v[146:147], s[40:41] op_sel_hi:[1,0]
    v_pk_mul_f32 v[148:149], v[148:149], s[40:41] op_sel_hi:[1,0]
    v_pk_mul_f32 v[150:151], v[150:151], s[40:41] op_sel_hi:[1,0]
    v_cvt_pk_bf16_f32 v176, v144, v145
    v_cvt_pk_bf16_f32 v177, v146, v147
    v_cvt_pk_bf16_f32 v178, v148, v149
    v_cvt_pk_bf16_f32 v179, v150, v151
    v_add_u32 v6, 152064, v6
    ds_write_b128 v6, v[176:179] offset:0
    s_setprio 0
    s_mov_b32 s39, 0
    v_lshrrev_b32 v1, 2, v0
    v_mul_u32_u24 v1, 1056, v1
    v_and_b32 v6, 3, v0
    v_lshl_add_u32 v1, v6, 3, v1
    v_lshlrev_b32 v2, 4, v0
    v_and_b32 v4, 7, v0
    v_lshlrev_b32 v4, 2, v4
    v_add_u32 v4, 160256, v4
    v_lshrrev_b32 v9, 3, v0
    v_mul_u32_u24 v9, 14336, v9
    v_and_b32 v6, 7, v0
    v_lshl_add_u32 v9, v6, 4, v9
    s_mul_i32 s42, s33, 3584
    v_add_u32 v9, s42, v9
    s_lshl_b32 s47, s6, 7
    s_waitcnt lgkmcnt(0)
    s_waitcnt vmcnt(2)
    s_cmp_eq_u32 s32, 7
    s_cbranch_scc1 L_owave7
    s_lshl_b32 s42, s33, 7
    v_add_u32 v1, s42, v1
    s_barrier
    s_add_u32 m0, s35, 118272
    s_nop 0
    buffer_load_dwordx4 v8, s[20:23], s37 offen offset:0 nt lds
    s_add_u32 m0, s35, 118816
    s_nop 0
    buffer_load_dwordx4 v8, s[20:23], s37 offen offset:512 nt lds
    s_add_u32 m0, s35, 119360
    s_nop 0
    buffer_load_dwordx4 v8, s[20:23], s37 offen offset:1024 nt lds
    s_add_u32 m0, s35, 119904
    s_nop 0
    buffer_load_dwordx4 v8, s[20:23], s37 offen offset:1536 nt lds
    s_add_u32 s37, s37, 16384
    v_mov_b32 v68, 0
    v_mov_b32 v69, 0
    v_mov_b32 v70, 0
    v_mov_b32 v71, 0
    v_mov_b32 v72, 0
    v_mov_b32 v73, 0
    v_mov_b32 v74, 0
    v_mov_b32 v75, 0
    v_mov_b32 v76, 0
    v_mov_b32 v77, 0
    v_mov_b32 v78, 0
    v_mov_b32 v79, 0
    v_mov_b32 v80, 0
    v_mov_b32 v81, 0
    v_mov_b32 v82, 0
    v_mov_b32 v83, 0
    v_mov_b32 v84, 0
    v_mov_b32 v85, 0
    v_mov_b32 v86, 0
    v_mov_b32 v87, 0
    v_mov_b32 v88, 0
    v_mov_b32 v89, 0
    v_mov_b32 v90, 0
    v_mov_b32 v91, 0
    v_mov_b32 v92, 0
    v_mov_b32 v93, 0
    v_mov_b32 v94, 0
    v_mov_b32 v95, 0
    v_mov_b32 v96, 0
    v_mov_b32 v97, 0
    v_mov_b32 v98, 0
    v_mov_b32 v99, 0
    v_mov_b32 v100, 0
    v_mov_b32 v101, 0
    v_mov_b32 v102, 0
    v_mov_b32 v103, 0
    v_mov_b32 v104, 0
    v_mov_b32 v105, 0
    v_mov_b32 v106, 0
    v_mov_b32 v107, 0
    v_mov_b32 v108, 0
    v_mov_b32 v109, 0
    v_mov_b32 v110, 0
    v_mov_b32 v111, 0
    v_mov_b32 v112, 0
    v_mov_b32 v113, 0
    v_mov_b32 v114, 0
    v_mov_b32 v115, 0
    v_mov_b32 v116, 0
    v_mov_b32 v117, 0
    v_mov_b32 v118, 0
    v_mov_b32 v119, 0
    v_mov_b32 v120, 0
    v_mov_b32 v121, 0
    v_mov_b32 v122, 0
    v_mov_b32 v123, 0
    v_mov_b32 v124, 0
    v_mov_b32 v125, 0
    v_mov_b32 v126, 0
    v_mov_b32 v127, 0
    v_mov_b32 v128, 0
    v_mov_b32 v129, 0
    v_mov_b32 v130, 0
    v_mov_b32 v131, 0
    v_mov_b32 v132, 0
    v_mov_b32 v133, 0
    v_mov_b32 v134, 0
    v_mov_b32 v135, 0
    v_mov_b32 v136, 0
    v_mov_b32 v137, 0
    v_mov_b32 v138, 0
    v_mov_b32 v139, 0
    v_mov_b32 v140, 0
    v_mov_b32 v141, 0
    v_mov_b32 v142, 0
    v_mov_b32 v143, 0
    v_mov_b32 v144, 0
    v_mov_b32 v145, 0
    v_mov_b32 v146, 0
    v_mov_b32 v147, 0
    v_mov_b32 v148, 0
    v_mov_b32 v149, 0
    v_mov_b32 v150, 0
    v_mov_b32 v151, 0
    v_mov_b32 v152, 0
    v_mov_b32 v153, 0
    v_mov_b32 v154, 0
    v_mov_b32 v155, 0
    v_mov_b32 v156, 0
    v_mov_b32 v157, 0
    v_mov_b32 v158, 0
    v_mov_b32 v159, 0
    v_mov_b32 v160, 0
    v_mov_b32 v161, 0
    v_mov_b32 v162, 0
    v_mov_b32 v163, 0
    v_mov_b32 v164, 0
    v_mov_b32 v165, 0
    v_mov_b32 v166, 0
    v_mov_b32 v167, 0
    v_mov_b32 v168, 0
    v_mov_b32 v169, 0
    v_mov_b32 v170, 0
    v_mov_b32 v171, 0
    v_mov_b32 v172, 0
    v_mov_b32 v173, 0
    v_mov_b32 v174, 0
    v_mov_b32 v175, 0
    v_mov_b32 v176, 0
    v_mov_b32 v177, 0
    v_mov_b32 v178, 0
    v_mov_b32 v179, 0
    s_waitcnt vmcnt(4)
    s_barrier
    s_add_u32 m0, s35, 16896
    s_nop 0
    buffer_load_dwordx4 v8, s[20:23], s37 offen offset:0 nt lds
    s_add_u32 m0, s35, 17440
    s_nop 0
    buffer_load_dwordx4 v8, s[20:23], s37 offen offset:512 nt lds
    s_add_u32 m0, s35, 17984
    s_nop 0
    buffer_load_dwordx4 v8, s[20:23], s37 offen offset:1024 nt lds
    s_add_u32 m0, s35, 18528
    s_nop 0
    buffer_load_dwordx4 v8, s[20:23], s37 offen offset:1536 nt lds
    s_add_u32 s37, s37, 16384
    v_add_u32 v1, 84480, v1
    ds_read_b64_tr_b16 v[12:13], v1 offset:0
    ds_read_b64_tr_b16 v[14:15], v1 offset:512
    ds_read_b64_tr_b16 v[16:17], v1 offset:32
    ds_read_b64_tr_b16 v[18:19], v1 offset:544
    ds_read_b64_tr_b16 v[20:21], v1 offset:64
    ds_read_b64_tr_b16 v[22:23], v1 offset:576
    ds_read_b64_tr_b16 v[24:25], v1 offset:96
    ds_read_b64_tr_b16 v[26:27], v1 offset:608
    s_waitcnt vmcnt(4)
    s_barrier
    ds_read_b32 v5, v4 offset:0
    ds_read_b128 v[228:231], v2 offset:0
    ds_read_b128 v[232:235], v2 offset:1024
    ds_read_b128 v[236:239], v2 offset:2048
    ds_read_b128 v[240:243], v2 offset:3072
    ds_read_b128 v[244:247], v2 offset:4096
    ds_read_b128 v[248:251], v2 offset:5120
    ds_read_b128 v[252:255], v2 offset:6144
    s_add_u32 s39, s39, 1
    s_add_u32 m0, s35, 33792
    s_nop 0
    buffer_load_dwordx4 v8, s[20:23], s37 offen offset:0 nt lds
    s_waitcnt lgkmcnt(7)
    v_cmp_eq_u32 vcc, s39, v5
    s_cbranch_vccnz L_stub_oa2
L_back_oa2:
    s_waitcnt lgkmcnt(6)
    v_mfma_f32_16x16x32_bf16 v[68:71], v[12:15], v[228:231], v[68:71]
    v_mfma_f32_16x16x32_bf16 v[72:75], v[16:19], v[228:231], v[72:75]
    v_mfma_f32_16x16x32_bf16 v[76:79], v[20:23], v[228:231], v[76:79]
    v_mfma_f32_16x16x32_bf16 v[80:83], v[24:27], v[228:231], v[80:83]
    s_add_u32 m0, s35, 34336
    s_nop 0
    buffer_load_dwordx4 v8, s[20:23], s37 offen offset:512 nt lds
    s_waitcnt lgkmcnt(5)
    v_mfma_f32_16x16x32_bf16 v[84:87], v[12:15], v[232:235], v[84:87]
    v_mfma_f32_16x16x32_bf16 v[88:91], v[16:19], v[232:235], v[88:91]
    v_mfma_f32_16x16x32_bf16 v[92:95], v[20:23], v[232:235], v[92:95]
    v_mfma_f32_16x16x32_bf16 v[96:99], v[24:27], v[232:235], v[96:99]
    s_add_u32 m0, s35, 34880
    s_nop 0
    buffer_load_dwordx4 v8, s[20:23], s37 offen offset:1024 nt lds
    s_waitcnt lgkmcnt(4)
    v_mfma_f32_16x16x32_bf16 v[100:103], v[12:15], v[236:239], v[100:103]
    v_add_u32 v1, 33792, v1
    ds_read_b64_tr_b16 v[40:41], v1 offset:0
    v_mfma_f32_16x16x32_bf16 v[104:107], v[16:19], v[236:239], v[104:107]
    ds_read_b64_tr_b16 v[42:43], v1 offset:512
    v_mfma_f32_16x16x32_bf16 v[108:111], v[20:23], v[236:239], v[108:111]
    ds_read_b64_tr_b16 v[44:45], v1 offset:32
    v_mfma_f32_16x16x32_bf16 v[112:115], v[24:27], v[236:239], v[112:115]
    ds_read_b64_tr_b16 v[46:47], v1 offset:544
    s_add_u32 m0, s35, 35424
    s_nop 0
    buffer_load_dwordx4 v8, s[20:23], s37 offen offset:1536 nt lds
    s_add_u32 s37, s37, 16384
    s_waitcnt lgkmcnt(7)
    v_mfma_f32_16x16x32_bf16 v[116:119], v[12:15], v[240:243], v[116:119]
    ds_read_b64_tr_b16 v[48:49], v1 offset:64
    v_mfma_f32_16x16x32_bf16 v[120:123], v[16:19], v[240:243], v[120:123]
    ds_read_b64_tr_b16 v[50:51], v1 offset:576
    v_mfma_f32_16x16x32_bf16 v[124:127], v[20:23], v[240:243], v[124:127]
    ds_read_b64_tr_b16 v[52:53], v1 offset:96
    v_mfma_f32_16x16x32_bf16 v[128:131], v[24:27], v[240:243], v[128:131]
    ds_read_b64_tr_b16 v[54:55], v1 offset:608
    s_waitcnt lgkmcnt(10)
    v_mfma_f32_16x16x32_bf16 v[132:135], v[12:15], v[244:247], v[132:135]
    v_mfma_f32_16x16x32_bf16 v[136:139], v[16:19], v[244:247], v[136:139]
    v_mfma_f32_16x16x32_bf16 v[140:143], v[20:23], v[244:247], v[140:143]
    s_waitcnt lgkmcnt(9)
    v_mfma_f32_16x16x32_bf16 v[148:151], v[12:15], v[248:251], v[148:151]
    v_mfma_f32_16x16x32_bf16 v[152:155], v[16:19], v[248:251], v[152:155]
    v_mfma_f32_16x16x32_bf16 v[156:159], v[20:23], v[248:251], v[156:159]
    s_waitcnt lgkmcnt(8)
    v_mfma_f32_16x16x32_bf16 v[164:167], v[12:15], v[252:255], v[164:167]
    v_mfma_f32_16x16x32_bf16 v[168:171], v[16:19], v[252:255], v[168:171]
    v_mfma_f32_16x16x32_bf16 v[172:175], v[20:23], v[252:255], v[172:175]
    s_waitcnt vmcnt(4)
    s_barrier
    ds_read_b32 v5, v4 offset:128
    ds_read_b128 v[228:231], v2 offset:7168
    ds_read_b128 v[232:235], v2 offset:8192
    ds_read_b128 v[236:239], v2 offset:9216
    ds_read_b128 v[240:243], v2 offset:10240
    ds_read_b128 v[244:247], v2 offset:11264
    ds_read_b128 v[248:251], v2 offset:12288
    ds_read_b128 v[252:255], v2 offset:13312
    s_add_u32 s39, s39, 1
    s_add_u32 m0, s35, 84480
    s_nop 0
    buffer_load_dwordx4 v8, s[20:23], s37 offen offset:0 nt lds
    s_waitcnt lgkmcnt(7)
    v_cmp_eq_u32 vcc, s39, v5
    s_cbranch_vccnz L_stub_oa3
L_back_oa3:
    s_waitcnt lgkmcnt(6)
    v_mfma_f32_16x16x32_bf16 v[68:71], v[40:43], v[228:231], v[68:71]
    v_mfma_f32_16x16x32_bf16 v[72:75], v[44:47], v[228:231], v[72:75]
    v_mfma_f32_16x16x32_bf16 v[76:79], v[48:51], v[228:231], v[76:79]
    v_mfma_f32_16x16x32_bf16 v[80:83], v[52:55], v[228:231], v[80:83]
    s_add_u32 m0, s35, 85024
    s_nop 0
    buffer_load_dwordx4 v8, s[20:23], s37 offen offset:512 nt lds
    s_waitcnt lgkmcnt(5)
    v_mfma_f32_16x16x32_bf16 v[84:87], v[40:43], v[232:235], v[84:87]
    v_mfma_f32_16x16x32_bf16 v[88:91], v[44:47], v[232:235], v[88:91]
    v_mfma_f32_16x16x32_bf16 v[92:95], v[48:51], v[232:235], v[92:95]
    v_mfma_f32_16x16x32_bf16 v[96:99], v[52:55], v[232:235], v[96:99]
    s_add_u32 m0, s35, 85568
    s_nop 0
    buffer_load_dwordx4 v8, s[20:23], s37 offen offset:1024 nt lds
    s_waitcnt lgkmcnt(4)
    v_mfma_f32_16x16x32_bf16 v[100:103], v[40:43], v[236:239], v[100:103]
    v_add_u32 v1, 4294865920, v1
    ds_read_b64_tr_b16 v[12:13], v1 offset:0
    v_mfma_f32_16x16x32_bf16 v[104:107], v[44:47], v[236:239], v[104:107]
    ds_read_b64_tr_b16 v[14:15], v1 offset:512
    v_mfma_f32_16x16x32_bf16 v[108:111], v[48:51], v[236:239], v[108:111]
    ds_read_b64_tr_b16 v[16:17], v1 offset:32
    v_mfma_f32_16x16x32_bf16 v[112:115], v[52:55], v[236:239], v[112:115]
    ds_read_b64_tr_b16 v[18:19], v1 offset:544
    s_add_u32 m0, s35, 86112
    s_nop 0
    buffer_load_dwordx4 v8, s[20:23], s37 offen offset:1536 nt lds
    s_add_u32 s37, s37, 16384
    s_waitcnt lgkmcnt(7)
    v_mfma_f32_16x16x32_bf16 v[116:119], v[40:43], v[240:243], v[116:119]
    ds_read_b64_tr_b16 v[20:21], v1 offset:64
    v_mfma_f32_16x16x32_bf16 v[120:123], v[44:47], v[240:243], v[120:123]
    ds_read_b64_tr_b16 v[22:23], v1 offset:576
    v_mfma_f32_16x16x32_bf16 v[124:127], v[48:51], v[240:243], v[124:127]
    ds_read_b64_tr_b16 v[24:25], v1 offset:96
    v_mfma_f32_16x16x32_bf16 v[128:131], v[52:55], v[240:243], v[128:131]
    ds_read_b64_tr_b16 v[26:27], v1 offset:608
    s_waitcnt lgkmcnt(10)
    v_mfma_f32_16x16x32_bf16 v[132:135], v[40:43], v[244:247], v[132:135]
    v_mfma_f32_16x16x32_bf16 v[136:139], v[44:47], v[244:247], v[136:139]
    v_mfma_f32_16x16x32_bf16 v[140:143], v[48:51], v[244:247], v[140:143]
    s_waitcnt lgkmcnt(9)
    v_mfma_f32_16x16x32_bf16 v[148:151], v[40:43], v[248:251], v[148:151]
    v_mfma_f32_16x16x32_bf16 v[152:155], v[44:47], v[248:251], v[152:155]
    v_mfma_f32_16x16x32_bf16 v[156:159], v[48:51], v[248:251], v[156:159]
    s_waitcnt lgkmcnt(8)
    v_mfma_f32_16x16x32_bf16 v[164:167], v[40:43], v[252:255], v[164:167]
    v_mfma_f32_16x16x32_bf16 v[168:171], v[44:47], v[252:255], v[168:171]
    v_mfma_f32_16x16x32_bf16 v[172:175], v[48:51], v[252:255], v[172:175]
    s_waitcnt vmcnt(4)
    s_barrier
    ds_read_b32 v5, v4 offset:0
    ds_read_b128 v[228:231], v2 offset:0
    ds_read_b128 v[232:235], v2 offset:1024
    ds_read_b128 v[236:239], v2 offset:2048
    ds_read_b128 v[240:243], v2 offset:3072
    ds_read_b128 v[244:247], v2 offset:4096
    ds_read_b128 v[248:251], v2 offset:5120
    ds_read_b128 v[252:255], v2 offset:6144
    s_add_u32 s39, s39, 1
    s_add_u32 m0, s35, 118272
    s_nop 0
    buffer_load_dwordx4 v8, s[20:23], s37 offen offset:0 nt lds
    s_waitcnt lgkmcnt(7)
    v_cmp_eq_u32 vcc, s39, v5
    s_cbranch_vccnz L_stub_oa4
L_back_oa4:
    s_waitcnt lgkmcnt(6)
    v_mfma_f32_16x16x32_bf16 v[68:71], v[12:15], v[228:231], v[68:71]
    v_mfma_f32_16x16x32_bf16 v[72:75], v[16:19], v[228:231], v[72:75]
    v_mfma_f32_16x16x32_bf16 v[76:79], v[20:23], v[228:231], v[76:79]
    v_mfma_f32_16x16x32_bf16 v[80:83], v[24:27], v[228:231], v[80:83]
    s_add_u32 m0, s35, 118816
    s_nop 0
    buffer_load_dwordx4 v8, s[20:23], s37 offen offset:512 nt lds
    s_waitcnt lgkmcnt(5)
    v_mfma_f32_16x16x32_bf16 v[84:87], v[12:15], v[232:235], v[84:87]
    v_mfma_f32_16x16x32_bf16 v[88:91], v[16:19], v[232:235], v[88:91]
    v_mfma_f32_16x16x32_bf16 v[92:95], v[20:23], v[232:235], v[92:95]
    v_mfma_f32_16x16x32_bf16 v[96:99], v[24:27], v[232:235], v[96:99]
    s_add_u32 m0, s35, 119360
    s_nop 0
    buffer_load_dwordx4 v8, s[20:23], s37 offen offset:1024 nt lds
    s_waitcnt lgkmcnt(4)
    v_mfma_f32_16x16x32_bf16 v[100:103], v[12:15], v[236:239], v[100:103]
    v_add_u32 v1, 16896, v1
    ds_read_b64_tr_b16 v[40:41], v1 offset:0
    v_mfma_f32_16x16x32_bf16 v[104:107], v[16:19], v[236:239], v[104:107]
    ds_read_b64_tr_b16 v[42:43], v1 offset:512
    v_mfma_f32_16x16x32_bf16 v[108:111], v[20:23], v[236:239], v[108:111]
    ds_read_b64_tr_b16 v[44:45], v1 offset:32
    v_mfma_f32_16x16x32_bf16 v[112:115], v[24:27], v[236:239], v[112:115]
    ds_read_b64_tr_b16 v[46:47], v1 offset:544
    s_add_u32 m0, s35, 119904
    s_nop 0
    buffer_load_dwordx4 v8, s[20:23], s37 offen offset:1536 nt lds
    s_add_u32 s37, s37, 16384
    s_waitcnt lgkmcnt(7)
    v_mfma_f32_16x16x32_bf16 v[116:119], v[12:15], v[240:243], v[116:119]
    ds_read_b64_tr_b16 v[48:49], v1 offset:64
    v_mfma_f32_16x16x32_bf16 v[120:123], v[16:19], v[240:243], v[120:123]
    ds_read_b64_tr_b16 v[50:51], v1 offset:576
    v_mfma_f32_16x16x32_bf16 v[124:127], v[20:23], v[240:243], v[124:127]
    ds_read_b64_tr_b16 v[52:53], v1 offset:96
    v_mfma_f32_16x16x32_bf16 v[128:131], v[24:27], v[240:243], v[128:131]
    ds_read_b64_tr_b16 v[54:55], v1 offset:608
    s_waitcnt lgkmcnt(10)
    v_mfma_f32_16x16x32_bf16 v[132:135], v[12:15], v[244:247], v[132:135]
    v_mfma_f32_16x16x32_bf16 v[136:139], v[16:19], v[244:247], v[136:139]
    v_mfma_f32_16x16x32_bf16 v[140:143], v[20:23], v[244:247], v[140:143]
    s_waitcnt lgkmcnt(9)
    v_mfma_f32_16x16x32_bf16 v[148:151], v[12:15], v[248:251], v[148:151]
    v_mfma_f32_16x16x32_bf16 v[152:155], v[16:19], v[248:251], v[152:155]
    v_mfma_f32_16x16x32_bf16 v[156:159], v[20:23], v[248:251], v[156:159]
    s_waitcnt lgkmcnt(8)
    v_mfma_f32_16x16x32_bf16 v[164:167], v[12:15], v[252:255], v[164:167]
    v_mfma_f32_16x16x32_bf16 v[168:171], v[16:19], v[252:255], v[168:171]
    v_mfma_f32_16x16x32_bf16 v[172:175], v[20:23], v[252:255], v[172:175]
    s_waitcnt vmcnt(4)
    s_barrier
    s_mov_b32 s38, 14
L_oloopa:
    ds_read_b32 v5, v4 offset:128
    ds_read_b128 v[228:231], v2 offset:7168
    ds_read_b128 v[232:235], v2 offset:8192
    ds_read_b128 v[236:239], v2 offset:9216
    ds_read_b128 v[240:243], v2 offset:10240
    ds_read_b128 v[244:247], v2 offset:11264
    ds_read_b128 v[248:251], v2 offset:12288
    ds_read_b128 v[252:255], v2 offset:13312
    s_add_u32 s39, s39, 1
    s_add_u32 m0, s35, 16896
    s_nop 0
    buffer_load_dwordx4 v8, s[20:23], s37 offen offset:0 nt lds
    s_waitcnt lgkmcnt(7)
    v_cmp_eq_u32 vcc, s39, v5
    s_cbranch_vccnz L_stub_oa5
L_back_oa5:
    s_waitcnt lgkmcnt(6)
    v_mfma_f32_16x16x32_bf16 v[68:71], v[40:43], v[228:231], v[68:71]
    v_mfma_f32_16x16x32_bf16 v[72:75], v[44:47], v[228:231], v[72:75]
    v_mfma_f32_16x16x32_bf16 v[76:79], v[48:51], v[228:231], v[76:79]
    v_mfma_f32_16x16x32_bf16 v[80:83], v[52:55], v[228:231], v[80:83]
    s_add_u32 m0, s35, 17440
    s_nop 0
    buffer_load_dwordx4 v8, s[20:23], s37 offen offset:512 nt lds
    s_waitcnt lgkmcnt(5)
    v_mfma_f32_16x16x32_bf16 v[84:87], v[40:43], v[232:235], v[84:87]
    v_mfma_f32_16x16x32_bf16 v[88:91], v[44:47], v[232:235], v[88:91]
    v_mfma_f32_16x16x32_bf16 v[92:95], v[48:51], v[232:235], v[92:95]
    v_mfma_f32_16x16x32_bf16 v[96:99], v[52:55], v[232:235], v[96:99]
    s_add_u32 m0, s35, 17984
    s_nop 0
    buffer_load_dwordx4 v8, s[20:23], s37 offen offset:1024 nt lds
    s_waitcnt lgkmcnt(4)
    v_mfma_f32_16x16x32_bf16 v[100:103], v[40:43], v[236:239], v[100:103]
    v_add_u32 v1, 50688, v1
    ds_read_b64_tr_b16 v[12:13], v1 offset:0
    v_mfma_f32_16x16x32_bf16 v[104:107], v[44:47], v[236:239], v[104:107]
    ds_read_b64_tr_b16 v[14:15], v1 offset:512
    v_mfma_f32_16x16x32_bf16 v[108:111], v[48:51], v[236:239], v[108:111]
    ds_read_b64_tr_b16 v[16:17], v1 offset:32
    v_mfma_f32_16x16x32_bf16 v[112:115], v[52:55], v[236:239], v[112:115]
    ds_read_b64_tr_b16 v[18:19], v1 offset:544
    s_add_u32 m0, s35, 18528
    s_nop 0
    buffer_load_dwordx4 v8, s[20:23], s37 offen offset:1536 nt lds
    s_add_u32 s37, s37, 16384
    s_waitcnt lgkmcnt(7)
    v_mfma_f32_16x16x32_bf16 v[116:119], v[40:43], v[240:243], v[116:119]
    ds_read_b64_tr_b16 v[20:21], v1 offset:64
    v_mfma_f32_16x16x32_bf16 v[120:123], v[44:47], v[240:243], v[120:123]
    ds_read_b64_tr_b16 v[22:23], v1 offset:576
    v_mfma_f32_16x16x32_bf16 v[124:127], v[48:51], v[240:243], v[124:127]
    ds_read_b64_tr_b16 v[24:25], v1 offset:96
    v_mfma_f32_16x16x32_bf16 v[128:131], v[52:55], v[240:243], v[128:131]
    ds_read_b64_tr_b16 v[26:27], v1 offset:608
    s_waitcnt lgkmcnt(10)
    v_mfma_f32_16x16x32_bf16 v[132:135], v[40:43], v[244:247], v[132:135]
    v_mfma_f32_16x16x32_bf16 v[136:139], v[44:47], v[244:247], v[136:139]
    v_mfma_f32_16x16x32_bf16 v[140:143], v[48:51], v[244:247], v[140:143]
    s_waitcnt lgkmcnt(9)
    v_mfma_f32_16x16x32_bf16 v[148:151], v[40:43], v[248:251], v[148:151]
    v_mfma_f32_16x16x32_bf16 v[152:155], v[44:47], v[248:251], v[152:155]
    v_mfma_f32_16x16x32_bf16 v[156:159], v[48:51], v[248:251], v[156:159]
    s_waitcnt lgkmcnt(8)
    v_mfma_f32_16x16x32_bf16 v[164:167], v[40:43], v[252:255], v[164:167]
    v_mfma_f32_16x16x32_bf16 v[168:171], v[44:47], v[252:255], v[168:171]
    v_mfma_f32_16x16x32_bf16 v[172:175], v[48:51], v[252:255], v[172:175]
    s_waitcnt vmcnt(4)
    s_barrier
    ds_read_b32 v5, v4 offset:0
    ds_read_b128 v[228:231], v2 offset:0
    ds_read_b128 v[232:235], v2 offset:1024
    ds_read_b128 v[236:239], v2 offset:2048
    ds_read_b128 v[240:243], v2 offset:3072
    ds_read_b128 v[244:247], v2 offset:4096
    ds_read_b128 v[248:251], v2 offset:5120
    ds_read_b128 v[252:255], v2 offset:6144
    s_add_u32 s39, s39, 1
    s_add_u32 m0, s35, 33792
    s_nop 0
    buffer_load_dwordx4 v8, s[20:23], s37 offen offset:0 nt lds
    s_waitcnt lgkmcnt(7)
    v_cmp_eq_u32 vcc, s39, v5
    s_cbranch_vccnz L_stub_oa6
L_back_oa6:
    s_waitcnt lgkmcnt(6)
    v_mfma_f32_16x16x32_bf16 v[68:71], v[12:15], v[228:231], v[68:71]
    v_mfma_f32_16x16x32_bf16 v[72:75], v[16:19], v[228:231], v[72:75]
    v_mfma_f32_16x16x32_bf16 v[76:79], v[20:23], v[228:231], v[76:79]
    v_mfma_f32_16x16x32_bf16 v[80:83], v[24:27], v[228:231], v[80:83]
    s_add_u32 m0, s35, 34336
    s_nop 0
    buffer_load_dwordx4 v8, s[20:23], s37 offen offset:512 nt lds
    s_waitcnt lgkmcnt(5)
    v_mfma_f32_16x16x32_bf16 v[84:87], v[12:15], v[232:235], v[84:87]
    v_mfma_f32_16x16x32_bf16 v[88:91], v[16:19], v[232:235], v[88:91]
    v_mfma_f32_16x16x32_bf16 v[92:95], v[20:23], v[232:235], v[92:95]
    v_mfma_f32_16x16x32_bf16 v[96:99], v[24:27], v[232:235], v[96:99]
    s_add_u32 m0, s35, 34880
    s_nop 0
    buffer_load_dwordx4 v8, s[20:23], s37 offen offset:1024 nt lds
    s_waitcnt lgkmcnt(4)
    v_mfma_f32_16x16x32_bf16 v[100:103], v[12:15], v[236:239], v[100:103]
    v_add_u32 v1, 33792, v1
    ds_read_b64_tr_b16 v[40:41], v1 offset:0
    v_mfma_f32_16x16x32_bf16 v[104:107], v[16:19], v[236:239], v[104:107]
    ds_read_b64_tr_b16 v[42:43], v1 offset:512
    v_mfma_f32_16x16x32_bf16 v[108:111], v[20:23], v[236:239], v[108:111]
    ds_read_b64_tr_b16 v[44:45], v1 offset:32
    v_mfma_f32_16x16x32_bf16 v[112:115], v[24:27], v[236:239], v[112:115]
    ds_read_b64_tr_b16 v[46:47], v1 offset:544
    s_add_u32 m0, s35, 35424
    s_nop 0
    buffer_load_dwordx4 v8, s[20:23], s37 offen offset:1536 nt lds
    s_add_u32 s37, s37, 16384
    s_waitcnt lgkmcnt(7)
    v_mfma_f32_16x16x32_bf16 v[116:119], v[12:15], v[240:243], v[116:119]
    ds_read_b64_tr_b16 v[48:49], v1 offset:64
    v_mfma_f32_16x16x32_bf16 v[120:123], v[16:19], v[240:243], v[120:123]
    ds_read_b64_tr_b16 v[50:51], v1 offset:576
    v_mfma_f32_16x16x32_bf16 v[124:127], v[20:23], v[240:243], v[124:127]
    ds_read_b64_tr_b16 v[52:53], v1 offset:96
    v_mfma_f32_16x16x32_bf16 v[128:131], v[24:27], v[240:243], v[128:131]
    ds_read_b64_tr_b16 v[54:55], v1 offset:608
    s_waitcnt lgkmcnt(10)
    v_mfma_f32_16x16x32_bf16 v[132:135], v[12:15], v[244:247], v[132:135]
    v_mfma_f32_16x16x32_bf16 v[136:139], v[16:19], v[244:247], v[136:139]
    v_mfma_f32_16x16x32_bf16 v[140:143], v[20:23], v[244:247], v[140:143]
    s_waitcnt lgkmcnt(9)
    v_mfma_f32_16x16x32_bf16 v[148:151], v[12:15], v[248:251], v[148:151]
    v_mfma_f32_16x16x32_bf16 v[152:155], v[16:19], v[248:251], v[152:155]
    v_mfma_f32_16x16x32_bf16 v[156:159], v[20:23], v[248:251], v[156:159]
    s_waitcnt lgkmcnt(8)
    v_mfma_f32_16x16x32_bf16 v[164:167], v[12:15], v[252:255], v[164:167]
    v_mfma_f32_16x16x32_bf16 v[168:171], v[16:19], v[252:255], v[168:171]
    v_mfma_f32_16x16x32_bf16 v[172:175], v[20:23], v[252:255], v[172:175]
    s_waitcnt vmcnt(4)
    s_barrier
    ds_read_b32 v5, v4 offset:128
    ds_read_b128 v[228:231], v2 offset:7168
    ds_read_b128 v[232:235], v2 offset:8192
    ds_read_b128 v[236:239], v2 offset:9216
    ds_read_b128 v[240:243], v2 offset:10240
    ds_read_b128 v[244:247], v2 offset:11264
    ds_read_b128 v[248:251], v2 offset:12288
    ds_read_b128 v[252:255], v2 offset:13312
    s_add_u32 s39, s39, 1
    s_add_u32 m0, s35, 84480
    s_nop 0
    buffer_load_dwordx4 v8, s[20:23], s37 offen offset:0 nt lds
    s_waitcnt lgkmcnt(7)
    v_cmp_eq_u32 vcc, s39, v5
    s_cbranch_vccnz L_stub_oa7
L_back_oa7:
    s_waitcnt lgkmcnt(6)
    v_mfma_f32_16x16x32_bf16 v[68:71], v[40:43], v[228:231], v[68:71]
    v_mfma_f32_16x16x32_bf16 v[72:75], v[44:47], v[228:231], v[72:75]
    v_mfma_f32_16x16x32_bf16 v[76:79], v[48:51], v[228:231], v[76:79]
    v_mfma_f32_16x16x32_bf16 v[80:83], v[52:55], v[228:231], v[80:83]
    s_add_u32 m0, s35, 85024
    s_nop 0
    buffer_load_dwordx4 v8, s[20:23], s37 offen offset:512 nt lds
    s_waitcnt lgkmcnt(5)
    v_mfma_f32_16x16x32_bf16 v[84:87], v[40:43], v[232:235], v[84:87]
    v_mfma_f32_16x16x32_bf16 v[88:91], v[44:47], v[232:235], v[88:91]
    v_mfma_f32_16x16x32_bf16 v[92:95], v[48:51], v[232:235], v[92:95]
    v_mfma_f32_16x16x32_bf16 v[96:99], v[52:55], v[232:235], v[96:99]
    s_add_u32 m0, s35, 85568
    s_nop 0
    buffer_load_dwordx4 v8, s[20:23], s37 offen offset:1024 nt lds
    s_waitcnt lgkmcnt(4)
    v_mfma_f32_16x16x32_bf16 v[100:103], v[40:43], v[236:239], v[100:103]
    v_add_u32 v1, 4294865920, v1
    ds_read_b64_tr_b16 v[12:13], v1 offset:0
    v_mfma_f32_16x16x32_bf16 v[104:107], v[44:47], v[236:239], v[104:107]
    ds_read_b64_tr_b16 v[14:15], v1 offset:512
    v_mfma_f32_16x16x32_bf16 v[108:111], v[48:51], v[236:239], v[108:111]
    ds_read_b64_tr_b16 v[16:17], v1 offset:32
    v_mfma_f32_16x16x32_bf16 v[112:115], v[52:55], v[236:239], v[112:115]
    ds_read_b64_tr_b16 v[18:19], v1 offset:544
    s_add_u32 m0, s35, 86112
    s_nop 0
    buffer_load_dwordx4 v8, s[20:23], s37 offen offset:1536 nt lds
    s_add_u32 s37, s37, 16384
    s_waitcnt lgkmcnt(7)
    v_mfma_f32_16x16x32_bf16 v[116:119], v[40:43], v[240:243], v[116:119]
    ds_read_b64_tr_b16 v[20:21], v1 offset:64
    v_mfma_f32_16x16x32_bf16 v[120:123], v[44:47], v[240:243], v[120:123]
    ds_read_b64_tr_b16 v[22:23], v1 offset:576
    v_mfma_f32_16x16x32_bf16 v[124:127], v[48:51], v[240:243], v[124:127]
    ds_read_b64_tr_b16 v[24:25], v1 offset:96
    v_mfma_f32_16x16x32_bf16 v[128:131], v[52:55], v[240:243], v[128:131]
    ds_read_b64_tr_b16 v[26:27], v1 offset:608
    s_waitcnt lgkmcnt(10)
    v_mfma_f32_16x16x32_bf16 v[132:135], v[40:43], v[244:247], v[132:135]
    v_mfma_f32_16x16x32_bf16 v[136:139], v[44:47], v[244:247], v[136:139]
    v_mfma_f32_16x16x32_bf16 v[140:143], v[48:51], v[244:247], v[140:143]
    s_waitcnt lgkmcnt(9)
    v_mfma_f32_16x16x32_bf16 v[148:151], v[40:43], v[248:251], v[148:151]
    v_mfma_f32_16x16x32_bf16 v[152:155], v[44:47], v[248:251], v[152:155]
    v_mfma_f32_16x16x32_bf16 v[156:159], v[48:51], v[248:251], v[156:159]
    s_waitcnt lgkmcnt(8)
    v_mfma_f32_16x16x32_bf16 v[164:167], v[40:43], v[252:255], v[164:167]
    v_mfma_f32_16x16x32_bf16 v[168:171], v[44:47], v[252:255], v[168:171]
    v_mfma_f32_16x16x32_bf16 v[172:175], v[48:51], v[252:255], v[172:175]
    s_waitcnt vmcnt(4)
    s_barrier
    ds_read_b32 v5, v4 offset:0
    ds_read_b128 v[228:231], v2 offset:0
    ds_read_b128 v[232:235], v2 offset:1024
    ds_read_b128 v[236:239], v2 offset:2048
    ds_read_b128 v[240:243], v2 offset:3072
    ds_read_b128 v[244:247], v2 offset:4096
    ds_read_b128 v[248:251], v2 offset:5120
    ds_read_b128 v[252:255], v2 offset:6144
    s_add_u32 s39, s39, 1
    s_add_u32 m0, s35, 118272
    s_nop 0
    buffer_load_dwordx4 v8, s[20:23], s37 offen offset:0 nt lds
    s_waitcnt lgkmcnt(7)
    v_cmp_eq_u32 vcc, s39, v5
    s_cbranch_vccnz L_stub_oa8
L_back_oa8:
    s_waitcnt lgkmcnt(6)
    v_mfma_f32_16x16x32_bf16 v[68:71], v[12:15], v[228:231], v[68:71]
    v_mfma_f32_16x16x32_bf16 v[72:75], v[16:19], v[228:231], v[72:75]
    v_mfma_f32_16x16x32_bf16 v[76:79], v[20:23], v[228:231], v[76:79]
    v_mfma_f32_16x16x32_bf16 v[80:83], v[24:27], v[228:231], v[80:83]
    s_add_u32 m0, s35, 118816
    s_nop 0
    buffer_load_dwordx4 v8, s[20:23], s37 offen offset:512 nt lds
    s_waitcnt lgkmcnt(5)
    v_mfma_f32_16x16x32_bf16 v[84:87], v[12:15], v[232:235], v[84:87]
    v_mfma_f32_16x16x32_bf16 v[88:91], v[16:19], v[232:235], v[88:91]
    v_mfma_f32_16x16x32_bf16 v[92:95], v[20:23], v[232:235], v[92:95]
    v_mfma_f32_16x16x32_bf16 v[96:99], v[24:27], v[232:235], v[96:99]
    s_add_u32 m0, s35, 119360
    s_nop 0
    buffer_load_dwordx4 v8, s[20:23], s37 offen offset:1024 nt lds
    s_waitcnt lgkmcnt(4)
    v_mfma_f32_16x16x32_bf16 v[100:103], v[12:15], v[236:239], v[100:103]
    v_add_u32 v1, 16896, v1
    ds_read_b64_tr_b16 v[40:41], v1 offset:0
    v_mfma_f32_16x16x32_bf16 v[104:107], v[16:19], v[236:239], v[104:107]
    ds_read_b64_tr_b16 v[42:43], v1 offset:512
    v_mfma_f32_16x16x32_bf16 v[108:111], v[20:23], v[236:239], v[108:111]
    ds_read_b64_tr_b16 v[44:45], v1 offset:32
    v_mfma_f32_16x16x32_bf16 v[112:115], v[24:27], v[236:239], v[112:115]
    ds_read_b64_tr_b16 v[46:47], v1 offset:544
    s_add_u32 m0, s35, 119904
    s_nop 0
    buffer_load_dwordx4 v8, s[20:23], s37 offen offset:1536 nt lds
    s_add_u32 s37, s37, 16384
    s_waitcnt lgkmcnt(7)
    v_mfma_f32_16x16x32_bf16 v[116:119], v[12:15], v[240:243], v[116:119]
    ds_read_b64_tr_b16 v[48:49], v1 offset:64
    v_mfma_f32_16x16x32_bf16 v[120:123], v[16:19], v[240:243], v[120:123]
    ds_read_b64_tr_b16 v[50:51], v1 offset:576
    v_mfma_f32_16x16x32_bf16 v[124:127], v[20:23], v[240:243], v[124:127]
    ds_read_b64_tr_b16 v[52:53], v1 offset:96
    v_mfma_f32_16x16x32_bf16 v[128:131], v[24:27], v[240:243], v[128:131]
    ds_read_b64_tr_b16 v[54:55], v1 offset:608
    s_waitcnt lgkmcnt(10)
    v_mfma_f32_16x16x32_bf16 v[132:135], v[12:15], v[244:247], v[132:135]
    v_mfma_f32_16x16x32_bf16 v[136:139], v[16:19], v[244:247], v[136:139]
    v_mfma_f32_16x16x32_bf16 v[140:143], v[20:23], v[244:247], v[140:143]
    s_waitcnt lgkmcnt(9)
    v_mfma_f32_16x16x32_bf16 v[148:151], v[12:15], v[248:251], v[148:151]
    v_mfma_f32_16x16x32_bf16 v[152:155], v[16:19], v[248:251], v[152:155]
    v_mfma_f32_16x16x32_bf16 v[156:159], v[20:23], v[248:251], v[156:159]
    s_waitcnt lgkmcnt(8)
    v_mfma_f32_16x16x32_bf16 v[164:167], v[12:15], v[252:255], v[164:167]
    v_mfma_f32_16x16x32_bf16 v[168:171], v[16:19], v[252:255], v[168:171]
    v_mfma_f32_16x16x32_bf16 v[172:175], v[20:23], v[252:255], v[172:175]
    s_waitcnt vmcnt(4)
    s_barrier
    s_sub_u32 s38, s38, 1
    s_cmp_lg_u32 s38, 0
    s_cbranch_scc1 L_oloopa
    ds_read_b32 v5, v4 offset:128
    ds_read_b128 v[228:231], v2 offset:7168
    ds_read_b128 v[232:235], v2 offset:8192
    ds_read_b128 v[236:239], v2 offset:9216
    ds_read_b128 v[240:243], v2 offset:10240
    ds_read_b128 v[244:247], v2 offset:11264
    ds_read_b128 v[248:251], v2 offset:12288
    ds_read_b128 v[252:255], v2 offset:13312
    s_add_u32 s39, s39, 1
    s_add_u32 m0, s35, 16896
    s_nop 0
    buffer_load_dwordx4 v8, s[20:23], s37 offen offset:0 nt lds
    s_add_u32 m0, s35, 17440
    s_nop 0
    buffer_load_dwordx4 v8, s[20:23], s37 offen offset:512 nt lds
    s_waitcnt lgkmcnt(7)
    v_cmp_eq_u32 vcc, s39, v5
    s_cbranch_vccnz L_stub_oa61
L_back_oa61:
    s_waitcnt lgkmcnt(6)
    v_mfma_f32_16x16x32_bf16 v[68:71], v[40:43], v[228:231], v[68:71]
    v_mfma_f32_16x16x32_bf16 v[72:75], v[44:47], v[228:231], v[72:75]
    v_mfma_f32_16x16x32_bf16 v[76:79], v[48:51], v[228:231], v[76:79]
    v_mfma_f32_16x16x32_bf16 v[80:83], v[52:55], v[228:231], v[80:83]
    s_add_u32 m0, s35, 17984
    s_nop 0
    buffer_load_dwordx4 v8, s[20:23], s37 offen offset:1024 nt lds
    s_add_u32 m0, s35, 18528
    s_nop 0
    buffer_load_dwordx4 v8, s[20:23], s37 offen offset:1536 nt lds
    s_add_u32 s37, s37, 16384
    s_waitcnt lgkmcnt(5)
    v_mfma_f32_16x16x32_bf16 v[84:87], v[40:43], v[232:235], v[84:87]
    v_mfma_f32_16x16x32_bf16 v[88:91], v[44:47], v[232:235], v[88:91]
    v_mfma_f32_16x16x32_bf16 v[92:95], v[48:51], v[232:235], v[92:95]
    v_mfma_f32_16x16x32_bf16 v[96:99], v[52:55], v[232:235], v[96:99]
    s_add_u32 m0, s35, 50688
    s_add_u32 s44, s47, 0
    buffer_load_dwordx4 v9, s[24:27], s44 offen lds
    s_add_u32 m0, s35, 51744
    s_add_u32 s44, s47, 896
    buffer_load_dwordx4 v9, s[24:27], s44 offen lds
    s_waitcnt lgkmcnt(4)
    v_mfma_f32_16x16x32_bf16 v[100:103], v[40:43], v[236:239], v[100:103]
    v_add_u32 v1, 50688, v1
    ds_read_b64_tr_b16 v[12:13], v1 offset:0
    v_mfma_f32_16x16x32_bf16 v[104:107], v[44:47], v[236:239], v[104:107]
    ds_read_b64_tr_b16 v[14:15], v1 offset:512
    v_mfma_f32_16x16x32_bf16 v[108:111], v[48:51], v[236:239], v[108:111]
    ds_read_b64_tr_b16 v[16:17], v1 offset:32
    v_mfma_f32_16x16x32_bf16 v[112:115], v[52:55], v[236:239], v[112:115]
    ds_read_b64_tr_b16 v[18:19], v1 offset:544
    s_add_u32 m0, s35, 52800
    s_add_u32 s44, s47, 1792
    buffer_load_dwordx4 v9, s[24:27], s44 offen lds
    s_add_u32 m0, s35, 53856
    s_add_u32 s44, s47, 2688
    buffer_load_dwordx4 v9, s[24:27], s44 offen lds
    s_waitcnt lgkmcnt(7)
    v_mfma_f32_16x16x32_bf16 v[116:119], v[40:43], v[240:243], v[116:119]
    ds_read_b64_tr_b16 v[20:21], v1 offset:64
    v_mfma_f32_16x16x32_bf16 v[120:123], v[44:47], v[240:243], v[120:123]
    ds_read_b64_tr_b16 v[22:23], v1 offset:576
    v_mfma_f32_16x16x32_bf16 v[124:127], v[48:51], v[240:243], v[124:127]
    ds_read_b64_tr_b16 v[24:25], v1 offset:96
    v_mfma_f32_16x16x32_bf16 v[128:131], v[52:55], v[240:243], v[128:131]
    ds_read_b64_tr_b16 v[26:27], v1 offset:608
    s_waitcnt lgkmcnt(10)
    v_mfma_f32_16x16x32_bf16 v[132:135], v[40:43], v[244:247], v[132:135]
    v_mfma_f32_16x16x32_bf16 v[136:139], v[44:47], v[244:247], v[136:139]
    v_mfma_f32_16x16x32_bf16 v[140:143], v[48:51], v[244:247], v[140:143]
    s_waitcnt lgkmcnt(9)
    v_mfma_f32_16x16x32_bf16 v[148:151], v[40:43], v[248:251], v[148:151]
    v_mfma_f32_16x16x32_bf16 v[152:155], v[44:47], v[248:251], v[152:155]
    v_mfma_f32_16x16x32_bf16 v[156:159], v[48:51], v[248:251], v[156:159]
    s_waitcnt lgkmcnt(8)
    v_mfma_f32_16x16x32_bf16 v[164:167], v[40:43], v[252:255], v[164:167]
    v_mfma_f32_16x16x32_bf16 v[168:171], v[44:47], v[252:255], v[168:171]
    v_mfma_f32_16x16x32_bf16 v[172:175], v[48:51], v[252:255], v[172:175]
    s_waitcnt vmcnt(8)
    s_barrier
    ds_read_b32 v5, v4 offset:0
    ds_read_b128 v[228:231], v2 offset:0
    ds_read_b128 v[232:235], v2 offset:1024
    ds_read_b128 v[236:239], v2 offset:2048
    ds_read_b128 v[240:243], v2 offset:3072
    ds_read_b128 v[244:247], v2 offset:4096
    ds_read_b128 v[248:251], v2 offset:5120
    ds_read_b128 v[252:255], v2 offset:6144
    s_add_u32 s39, s39, 1
    s_add_u32 m0, s35, 33792
    s_nop 0
    buffer_load_dwordx4 v8, s[20:23], s37 offen offset:0 nt lds
    s_add_u32 m0, s35, 34336
    s_nop 0
    buffer_load_dwordx4 v8, s[20:23], s37 offen offset:512 nt lds
    s_waitcnt lgkmcnt(7)
    v_cmp_eq_u32 vcc, s39, v5
    s_cbranch_vccnz L_stub_oa62
L_back_oa62:
    s_waitcnt lgkmcnt(6)
    v_mfma_f32_16x16x32_bf16 v[68:71], v[12:15], v[228:231], v[68:71]
    v_mfma_f32_16x16x32_bf16 v[72:75], v[16:19], v[228:231], v[72:75]
    v_mfma_f32_16x16x32_bf16 v[76:79], v[20:23], v[228:231], v[76:79]
    v_mfma_f32_16x16x32_bf16 v[80:83], v[24:27], v[228:231], v[80:83]
    s_add_u32 m0, s35, 34880
    s_nop 0
    buffer_load_dwordx4 v8, s[20:23], s37 offen offset:1024 nt lds
    s_add_u32 m0, s35, 35424
    s_nop 0
    buffer_load_dwordx4 v8, s[20:23], s37 offen offset:1536 nt lds
    s_add_u32 s37, s37, 16384
    s_waitcnt lgkmcnt(5)
    v_mfma_f32_16x16x32_bf16 v[84:87], v[12:15], v[232:235], v[84:87]
    v_mfma_f32_16x16x32_bf16 v[88:91], v[16:19], v[232:235], v[88:91]
    v_mfma_f32_16x16x32_bf16 v[92:95], v[20:23], v[232:235], v[92:95]
    v_mfma_f32_16x16x32_bf16 v[96:99], v[24:27], v[232:235], v[96:99]
    s_add_u32 m0, s35, 67584
    s_add_u32 s44, s47, 114688
    buffer_load_dwordx4 v9, s[24:27], s44 offen lds
    s_add_u32 m0, s35, 68640
    s_add_u32 s44, s47, 115584
    buffer_load_dwordx4 v9, s[24:27], s44 offen lds
    s_waitcnt lgkmcnt(4)
    v_mfma_f32_16x16x32_bf16 v[100:103], v[12:15], v[236:239], v[100:103]
    v_add_u32 v1, 33792, v1
    ds_read_b64_tr_b16 v[40:41], v1 offset:0
    v_mfma_f32_16x16x32_bf16 v[104:107], v[16:19], v[236:239], v[104:107]
    ds_read_b64_tr_b16 v[42:43], v1 offset:512
    v_mfma_f32_16x16x32_bf16 v[108:111], v[20:23], v[236:239], v[108:111]
    ds_read_b64_tr_b16 v[44:45], v1 offset:32
    v_mfma_f32_16x16x32_bf16 v[112:115], v[24:27], v[236:239], v[112:115]
    ds_read_b64_tr_b16 v[46:47], v1 offset:544
    s_add_u32 m0, s35, 69696
    s_add_u32 s44, s47, 116480
    buffer_load_dwordx4 v9, s[24:27], s44 offen lds
    s_add_u32 m0, s35, 70752
    s_add_u32 s44, s47, 117376
    buffer_load_dwordx4 v9, s[24:27], s44 offen lds
    s_add_u32 s47, s47, 128
    s_cmp_eq_u32 s47, 896
    s_cselect_b32 s47, 0, s47
    s_waitcnt lgkmcnt(7)
    v_mfma_f32_16x16x32_bf16 v[116:119], v[12:15], v[240:243], v[116:119]
    ds_read_b64_tr_b16 v[48:49], v1 offset:64
    v_mfma_f32_16x16x32_bf16 v[120:123], v[16:19], v[240:243], v[120:123]
    ds_read_b64_tr_b16 v[50:51], v1 offset:576
    v_mfma_f32_16x16x32_bf16 v[124:127], v[20:23], v[240:243], v[124:127]
    ds_read_b64_tr_b16 v[52:53], v1 offset:96
    v_mfma_f32_16x16x32_bf16 v[128:131], v[24:27], v[240:243], v[128:131]
    ds_read_b64_tr_b16 v[54:55], v1 offset:608
    s_waitcnt lgkmcnt(10)
    v_mfma_f32_16x16x32_bf16 v[132:135], v[12:15], v[244:247], v[132:135]
    v_mfma_f32_16x16x32_bf16 v[136:139], v[16:19], v[244:247], v[136:139]
    v_mfma_f32_16x16x32_bf16 v[140:143], v[20:23], v[244:247], v[140:143]
    s_waitcnt lgkmcnt(9)
    v_mfma_f32_16x16x32_bf16 v[148:151], v[12:15], v[248:251], v[148:151]
    v_mfma_f32_16x16x32_bf16 v[152:155], v[16:19], v[248:251], v[152:155]
    v_mfma_f32_16x16x32_bf16 v[156:159], v[20:23], v[248:251], v[156:159]
    s_waitcnt lgkmcnt(8)
    v_mfma_f32_16x16x32_bf16 v[164:167], v[12:15], v[252:255], v[164:167]
    v_mfma_f32_16x16x32_bf16 v[168:171], v[16:19], v[252:255], v[168:171]
    v_mfma_f32_16x16x32_bf16 v[172:175], v[20:23], v[252:255], v[172:175]
    s_waitcnt vmcnt(12)
    s_barrier
    ds_read_b32 v5, v4 offset:128
    ds_read_b128 v[228:231], v2 offset:7168
    ds_read_b128 v[232:235], v2 offset:8192
    ds_read_b128 v[236:239], v2 offset:9216
    ds_read_b128 v[240:243], v2 offset:10240
    ds_read_b128 v[244:247], v2 offset:11264
    ds_read_b128 v[248:251], v2 offset:12288
    ds_read_b128 v[252:255], v2 offset:13312
    s_add_u32 s39, s39, 1
    s_add_u32 m0, s35, 101376
    s_add_u32 s44, s47, 0
    buffer_load_dwordx4 v9, s[24:27], s44 offen lds
    s_waitcnt lgkmcnt(7)
    v_cmp_eq_u32 vcc, s39, v5
    s_cbranch_vccnz L_stub_oa63
L_back_oa63:
    s_waitcnt lgkmcnt(6)
    v_mfma_f32_16x16x32_bf16 v[68:71], v[40:43], v[228:231], v[68:71]
    v_mfma_f32_16x16x32_bf16 v[72:75], v[44:47], v[228:231], v[72:75]
    v_mfma_f32_16x16x32_bf16 v[76:79], v[48:51], v[228:231], v[76:79]
    v_mfma_f32_16x16x32_bf16 v[80:83], v[52:55], v[228:231], v[80:83]
    s_add_u32 m0, s35, 102432
    s_add_u32 s44, s47, 896
    buffer_load_dwordx4 v9, s[24:27], s44 offen lds
    s_waitcnt lgkmcnt(5)
    v_mfma_f32_16x16x32_bf16 v[84:87], v[40:43], v[232:235], v[84:87]
    v_mfma_f32_16x16x32_bf16 v[88:91], v[44:47], v[232:235], v[88:91]
    v_mfma_f32_16x16x32_bf16 v[92:95], v[48:51], v[232:235], v[92:95]
    v_mfma_f32_16x16x32_bf16 v[96:99], v[52:55], v[232:235], v[96:99]
    s_add_u32 m0, s35, 103488
    s_add_u32 s44, s47, 1792
    buffer_load_dwordx4 v9, s[24:27], s44 offen lds
    s_waitcnt lgkmcnt(4)
    v_mfma_f32_16x16x32_bf16 v[100:103], v[40:43], v[236:239], v[100:103]
    v_add_u32 v1, 4294865920, v1
    ds_read_b64_tr_b16 v[12:13], v1 offset:0
    v_mfma_f32_16x16x32_bf16 v[104:107], v[44:47], v[236:239], v[104:107]
    ds_read_b64_tr_b16 v[14:15], v1 offset:512
    v_mfma_f32_16x16x32_bf16 v[108:111], v[48:51], v[236:239], v[108:111]
    ds_read_b64_tr_b16 v[16:17], v1 offset:32
    v_mfma_f32_16x16x32_bf16 v[112:115], v[52:55], v[236:239], v[112:115]
    ds_read_b64_tr_b16 v[18:19], v1 offset:544
    s_add_u32 m0, s35, 104544
    s_add_u32 s44, s47, 2688
    buffer_load_dwordx4 v9, s[24:27], s44 offen lds
    s_waitcnt lgkmcnt(7)
    v_mfma_f32_16x16x32_bf16 v[116:119], v[40:43], v[240:243], v[116:119]
    ds_read_b64_tr_b16 v[20:21], v1 offset:64
    v_mfma_f32_16x16x32_bf16 v[120:123], v[44:47], v[240:243], v[120:123]
    ds_read_b64_tr_b16 v[22:23], v1 offset:576
    v_mfma_f32_16x16x32_bf16 v[124:127], v[48:51], v[240:243], v[124:127]
    ds_read_b64_tr_b16 v[24:25], v1 offset:96
    v_mfma_f32_16x16x32_bf16 v[128:131], v[52:55], v[240:243], v[128:131]
    ds_read_b64_tr_b16 v[26:27], v1 offset:608
    s_waitcnt lgkmcnt(10)
    v_mfma_f32_16x16x32_bf16 v[132:135], v[40:43], v[244:247], v[132:135]
    v_mfma_f32_16x16x32_bf16 v[136:139], v[44:47], v[244:247], v[136:139]
    v_mfma_f32_16x16x32_bf16 v[140:143], v[48:51], v[244:247], v[140:143]
    s_waitcnt lgkmcnt(9)
    v_mfma_f32_16x16x32_bf16 v[148:151], v[40:43], v[248:251], v[148:151]
    v_mfma_f32_16x16x32_bf16 v[152:155], v[44:47], v[248:251], v[152:155]
    v_mfma_f32_16x16x32_bf16 v[156:159], v[48:51], v[248:251], v[156:159]
    s_waitcnt lgkmcnt(8)
    v_mfma_f32_16x16x32_bf16 v[164:167], v[40:43], v[252:255], v[164:167]
    v_mfma_f32_16x16x32_bf16 v[168:171], v[44:47], v[252:255], v[168:171]
    v_mfma_f32_16x16x32_bf16 v[172:175], v[48:51], v[252:255], v[172:175]
    s_waitcnt vmcnt(8)
    s_barrier
    ds_read_b32 v5, v4 offset:0
    ds_read_b128 v[228:231], v2 offset:0
    ds_read_b128 v[232:235], v2 offset:1024
    ds_read_b128 v[236:239], v2 offset:2048
    ds_read_b128 v[240:243], v2 offset:3072
    ds_read_b128 v[244:247], v2 offset:4096
    ds_read_b128 v[248:251], v2 offset:5120
    ds_read_b128 v[252:255], v2 offset:6144
    s_add_u32 s39, s39, 1
    s_add_u32 m0, s35, 135168
    s_add_u32 s44, s47, 114688
    buffer_load_dwordx4 v9, s[24:27], s44 offen lds
    s_add_u32 m0, s35, 136224
    s_add_u32 s44, s47, 115584
    buffer_load_dwordx4 v9, s[24:27], s44 offen lds
    s_waitcnt lgkmcnt(7)
    v_cmp_eq_u32 vcc, s39, v5
    s_cbranch_vccnz L_stub_oa64
L_back_oa64:
    s_waitcnt lgkmcnt(6)
    v_mfma_f32_16x16x32_bf16 v[68:71], v[12:15], v[228:231], v[68:71]
    v_mfma_f32_16x16x32_bf16 v[72:75], v[16:19], v[228:231], v[72:75]
    v_mfma_f32_16x16x32_bf16 v[76:79], v[20:23], v[228:231], v[76:79]
    v_mfma_f32_16x16x32_bf16 v[80:83], v[24:27], v[228:231], v[80:83]
    s_add_u32 m0, s35, 137280
    s_add_u32 s44, s47, 116480
    buffer_load_dwordx4 v9, s[24:27], s44 offen lds
    s_add_u32 m0, s35, 138336
    s_add_u32 s44, s47, 117376
    buffer_load_dwordx4 v9, s[24:27], s44 offen lds
    s_add_u32 s47, s47, 128
    s_cmp_eq_u32 s47, 896
    s_cselect_b32 s47, 0, s47
    s_waitcnt lgkmcnt(5)
    v_mfma_f32_16x16x32_bf16 v[84:87], v[12:15], v[232:235], v[84:87]
    v_mfma_f32_16x16x32_bf16 v[88:91], v[16:19], v[232:235], v[88:91]
    v_mfma_f32_16x16x32_bf16 v[92:95], v[20:23], v[232:235], v[92:95]
    v_mfma_f32_16x16x32_bf16 v[96:99], v[24:27], v[232:235], v[96:99]
    s_add_u32 m0, s35, 84480
    s_add_u32 s44, s47, 0
    buffer_load_dwordx4 v9, s[24:27], s44 offen lds
    s_add_u32 m0, s35, 85536
    s_add_u32 s44, s47, 896
    buffer_load_dwordx4 v9, s[24:27], s44 offen lds
    s_waitcnt lgkmcnt(4)
    v_mfma_f32_16x16x32_bf16 v[100:103], v[12:15], v[236:239], v[100:103]
    v_add_u32 v1, 16896, v1
    ds_read_b64_tr_b16 v[40:41], v1 offset:0
    v_mfma_f32_16x16x32_bf16 v[104:107], v[16:19], v[236:239], v[104:107]
    ds_read_b64_tr_b16 v[42:43], v1 offset:512
    v_mfma_f32_16x16x32_bf16 v[108:111], v[20:23], v[236:239], v[108:111]
    ds_read_b64_tr_b16 v[44:45], v1 offset:32
    v_mfma_f32_16x16x32_bf16 v[112:115], v[24:27], v[236:239], v[112:115]
    ds_read_b64_tr_b16 v[46:47], v1 offset:544
    s_add_u32 m0, s35, 86592
    s_add_u32 s44, s47, 1792
    buffer_load_dwordx4 v9, s[24:27], s44 offen lds
    s_add_u32 m0, s35, 87648
    s_add_u32 s44, s47, 2688
    buffer_load_dwordx4 v9, s[24:27], s44 offen lds
    s_waitcnt lgkmcnt(7)
    v_mfma_f32_16x16x32_bf16 v[116:119], v[12:15], v[240:243], v[116:119]
    ds_read_b64_tr_b16 v[48:49], v1 offset:64
    v_mfma_f32_16x16x32_bf16 v[120:123], v[16:19], v[240:243], v[120:123]
    ds_read_b64_tr_b16 v[50:51], v1 offset:576
    v_mfma_f32_16x16x32_bf16 v[124:127], v[20:23], v[240:243], v[124:127]
    ds_read_b64_tr_b16 v[52:53], v1 offset:96
    v_mfma_f32_16x16x32_bf16 v[128:131], v[24:27], v[240:243], v[128:131]
    ds_read_b64_tr_b16 v[54:55], v1 offset:608
    s_waitcnt lgkmcnt(10)
    v_mfma_f32_16x16x32_bf16 v[132:135], v[12:15], v[244:247], v[132:135]
    v_mfma_f32_16x16x32_bf16 v[136:139], v[16:19], v[244:247], v[136:139]
    v_mfma_f32_16x16x32_bf16 v[140:143], v[20:23], v[244:247], v[140:143]
    s_waitcnt lgkmcnt(9)
    v_mfma_f32_16x16x32_bf16 v[148:151], v[12:15], v[248:251], v[148:151]
    v_mfma_f32_16x16x32_bf16 v[152:155], v[16:19], v[248:251], v[152:155]
    v_mfma_f32_16x16x32_bf16 v[156:159], v[20:23], v[248:251], v[156:159]
    s_waitcnt lgkmcnt(8)
    v_mfma_f32_16x16x32_bf16 v[164:167], v[12:15], v[252:255], v[164:167]
    v_mfma_f32_16x16x32_bf16 v[168:171], v[16:19], v[252:255], v[168:171]
    v_mfma_f32_16x16x32_bf16 v[172:175], v[20:23], v[252:255], v[172:175]
    s_waitcnt lgkmcnt(0)
    s_barrier
    ds_read_b32 v5, v4 offset:128
    ds_read_b128 v[228:231], v2 offset:7168
    ds_read_b128 v[232:235], v2 offset:8192
    ds_read_b128 v[236:239], v2 offset:9216
    ds_read_b128 v[240:243], v2 offset:10240
    ds_read_b128 v[244:247], v2 offset:11264
    ds_read_b128 v[248:251], v2 offset:12288
    ds_read_b128 v[252:255], v2 offset:13312
    s_add_u32 s39, s39, 1
    s_waitcnt lgkmcnt(7)
    v_cmp_eq_u32 vcc, s39, v5
    s_cbranch_vccnz L_stub_oa65
L_back_oa65:
    s_lshl_b32 s42, s33, 11
    v_add_u32 v6, s42, v2
    v_mov_b32 v7, v2
    s_waitcnt lgkmcnt(6)
    v_mfma_f32_16x16x32_bf16 v[68:71], v[40:43], v[228:231], v[68:71]
    v_mfma_f32_16x16x32_bf16 v[72:75], v[44:47], v[228:231], v[72:75]
    v_mfma_f32_16x16x32_bf16 v[76:79], v[48:51], v[228:231], v[76:79]
    v_mfma_f32_16x16x32_bf16 v[80:83], v[52:55], v[228:231], v[80:83]
    s_waitcnt lgkmcnt(5)
    v_mfma_f32_16x16x32_bf16 v[84:87], v[40:43], v[232:235], v[84:87]
    v_mfma_f32_16x16x32_bf16 v[88:91], v[44:47], v[232:235], v[88:91]
    v_mfma_f32_16x16x32_bf16 v[92:95], v[48:51], v[232:235], v[92:95]
    v_mfma_f32_16x16x32_bf16 v[96:99], v[52:55], v[232:235], v[96:99]
    s_waitcnt lgkmcnt(4)
    v_mfma_f32_16x16x32_bf16 v[100:103], v[40:43], v[236:239], v[100:103]
    v_mfma_f32_16x16x32_bf16 v[104:107], v[44:47], v[236:239], v[104:107]
    v_mfma_f32_16x16x32_bf16 v[108:111], v[48:51], v[236:239], v[108:111]
    v_mfma_f32_16x16x32_bf16 v[112:115], v[52:55], v[236:239], v[112:115]
    v_cvt_pk_bf16_f32 v68, v68, v69
    v_cvt_pk_bf16_f32 v69, v70, v71
    v_cvt_pk_bf16_f32 v70, v72, v73
    v_cvt_pk_bf16_f32 v71, v74, v75
    v_cvt_pk_bf16_f32 v76, v76, v77
    v_cvt_pk_bf16_f32 v77, v78, v79
    v_cvt_pk_bf16_f32 v78, v80, v81
    v_cvt_pk_bf16_f32 v79, v82, v83
    ds_write_b128 v6, v[68:71] offset:16896
    ds_write_b128 v6, v[76:79] offset:17920
    v_cvt_pk_bf16_f32 v84, v84, v85
    v_cvt_pk_bf16_f32 v85, v86, v87
    v_cvt_pk_bf16_f32 v86, v88, v89
    v_cvt_pk_bf16_f32 v87, v90, v91
    v_cvt_pk_bf16_f32 v92, v92, v93
    v_cvt_pk_bf16_f32 v93, v94, v95
    v_cvt_pk_bf16_f32 v94, v96, v97
    v_cvt_pk_bf16_f32 v95, v98, v99
    ds_write_b128 v6, v[84:87] offset:25088
    ds_write_b128 v6, v[92:95] offset:26112
    s_waitcnt lgkmcnt(7)
    v_mfma_f32_16x16x32_bf16 v[116:119], v[40:43], v[240:243], v[116:119]
    v_mfma_f32_16x16x32_bf16 v[120:123], v[44:47], v[240:243], v[120:123]
    v_mfma_f32_16x16x32_bf16 v[124:127], v[48:51], v[240:243], v[124:127]
    v_mfma_f32_16x16x32_bf16 v[128:131], v[52:55], v[240:243], v[128:131]
    v_cvt_pk_bf16_f32 v100, v100, v101
    v_cvt_pk_bf16_f32 v101, v102, v103
    v_cvt_pk_bf16_f32 v102, v104, v105
    v_cvt_pk_bf16_f32 v103, v106, v107
    v_cvt_pk_bf16_f32 v108, v108, v109
    v_cvt_pk_bf16_f32 v109, v110, v111
    v_cvt_pk_bf16_f32 v110, v112, v113
    v_cvt_pk_bf16_f32 v111, v114, v115
    ds_write_b128 v6, v[100:103] offset:33792
    ds_write_b128 v6, v[108:111] offset:34816
    s_waitcnt lgkmcnt(8)
    v_mfma_f32_16x16x32_bf16 v[132:135], v[40:43], v[244:247], v[132:135]
    v_mfma_f32_16x16x32_bf16 v[136:139], v[44:47], v[244:247], v[136:139]
    v_mfma_f32_16x16x32_bf16 v[140:143], v[48:51], v[244:247], v[140:143]
    v_cvt_pk_bf16_f32 v116, v116, v117
    v_cvt_pk_bf16_f32 v117, v118, v119
    v_cvt_pk_bf16_f32 v118, v120, v121
    v_cvt_pk_bf16_f32 v119, v122, v123
    v_cvt_pk_bf16_f32 v124, v124, v125
    v_cvt_pk_bf16_f32 v125, v126, v127
    v_cvt_pk_bf16_f32 v126, v128, v129
    v_cvt_pk_bf16_f32 v127, v130, v131
    ds_write_b128 v6, v[116:119] offset:41984
    ds_write_b128 v6, v[124:127] offset:43008
    s_waitcnt lgkmcnt(9)
    v_mfma_f32_16x16x32_bf16 v[148:151], v[40:43], v[248:251], v[148:151]
    v_mfma_f32_16x16x32_bf16 v[152:155], v[44:47], v[248:251], v[152:155]
    v_mfma_f32_16x16x32_bf16 v[156:159], v[48:51], v[248:251], v[156:159]
    v_cvt_pk_bf16_f32 v132, v132, v133
    v_cvt_pk_bf16_f32 v133, v134, v135
    v_cvt_pk_bf16_f32 v134, v136, v137
    v_cvt_pk_bf16_f32 v135, v138, v139
    v_cvt_pk_bf16_f32 v140, v140, v141
    v_cvt_pk_bf16_f32 v141, v142, v143
    v_add_u32 v6, 118272, v6
    ds_write_b128 v6, v[132:135] offset:0
    ds_write_b64 v6, v[140:141] offset:1024
    s_waitcnt lgkmcnt(10)
    v_mfma_f32_16x16x32_bf16 v[164:167], v[40:43], v[252:255], v[164:167]
    v_mfma_f32_16x16x32_bf16 v[168:171], v[44:47], v[252:255], v[168:171]
    v_mfma_f32_16x16x32_bf16 v[172:175], v[48:51], v[252:255], v[172:175]
    v_cvt_pk_bf16_f32 v148, v148, v149
    v_cvt_pk_bf16_f32 v149, v150, v151
    v_cvt_pk_bf16_f32 v150, v152, v153
    v_cvt_pk_bf16_f32 v151, v154, v155
    v_cvt_pk_bf16_f32 v156, v156, v157
    v_cvt_pk_bf16_f32 v157, v158, v159
    ds_write_b128 v6, v[148:151] offset:8192
    ds_write_b64 v6, v[156:157] offset:9216
    v_cvt_pk_bf16_f32 v164, v164, v165
    v_cvt_pk_bf16_f32 v165, v166, v167
    v_cvt_pk_bf16_f32 v166, v168, v169
    v_cvt_pk_bf16_f32 v167, v170, v171
    v_cvt_pk_bf16_f32 v172, v172, v173
    v_cvt_pk_bf16_f32 v173, v174, v175
    ds_write_b128 v6, v[164:167] offset:33792
    ds_write_b64 v6, v[172:173] offset:34816
    s_waitcnt vmcnt(8)
    s_waitcnt lgkmcnt(0)
    s_branch L_ojoin
L_owave7:
    s_barrier
    s_add_u32 m0, s35, 118272
    s_nop 0
    buffer_load_dwordx4 v8, s[20:23], s37 offen offset:0 nt lds
    s_add_u32 m0, s35, 118816
    s_nop 0
    buffer_load_dwordx4 v8, s[20:23], s37 offen offset:512 nt lds
    s_add_u32 m0, s35, 119360
    s_nop 0
    buffer_load_dwordx4 v8, s[20:23], s37 offen offset:1024 nt lds
    s_add_u32 m0, s35, 119904
    s_nop 0
    buffer_load_dwordx4 v8, s[20:23], s37 offen offset:1536 nt lds
    s_add_u32 s37, s37, 16384
    v_mov_b32 v68, 0
    v_mov_b32 v69, 0
    v_mov_b32 v70, 0
    v_mov_b32 v71, 0
    v_mov_b32 v72, 0
    v_mov_b32 v73, 0
    v_mov_b32 v74, 0
    v_mov_b32 v75, 0
    v_mov_b32 v76, 0
    v_mov_b32 v77, 0
    v_mov_b32 v78, 0
    v_mov_b32 v79, 0
    v_mov_b32 v80, 0
    v_mov_b32 v81, 0
    v_mov_b32 v82, 0
    v_mov_b32 v83, 0
    v_mov_b32 v84, 0
    v_mov_b32 v85, 0
    v_mov_b32 v86, 0
    v_mov_b32 v87, 0
    v_mov_b32 v88, 0
    v_mov_b32 v89, 0
    v_mov_b32 v90, 0
    v_mov_b32 v91, 0
    v_mov_b32 v92, 0
    v_mov_b32 v93, 0
    v_mov_b32 v94, 0
    v_mov_b32 v95, 0
    v_mov_b32 v96, 0
    v_mov_b32 v97, 0
    v_mov_b32 v98, 0
    v_mov_b32 v99, 0
    v_mov_b32 v100, 0
    v_mov_b32 v101, 0
    v_mov_b32 v102, 0
    v_mov_b32 v103, 0
    v_mov_b32 v104, 0
    v_mov_b32 v105, 0
    v_mov_b32 v106, 0
    v_mov_b32 v107, 0
    v_mov_b32 v108, 0
    v_mov_b32 v109, 0
    v_mov_b32 v110, 0
    v_mov_b32 v111, 0
    v_mov_b32 v112, 0
    v_mov_b32 v113, 0
    v_mov_b32 v114, 0
    v_mov_b32 v115, 0
    v_mov_b32 v116, 0
    v_mov_b32 v117, 0
    v_mov_b32 v118, 0
    v_mov_b32 v119, 0
    v_mov_b32 v120, 0
    v_mov_b32 v121, 0
    v_mov_b32 v122, 0
    v_mov_b32 v123, 0
    v_mov_b32 v124, 0
    v_mov_b32 v125, 0
    v_mov_b32 v126, 0
    v_mov_b32 v127, 0
    v_mov_b32 v128, 0
    v_mov_b32 v129, 0
    v_mov_b32 v130, 0
    v_mov_b32 v131, 0
    v_mov_b32 v132, 0
    v_mov_b32 v133, 0
    v_mov_b32 v134, 0
    v_mov_b32 v135, 0
    v_mov_b32 v136, 0
    v_mov_b32 v137, 0
    v_mov_b32 v138, 0
    v_mov_b32 v139, 0
    v_mov_b32 v140, 0
    v_mov_b32 v141, 0
    v_mov_b32 v142, 0
    v_mov_b32 v143, 0
    v_mov_b32 v144, 0
    v_mov_b32 v145, 0
    v_mov_b32 v146, 0
    v_mov_b32 v147, 0
    v_mov_b32 v148, 0
    v_mov_b32 v149, 0
    v_mov_b32 v150, 0
    v_mov_b32 v151, 0
    v_mov_b32 v152, 0
    v_mov_b32 v153, 0
    v_mov_b32 v154, 0
    v_mov_b32 v155, 0
    v_mov_b32 v156, 0
    v_mov_b32 v157, 0
    v_mov_b32 v158, 0
    v_mov_b32 v159, 0
    v_mov_b32 v160, 0
    v_mov_b32 v161, 0
    v_mov_b32 v162, 0
    v_mov_b32 v163, 0
    v_mov_b32 v164, 0
    v_mov_b32 v165, 0
    v_mov_b32 v166, 0
    v_mov_b32 v167, 0
    v_mov_b32 v168, 0
    v_mov_b32 v169, 0
    v_mov_b32 v170, 0
    v_mov_b32 v171, 0
    v_mov_b32 v172, 0
    v_mov_b32 v173, 0
    v_mov_b32 v174, 0
    v_mov_b32 v175, 0
    v_mov_b32 v176, 0
    v_mov_b32 v177, 0
    v_mov_b32 v178, 0
    v_mov_b32 v179, 0
    v_mov_b32 v180, 0
    v_mov_b32 v181, 0
    v_mov_b32 v182, 0
    v_mov_b32 v183, 0
    v_mov_b32 v184, 0
    v_mov_b32 v185, 0
    v_mov_b32 v186, 0
    v_mov_b32 v187, 0
    v_mov_b32 v188, 0
    v_mov_b32 v189, 0
    v_mov_b32 v190, 0
    v_mov_b32 v191, 0
    v_mov_b32 v192, 0
    v_mov_b32 v193, 0
    v_mov_b32 v194, 0
    v_mov_b32 v195, 0
    v_mov_b32 v196, 0
    v_mov_b32 v197, 0
    v_mov_b32 v198, 0
    v_mov_b32 v199, 0
    v_mov_b32 v200, 0
    v_mov_b32 v201, 0
    v_mov_b32 v202, 0
    v_mov_b32 v203, 0
    v_mov_b32 v204, 0
    v_mov_b32 v205, 0
    v_mov_b32 v206, 0
    v_mov_b32 v207, 0
    v_mov_b32 v208, 0
    v_mov_b32 v209, 0
    v_mov_b32 v210, 0
    v_mov_b32 v211, 0
    v_mov_b32 v212, 0
    v_mov_b32 v213, 0
    v_mov_b32 v214, 0
    v_mov_b32 v215, 0
    v_mov_b32 v216, 0
    v_mov_b32 v217, 0
    v_mov_b32 v218, 0
    v_mov_b32 v219, 0
    v_mov_b32 v220, 0
    v_mov_b32 v221, 0
    v_mov_b32 v222, 0
    v_mov_b32 v223, 0
    v_mov_b32 v224, 0
    v_mov_b32 v225, 0
    v_mov_b32 v226, 0
    v_mov_b32 v227, 0
    s_waitcnt vmcnt(4)
    s_barrier
    s_add_u32 m0, s35, 16896
    s_nop 0
    buffer_load_dwordx4 v8, s[20:23], s37 offen offset:0 nt lds
    s_add_u32 m0, s35, 17440
    s_nop 0
    buffer_load_dwordx4 v8, s[20:23], s37 offen offset:512 nt lds
    s_add_u32 m0, s35, 17984
    s_nop 0
    buffer_load_dwordx4 v8, s[20:23], s37 offen offset:1024 nt lds
    s_add_u32 m0, s35, 18528
    s_nop 0
    buffer_load_dwordx4 v8, s[20:23], s37 offen offset:1536 nt lds
    s_add_u32 s37, s37, 16384
    v_add_u32 v1, 84480, v1
    ds_read_b64_tr_b16 v[12:13], v1 offset:384
    ds_read_b64_tr_b16 v[14:15], v1 offset:896
    ds_read_b64_tr_b16 v[16:17], v1 offset:416
    ds_read_b64_tr_b16 v[18:19], v1 offset:928
    ds_read_b64_tr_b16 v[20:21], v1 offset:448
    ds_read_b64_tr_b16 v[22:23], v1 offset:960
    ds_read_b64_tr_b16 v[24:25], v1 offset:480
    ds_read_b64_tr_b16 v[26:27], v1 offset:992
    ds_read_b64_tr_b16 v[28:29], v1 offset:96
    ds_read_b64_tr_b16 v[30:31], v1 offset:608
    ds_read_b64_tr_b16 v[32:33], v1 offset:224
    ds_read_b64_tr_b16 v[34:35], v1 offset:736
    ds_read_b64_tr_b16 v[36:37], v1 offset:352
    ds_read_b64_tr_b16 v[38:39], v1 offset:864
    s_waitcnt vmcnt(4)
    s_barrier
    ds_read_b32 v5, v4 offset:0
    ds_read_b128 v[228:231], v2 offset:0
    ds_read_b128 v[232:235], v2 offset:1024
    ds_read_b128 v[236:239], v2 offset:2048
    ds_read_b128 v[240:243], v2 offset:3072
    ds_read_b128 v[244:247], v2 offset:4096
    ds_read_b128 v[248:251], v2 offset:5120
    ds_read_b128 v[252:255], v2 offset:6144
    s_add_u32 s39, s39, 1
    s_add_u32 m0, s35, 33792
    s_nop 0
    buffer_load_dwordx4 v8, s[20:23], s37 offen offset:0 nt lds
    s_waitcnt lgkmcnt(7)
    v_cmp_eq_u32 vcc, s39, v5
    s_cbranch_vccnz L_stub_ob2
L_back_ob2:
    s_waitcnt lgkmcnt(6)
    v_mfma_f32_16x16x32_bf16 v[68:71], v[12:15], v[228:231], v[68:71]
    v_mfma_f32_16x16x32_bf16 v[72:75], v[16:19], v[228:231], v[72:75]
    v_mfma_f32_16x16x32_bf16 v[76:79], v[20:23], v[228:231], v[76:79]
    v_mfma_f32_16x16x32_bf16 v[80:83], v[24:27], v[228:231], v[80:83]
    s_add_u32 m0, s35, 34336
    s_nop 0
    buffer_load_dwordx4 v8, s[20:23], s37 offen offset:512 nt lds
    s_waitcnt lgkmcnt(5)
    v_mfma_f32_16x16x32_bf16 v[84:87], v[12:15], v[232:235], v[84:87]
    v_mfma_f32_16x16x32_bf16 v[88:91], v[16:19], v[232:235], v[88:91]
    v_mfma_f32_16x16x32_bf16 v[92:95], v[20:23], v[232:235], v[92:95]
    v_mfma_f32_16x16x32_bf16 v[96:99], v[24:27], v[232:235], v[96:99]
    s_add_u32 m0, s35, 34880
    s_nop 0
    buffer_load_dwordx4 v8, s[20:23], s37 offen offset:1024 nt lds
    s_waitcnt lgkmcnt(4)
    v_mfma_f32_16x16x32_bf16 v[100:103], v[12:15], v[236:239], v[100:103]
    v_add_u32 v1, 33792, v1
    ds_read_b64_tr_b16 v[40:41], v1 offset:384
    v_mfma_f32_16x16x32_bf16 v[104:107], v[16:19], v[236:239], v[104:107]
    ds_read_b64_tr_b16 v[42:43], v1 offset:896
    v_mfma_f32_16x16x32_bf16 v[108:111], v[20:23], v[236:239], v[108:111]
    ds_read_b64_tr_b16 v[44:45], v1 offset:416
    v_mfma_f32_16x16x32_bf16 v[112:115], v[24:27], v[236:239], v[112:115]
    ds_read_b64_tr_b16 v[46:47], v1 offset:928
    s_add_u32 m0, s35, 35424
    s_nop 0
    buffer_load_dwordx4 v8, s[20:23], s37 offen offset:1536 nt lds
    s_add_u32 s37, s37, 16384
    s_waitcnt lgkmcnt(7)
    v_mfma_f32_16x16x32_bf16 v[116:119], v[12:15], v[240:243], v[116:119]
    ds_read_b64_tr_b16 v[48:49], v1 offset:448
    v_mfma_f32_16x16x32_bf16 v[120:123], v[16:19], v[240:243], v[120:123]
    ds_read_b64_tr_b16 v[50:51], v1 offset:960
    v_mfma_f32_16x16x32_bf16 v[124:127], v[20:23], v[240:243], v[124:127]
    ds_read_b64_tr_b16 v[52:53], v1 offset:480
    v_mfma_f32_16x16x32_bf16 v[128:131], v[24:27], v[240:243], v[128:131]
    ds_read_b64_tr_b16 v[54:55], v1 offset:992
    s_waitcnt lgkmcnt(10)
    v_mfma_f32_16x16x32_bf16 v[132:135], v[12:15], v[244:247], v[132:135]
    ds_read_b64_tr_b16 v[56:57], v1 offset:96
    v_mfma_f32_16x16x32_bf16 v[136:139], v[16:19], v[244:247], v[136:139]
    ds_read_b64_tr_b16 v[58:59], v1 offset:608
    v_mfma_f32_16x16x32_bf16 v[140:143], v[20:23], v[244:247], v[140:143]
    ds_read_b64_tr_b16 v[60:61], v1 offset:224
    v_mfma_f32_16x16x32_bf16 v[144:147], v[24:27], v[244:247], v[144:147]
    ds_read_b64_tr_b16 v[62:63], v1 offset:736
    v_mfma_f32_16x16x32_bf16 v[192:195], v[28:31], v[244:247], v[192:195]
    ds_read_b64_tr_b16 v[64:65], v1 offset:352
    v_mfma_f32_16x16x32_bf16 v[196:199], v[32:35], v[244:247], v[196:199]
    ds_read_b64_tr_b16 v[66:67], v1 offset:864
    v_mfma_f32_16x16x32_bf16 v[200:203], v[36:39], v[244:247], v[200:203]
    s_waitcnt lgkmcnt(15)
    v_mfma_f32_16x16x32_bf16 v[148:151], v[12:15], v[248:251], v[148:151]
    v_mfma_f32_16x16x32_bf16 v[152:155], v[16:19], v[248:251], v[152:155]
    v_mfma_f32_16x16x32_bf16 v[156:159], v[20:23], v[248:251], v[156:159]
    v_mfma_f32_16x16x32_bf16 v[160:163], v[24:27], v[248:251], v[160:163]
    v_mfma_f32_16x16x32_bf16 v[204:207], v[28:31], v[248:251], v[204:207]
    v_mfma_f32_16x16x32_bf16 v[208:211], v[32:35], v[248:251], v[208:211]
    v_mfma_f32_16x16x32_bf16 v[212:215], v[36:39], v[248:251], v[212:215]
    s_waitcnt lgkmcnt(14)
    v_mfma_f32_16x16x32_bf16 v[164:167], v[12:15], v[252:255], v[164:167]
    v_mfma_f32_16x16x32_bf16 v[168:171], v[16:19], v[252:255], v[168:171]
    v_mfma_f32_16x16x32_bf16 v[172:175], v[20:23], v[252:255], v[172:175]
    v_mfma_f32_16x16x32_bf16 v[176:179], v[24:27], v[252:255], v[176:179]
    v_mfma_f32_16x16x32_bf16 v[216:219], v[28:31], v[252:255], v[216:219]
    v_mfma_f32_16x16x32_bf16 v[220:223], v[32:35], v[252:255], v[220:223]
    v_mfma_f32_16x16x32_bf16 v[224:227], v[36:39], v[252:255], v[224:227]
    s_waitcnt vmcnt(4)
    s_barrier
    ds_read_b32 v5, v4 offset:128
    ds_read_b128 v[228:231], v2 offset:7168
    ds_read_b128 v[232:235], v2 offset:8192
    ds_read_b128 v[236:239], v2 offset:9216
    ds_read_b128 v[240:243], v2 offset:10240
    ds_read_b128 v[244:247], v2 offset:11264
    ds_read_b128 v[248:251], v2 offset:12288
    ds_read_b128 v[252:255], v2 offset:13312
    s_add_u32 s39, s39, 1
    s_add_u32 m0, s35, 84480
    s_nop 0
    buffer_load_dwordx4 v8, s[20:23], s37 offen offset:0 nt lds
    s_waitcnt lgkmcnt(7)
    v_cmp_eq_u32 vcc, s39, v5
    s_cbranch_vccnz L_stub_ob3
L_back_ob3:
    s_waitcnt lgkmcnt(6)
    v_mfma_f32_16x16x32_bf16 v[68:71], v[40:43], v[228:231], v[68:71]
    v_mfma_f32_16x16x32_bf16 v[72:75], v[44:47], v[228:231], v[72:75]
    v_mfma_f32_16x16x32_bf16 v[76:79], v[48:51], v[228:231], v[76:79]
    v_mfma_f32_16x16x32_bf16 v[80:83], v[52:55], v[228:231], v[80:83]
    s_add_u32 m0, s35, 85024
    s_nop 0
    buffer_load_dwordx4 v8, s[20:23], s37 offen offset:512 nt lds
    s_waitcnt lgkmcnt(5)
    v_mfma_f32_16x16x32_bf16 v[84:87], v[40:43], v[232:235], v[84:87]
    v_mfma_f32_16x16x32_bf16 v[88:91], v[44:47], v[232:235], v[88:91]
    v_mfma_f32_16x16x32_bf16 v[92:95], v[48:51], v[232:235], v[92:95]
    v_mfma_f32_16x16x32_bf16 v[96:99], v[52:55], v[232:235], v[96:99]
    s_add_u32 m0, s35, 85568
    s_nop 0
    buffer_load_dwordx4 v8, s[20:23], s37 offen offset:1024 nt lds
    s_waitcnt lgkmcnt(4)
    v_mfma_f32_16x16x32_bf16 v[100:103], v[40:43], v[236:239], v[100:103]
    v_add_u32 v1, 4294865920, v1
    ds_read_b64_tr_b16 v[12:13], v1 offset:384
    v_mfma_f32_16x16x32_bf16 v[104:107], v[44:47], v[236:239], v[104:107]
    ds_read_b64_tr_b16 v[14:15], v1 offset:896
    v_mfma_f32_16x16x32_bf16 v[108:111], v[48:51], v[236:239], v[108:111]
    ds_read_b64_tr_b16 v[16:17], v1 offset:416
    v_mfma_f32_16x16x32_bf16 v[112:115], v[52:55], v[236:239], v[112:115]
    ds_read_b64_tr_b16 v[18:19], v1 offset:928
    s_add_u32 m0, s35, 86112
    s_nop 0
    buffer_load_dwordx4 v8, s[20:23], s37 offen offset:1536 nt lds
    s_add_u32 s37, s37, 16384
    s_waitcnt lgkmcnt(7)
    v_mfma_f32_16x16x32_bf16 v[116:119], v[40:43], v[240:243], v[116:119]
    ds_read_b64_tr_b16 v[20:21], v1 offset:448
    v_mfma_f32_16x16x32_bf16 v[120:123], v[44:47], v[240:243], v[120:123]
    ds_read_b64_tr_b16 v[22:23], v1 offset:960
    v_mfma_f32_16x16x32_bf16 v[124:127], v[48:51], v[240:243], v[124:127]
    ds_read_b64_tr_b16 v[24:25], v1 offset:480
    v_mfma_f32_16x16x32_bf16 v[128:131], v[52:55], v[240:243], v[128:131]
    ds_read_b64_tr_b16 v[26:27], v1 offset:992
    s_waitcnt lgkmcnt(10)
    v_mfma_f32_16x16x32_bf16 v[132:135], v[40:43], v[244:247], v[132:135]
    ds_read_b64_tr_b16 v[28:29], v1 offset:96
    v_mfma_f32_16x16x32_bf16 v[136:139], v[44:47], v[244:247], v[136:139]
    ds_read_b64_tr_b16 v[30:31], v1 offset:608
    v_mfma_f32_16x16x32_bf16 v[140:143], v[48:51], v[244:247], v[140:143]
    ds_read_b64_tr_b16 v[32:33], v1 offset:224
    v_mfma_f32_16x16x32_bf16 v[144:147], v[52:55], v[244:247], v[144:147]
    ds_read_b64_tr_b16 v[34:35], v1 offset:736
    v_mfma_f32_16x16x32_bf16 v[192:195], v[56:59], v[244:247], v[192:195]
    ds_read_b64_tr_b16 v[36:37], v1 offset:352
    v_mfma_f32_16x16x32_bf16 v[196:199], v[60:63], v[244:247], v[196:199]
    ds_read_b64_tr_b16 v[38:39], v1 offset:864
    v_mfma_f32_16x16x32_bf16 v[200:203], v[64:67], v[244:247], v[200:203]
    s_waitcnt lgkmcnt(15)
    v_mfma_f32_16x16x32_bf16 v[148:151], v[40:43], v[248:251], v[148:151]
    v_mfma_f32_16x16x32_bf16 v[152:155], v[44:47], v[248:251], v[152:155]
    v_mfma_f32_16x16x32_bf16 v[156:159], v[48:51], v[248:251], v[156:159]
    v_mfma_f32_16x16x32_bf16 v[160:163], v[52:55], v[248:251], v[160:163]
    v_mfma_f32_16x16x32_bf16 v[204:207], v[56:59], v[248:251], v[204:207]
    v_mfma_f32_16x16x32_bf16 v[208:211], v[60:63], v[248:251], v[208:211]
    v_mfma_f32_16x16x32_bf16 v[212:215], v[64:67], v[248:251], v[212:215]
    s_waitcnt lgkmcnt(14)
    v_mfma_f32_16x16x32_bf16 v[164:167], v[40:43], v[252:255], v[164:167]
    v_mfma_f32_16x16x32_bf16 v[168:171], v[44:47], v[252:255], v[168:171]
    v_mfma_f32_16x16x32_bf16 v[172:175], v[48:51], v[252:255], v[172:175]
    v_mfma_f32_16x16x32_bf16 v[176:179], v[52:55], v[252:255], v[176:179]
    v_mfma_f32_16x16x32_bf16 v[216:219], v[56:59], v[252:255], v[216:219]
    v_mfma_f32_16x16x32_bf16 v[220:223], v[60:63], v[252:255], v[220:223]
    v_mfma_f32_16x16x32_bf16 v[224:227], v[64:67], v[252:255], v[224:227]
    s_waitcnt vmcnt(4)
    s_barrier
    ds_read_b32 v5, v4 offset:0
    ds_read_b128 v[228:231], v2 offset:0
    ds_read_b128 v[232:235], v2 offset:1024
    ds_read_b128 v[236:239], v2 offset:2048
    ds_read_b128 v[240:243], v2 offset:3072
    ds_read_b128 v[244:247], v2 offset:4096
    ds_read_b128 v[248:251], v2 offset:5120
    ds_read_b128 v[252:255], v2 offset:6144
    s_add_u32 s39, s39, 1
    s_add_u32 m0, s35, 118272
    s_nop 0
    buffer_load_dwordx4 v8, s[20:23], s37 offen offset:0 nt lds
    s_waitcnt lgkmcnt(7)
    v_cmp_eq_u32 vcc, s39, v5
    s_cbranch_vccnz L_stub_ob4
L_back_ob4:
    s_waitcnt lgkmcnt(6)
    v_mfma_f32_16x16x32_bf16 v[68:71], v[12:15], v[228:231], v[68:71]
    v_mfma_f32_16x16x32_bf16 v[72:75], v[16:19], v[228:231], v[72:75]
    v_mfma_f32_16x16x32_bf16 v[76:79], v[20:23], v[228:231], v[76:79]
    v_mfma_f32_16x16x32_bf16 v[80:83], v[24:27], v[228:231], v[80:83]
    s_add_u32 m0, s35, 118816
    s_nop 0
    buffer_load_dwordx4 v8, s[20:23], s37 offen offset:512 nt lds
    s_waitcnt lgkmcnt(5)
    v_mfma_f32_16x16x32_bf16 v[84:87], v[12:15], v[232:235], v[84:87]
    v_mfma_f32_16x16x32_bf16 v[88:91], v[16:19], v[232:235], v[88:91]
    v_mfma_f32_16x16x32_bf16 v[92:95], v[20:23], v[232:235], v[92:95]
    v_mfma_f32_16x16x32_bf16 v[96:99], v[24:27], v[232:235], v[96:99]
    s_add_u32 m0, s35, 119360
    s_nop 0
    buffer_load_dwordx4 v8, s[20:23], s37 offen offset:1024 nt lds
    s_waitcnt lgkmcnt(4)
    v_mfma_f32_16x16x32_bf16 v[100:103], v[12:15], v[236:239], v[100:103]
    v_add_u32 v1, 16896, v1
    ds_read_b64_tr_b16 v[40:41], v1 offset:384
    v_mfma_f32_16x16x32_bf16 v[104:107], v[16:19], v[236:239], v[104:107]
    ds_read_b64_tr_b16 v[42:43], v1 offset:896
    v_mfma_f32_16x16x32_bf16 v[108:111], v[20:23], v[236:239], v[108:111]
    ds_read_b64_tr_b16 v[44:45], v1 offset:416
    v_mfma_f32_16x16x32_bf16 v[112:115], v[24:27], v[236:239], v[112:115]
    ds_read_b64_tr_b16 v[46:47], v1 offset:928
    s_add_u32 m0, s35, 119904
    s_nop 0
    buffer_load_dwordx4 v8, s[20:23], s37 offen offset:1536 nt lds
    s_add_u32 s37, s37, 16384
    s_waitcnt lgkmcnt(7)
    v_mfma_f32_16x16x32_bf16 v[116:119], v[12:15], v[240:243], v[116:119]
    ds_read_b64_tr_b16 v[48:49], v1 offset:448
    v_mfma_f32_16x16x32_bf16 v[120:123], v[16:19], v[240:243], v[120:123]
    ds_read_b64_tr_b16 v[50:51], v1 offset:960
    v_mfma_f32_16x16x32_bf16 v[124:127], v[20:23], v[240:243], v[124:127]
    ds_read_b64_tr_b16 v[52:53], v1 offset:480
    v_mfma_f32_16x16x32_bf16 v[128:131], v[24:27], v[240:243], v[128:131]
    ds_read_b64_tr_b16 v[54:55], v1 offset:992
    s_waitcnt lgkmcnt(10)
    v_mfma_f32_16x16x32_bf16 v[132:135], v[12:15], v[244:247], v[132:135]
    ds_read_b64_tr_b16 v[56:57], v1 offset:96
    v_mfma_f32_16x16x32_bf16 v[136:139], v[16:19], v[244:247], v[136:139]
    ds_read_b64_tr_b16 v[58:59], v1 offset:608
    v_mfma_f32_16x16x32_bf16 v[140:143], v[20:23], v[244:247], v[140:143]
    ds_read_b64_tr_b16 v[60:61], v1 offset:224
    v_mfma_f32_16x16x32_bf16 v[144:147], v[24:27], v[244:247], v[144:147]
    ds_read_b64_tr_b16 v[62:63], v1 offset:736
    v_mfma_f32_16x16x32_bf16 v[192:195], v[28:31], v[244:247], v[192:195]
    ds_read_b64_tr_b16 v[64:65], v1 offset:352
    v_mfma_f32_16x16x32_bf16 v[196:199], v[32:35], v[244:247], v[196:199]
    ds_read_b64_tr_b16 v[66:67], v1 offset:864
    v_mfma_f32_16x16x32_bf16 v[200:203], v[36:39], v[244:247], v[200:203]
    s_waitcnt lgkmcnt(15)
    v_mfma_f32_16x16x32_bf16 v[148:151], v[12:15], v[248:251], v[148:151]
    v_mfma_f32_16x16x32_bf16 v[152:155], v[16:19], v[248:251], v[152:155]
    v_mfma_f32_16x16x32_bf16 v[156:159], v[20:23], v[248:251], v[156:159]
    v_mfma_f32_16x16x32_bf16 v[160:163], v[24:27], v[248:251], v[160:163]
    v_mfma_f32_16x16x32_bf16 v[204:207], v[28:31], v[248:251], v[204:207]
    v_mfma_f32_16x16x32_bf16 v[208:211], v[32:35], v[248:251], v[208:211]
    v_mfma_f32_16x16x32_bf16 v[212:215], v[36:39], v[248:251], v[212:215]
    s_waitcnt lgkmcnt(14)
    v_mfma_f32_16x16x32_bf16 v[164:167], v[12:15], v[252:255], v[164:167]
    v_mfma_f32_16x16x32_bf16 v[168:171], v[16:19], v[252:255], v[168:171]
    v_mfma_f32_16x16x32_bf16 v[172:175], v[20:23], v[252:255], v[172:175]
    v_mfma_f32_16x16x32_bf16 v[176:179], v[24:27], v[252:255], v[176:179]
    v_mfma_f32_16x16x32_bf16 v[216:219], v[28:31], v[252:255], v[216:219]
    v_mfma_f32_16x16x32_bf16 v[220:223], v[32:35], v[252:255], v[220:223]
    v_mfma_f32_16x16x32_bf16 v[224:227], v[36:39], v[252:255], v[224:227]
    s_waitcnt vmcnt(4)
    s_barrier
    s_mov_b32 s38, 14
L_oloopb:
    ds_read_b32 v5, v4 offset:128
    ds_read_b128 v[228:231], v2 offset:7168
    ds_read_b128 v[232:235], v2 offset:8192
    ds_read_b128 v[236:239], v2 offset:9216
    ds_read_b128 v[240:243], v2 offset:10240
    ds_read_b128 v[244:247], v2 offset:11264
    ds_read_b128 v[248:251], v2 offset:12288
    ds_read_b128 v[252:255], v2 offset:13312
    s_add_u32 s39, s39, 1
    s_add_u32 m0, s35, 16896
    s_nop 0
    buffer_load_dwordx4 v8, s[20:23], s37 offen offset:0 nt lds
    s_waitcnt lgkmcnt(7)
    v_cmp_eq_u32 vcc, s39, v5
    s_cbranch_vccnz L_stub_ob5
L_back_ob5:
    s_waitcnt lgkmcnt(6)
    v_mfma_f32_16x16x32_bf16 v[68:71], v[40:43], v[228:231], v[68:71]
    v_mfma_f32_16x16x32_bf16 v[72:75], v[44:47], v[228:231], v[72:75]
    v_mfma_f32_16x16x32_bf16 v[76:79], v[48:51], v[228:231], v[76:79]
    v_mfma_f32_16x16x32_bf16 v[80:83], v[52:55], v[228:231], v[80:83]
    s_add_u32 m0, s35, 17440
    s_nop 0
    buffer_load_dwordx4 v8, s[20:23], s37 offen offset:512 nt lds
    s_waitcnt lgkmcnt(5)
    v_mfma_f32_16x16x32_bf16 v[84:87], v[40:43], v[232:235], v[84:87]
    v_mfma_f32_16x16x32_bf16 v[88:91], v[44:47], v[232:235], v[88:91]
    v_mfma_f32_16x16x32_bf16 v[92:95], v[48:51], v[232:235], v[92:95]
    v_mfma_f32_16x16x32_bf16 v[96:99], v[52:55], v[232:235], v[96:99]
    s_add_u32 m0, s35, 17984
    s_nop 0
    buffer_load_dwordx4 v8, s[20:23], s37 offen offset:1024 nt lds
    s_waitcnt lgkmcnt(4)
    v_mfma_f32_16x16x32_bf16 v[100:103], v[40:43], v[236:239], v[100:103]
    v_add_u32 v1, 50688, v1
    ds_read_b64_tr_b16 v[12:13], v1 offset:384
    v_mfma_f32_16x16x32_bf16 v[104:107], v[44:47], v[236:239], v[104:107]
    ds_read_b64_tr_b16 v[14:15], v1 offset:896
    v_mfma_f32_16x16x32_bf16 v[108:111], v[48:51], v[236:239], v[108:111]
    ds_read_b64_tr_b16 v[16:17], v1 offset:416
    v_mfma_f32_16x16x32_bf16 v[112:115], v[52:55], v[236:239], v[112:115]
    ds_read_b64_tr_b16 v[18:19], v1 offset:928
    s_add_u32 m0, s35, 18528
    s_nop 0
    buffer_load_dwordx4 v8, s[20:23], s37 offen offset:1536 nt lds
    s_add_u32 s37, s37, 16384
    s_waitcnt lgkmcnt(7)
    v_mfma_f32_16x16x32_bf16 v[116:119], v[40:43], v[240:243], v[116:119]
    ds_read_b64_tr_b16 v[20:21], v1 offset:448
    v_mfma_f32_16x16x32_bf16 v[120:123], v[44:47], v[240:243], v[120:123]
    ds_read_b64_tr_b16 v[22:23], v1 offset:960
    v_mfma_f32_16x16x32_bf16 v[124:127], v[48:51], v[240:243], v[124:127]
    ds_read_b64_tr_b16 v[24:25], v1 offset:480
    v_mfma_f32_16x16x32_bf16 v[128:131], v[52:55], v[240:243], v[128:131]
    ds_read_b64_tr_b16 v[26:27], v1 offset:992
    s_waitcnt lgkmcnt(10)
    v_mfma_f32_16x16x32_bf16 v[132:135], v[40:43], v[244:247], v[132:135]
    ds_read_b64_tr_b16 v[28:29], v1 offset:96
    v_mfma_f32_16x16x32_bf16 v[136:139], v[44:47], v[244:247], v[136:139]
    ds_read_b64_tr_b16 v[30:31], v1 offset:608
    v_mfma_f32_16x16x32_bf16 v[140:143], v[48:51], v[244:247], v[140:143]
    ds_read_b64_tr_b16 v[32:33], v1 offset:224
    v_mfma_f32_16x16x32_bf16 v[144:147], v[52:55], v[244:247], v[144:147]
    ds_read_b64_tr_b16 v[34:35], v1 offset:736
    v_mfma_f32_16x16x32_bf16 v[192:195], v[56:59], v[244:247], v[192:195]
    ds_read_b64_tr_b16 v[36:37], v1 offset:352
    v_mfma_f32_16x16x32_bf16 v[196:199], v[60:63], v[244:247], v[196:199]
    ds_read_b64_tr_b16 v[38:39], v1 offset:864
    v_mfma_f32_16x16x32_bf16 v[200:203], v[64:67], v[244:247], v[200:203]
    s_waitcnt lgkmcnt(15)
    v_mfma_f32_16x16x32_bf16 v[148:151], v[40:43], v[248:251], v[148:151]
    v_mfma_f32_16x16x32_bf16 v[152:155], v[44:47], v[248:251], v[152:155]
    v_mfma_f32_16x16x32_bf16 v[156:159], v[48:51], v[248:251], v[156:159]
    v_mfma_f32_16x16x32_bf16 v[160:163], v[52:55], v[248:251], v[160:163]
    v_mfma_f32_16x16x32_bf16 v[204:207], v[56:59], v[248:251], v[204:207]
    v_mfma_f32_16x16x32_bf16 v[208:211], v[60:63], v[248:251], v[208:211]
    v_mfma_f32_16x16x32_bf16 v[212:215], v[64:67], v[248:251], v[212:215]
    s_waitcnt lgkmcnt(14)
    v_mfma_f32_16x16x32_bf16 v[164:167], v[40:43], v[252:255], v[164:167]
    v_mfma_f32_16x16x32_bf16 v[168:171], v[44:47], v[252:255], v[168:171]
    v_mfma_f32_16x16x32_bf16 v[172:175], v[48:51], v[252:255], v[172:175]
    v_mfma_f32_16x16x32_bf16 v[176:179], v[52:55], v[252:255], v[176:179]
    v_mfma_f32_16x16x32_bf16 v[216:219], v[56:59], v[252:255], v[216:219]
    v_mfma_f32_16x16x32_bf16 v[220:223], v[60:63], v[252:255], v[220:223]
    v_mfma_f32_16x16x32_bf16 v[224:227], v[64:67], v[252:255], v[224:227]
    s_waitcnt vmcnt(4)
    s_barrier
    ds_read_b32 v5, v4 offset:0
    ds_read_b128 v[228:231], v2 offset:0
    ds_read_b128 v[232:235], v2 offset:1024
    ds_read_b128 v[236:239], v2 offset:2048
    ds_read_b128 v[240:243], v2 offset:3072
    ds_read_b128 v[244:247], v2 offset:4096
    ds_read_b128 v[248:251], v2 offset:5120
    ds_read_b128 v[252:255], v2 offset:6144
    s_add_u32 s39, s39, 1
    s_add_u32 m0, s35, 33792
    s_nop 0
    buffer_load_dwordx4 v8, s[20:23], s37 offen offset:0 nt lds
    s_waitcnt lgkmcnt(7)
    v_cmp_eq_u32 vcc, s39, v5
    s_cbranch_vccnz L_stub_ob6
L_back_ob6:
    s_waitcnt lgkmcnt(6)
    v_mfma_f32_16x16x32_bf16 v[68:71], v[12:15], v[228:231], v[68:71]
    v_mfma_f32_16x16x32_bf16 v[72:75], v[16:19], v[228:231], v[72:75]
    v_mfma_f32_16x16x32_bf16 v[76:79], v[20:23], v[228:231], v[76:79]
    v_mfma_f32_16x16x32_bf16 v[80:83], v[24:27], v[228:231], v[80:83]
    s_add_u32 m0, s35, 34336
    s_nop 0
    buffer_load_dwordx4 v8, s[20:23], s37 offen offset:512 nt lds
    s_waitcnt lgkmcnt(5)
    v_mfma_f32_16x16x32_bf16 v[84:87], v[12:15], v[232:235], v[84:87]
    v_mfma_f32_16x16x32_bf16 v[88:91], v[16:19], v[232:235], v[88:91]
    v_mfma_f32_16x16x32_bf16 v[92:95], v[20:23], v[232:235], v[92:95]
    v_mfma_f32_16x16x32_bf16 v[96:99], v[24:27], v[232:235], v[96:99]
    s_add_u32 m0, s35, 34880
    s_nop 0
    buffer_load_dwordx4 v8, s[20:23], s37 offen offset:1024 nt lds
    s_waitcnt lgkmcnt(4)
    v_mfma_f32_16x16x32_bf16 v[100:103], v[12:15], v[236:239], v[100:103]
    v_add_u32 v1, 33792, v1
    ds_read_b64_tr_b16 v[40:41], v1 offset:384
    v_mfma_f32_16x16x32_bf16 v[104:107], v[16:19], v[236:239], v[104:107]
    ds_read_b64_tr_b16 v[42:43], v1 offset:896
    v_mfma_f32_16x16x32_bf16 v[108:111], v[20:23], v[236:239], v[108:111]
    ds_read_b64_tr_b16 v[44:45], v1 offset:416
    v_mfma_f32_16x16x32_bf16 v[112:115], v[24:27], v[236:239], v[112:115]
    ds_read_b64_tr_b16 v[46:47], v1 offset:928
    s_add_u32 m0, s35, 35424
    s_nop 0
    buffer_load_dwordx4 v8, s[20:23], s37 offen offset:1536 nt lds
    s_add_u32 s37, s37, 16384
    s_waitcnt lgkmcnt(7)
    v_mfma_f32_16x16x32_bf16 v[116:119], v[12:15], v[240:243], v[116:119]
    ds_read_b64_tr_b16 v[48:49], v1 offset:448
    v_mfma_f32_16x16x32_bf16 v[120:123], v[16:19], v[240:243], v[120:123]
    ds_read_b64_tr_b16 v[50:51], v1 offset:960
    v_mfma_f32_16x16x32_bf16 v[124:127], v[20:23], v[240:243], v[124:127]
    ds_read_b64_tr_b16 v[52:53], v1 offset:480
    v_mfma_f32_16x16x32_bf16 v[128:131], v[24:27], v[240:243], v[128:131]
    ds_read_b64_tr_b16 v[54:55], v1 offset:992
    s_waitcnt lgkmcnt(10)
    v_mfma_f32_16x16x32_bf16 v[132:135], v[12:15], v[244:247], v[132:135]
    ds_read_b64_tr_b16 v[56:57], v1 offset:96
    v_mfma_f32_16x16x32_bf16 v[136:139], v[16:19], v[244:247], v[136:139]
    ds_read_b64_tr_b16 v[58:59], v1 offset:608
    v_mfma_f32_16x16x32_bf16 v[140:143], v[20:23], v[244:247], v[140:143]
    ds_read_b64_tr_b16 v[60:61], v1 offset:224
    v_mfma_f32_16x16x32_bf16 v[144:147], v[24:27], v[244:247], v[144:147]
    ds_read_b64_tr_b16 v[62:63], v1 offset:736
    v_mfma_f32_16x16x32_bf16 v[192:195], v[28:31], v[244:247], v[192:195]
    ds_read_b64_tr_b16 v[64:65], v1 offset:352
    v_mfma_f32_16x16x32_bf16 v[196:199], v[32:35], v[244:247], v[196:199]
    ds_read_b64_tr_b16 v[66:67], v1 offset:864
    v_mfma_f32_16x16x32_bf16 v[200:203], v[36:39], v[244:247], v[200:203]
    s_waitcnt lgkmcnt(15)
    v_mfma_f32_16x16x32_bf16 v[148:151], v[12:15], v[248:251], v[148:151]
    v_mfma_f32_16x16x32_bf16 v[152:155], v[16:19], v[248:251], v[152:155]
    v_mfma_f32_16x16x32_bf16 v[156:159], v[20:23], v[248:251], v[156:159]
    v_mfma_f32_16x16x32_bf16 v[160:163], v[24:27], v[248:251], v[160:163]
    v_mfma_f32_16x16x32_bf16 v[204:207], v[28:31], v[248:251], v[204:207]
    v_mfma_f32_16x16x32_bf16 v[208:211], v[32:35], v[248:251], v[208:211]
    v_mfma_f32_16x16x32_bf16 v[212:215], v[36:39], v[248:251], v[212:215]
    s_waitcnt lgkmcnt(14)
    v_mfma_f32_16x16x32_bf16 v[164:167], v[12:15], v[252:255], v[164:167]
    v_mfma_f32_16x16x32_bf16 v[168:171], v[16:19], v[252:255], v[168:171]
    v_mfma_f32_16x16x32_bf16 v[172:175], v[20:23], v[252:255], v[172:175]
    v_mfma_f32_16x16x32_bf16 v[176:179], v[24:27], v[252:255], v[176:179]
    v_mfma_f32_16x16x32_bf16 v[216:219], v[28:31], v[252:255], v[216:219]
    v_mfma_f32_16x16x32_bf16 v[220:223], v[32:35], v[252:255], v[220:223]
    v_mfma_f32_16x16x32_bf16 v[224:227], v[36:39], v[252:255], v[224:227]
    s_waitcnt vmcnt(4)
    s_barrier
    ds_read_b32 v5, v4 offset:128
    ds_read_b128 v[228:231], v2 offset:7168
    ds_read_b128 v[232:235], v2 offset:8192
    ds_read_b128 v[236:239], v2 offset:9216
    ds_read_b128 v[240:243], v2 offset:10240
    ds_read_b128 v[244:247], v2 offset:11264
    ds_read_b128 v[248:251], v2 offset:12288
    ds_read_b128 v[252:255], v2 offset:13312
    s_add_u32 s39, s39, 1
    s_add_u32 m0, s35, 84480
    s_nop 0
    buffer_load_dwordx4 v8, s[20:23], s37 offen offset:0 nt lds
    s_waitcnt lgkmcnt(7)
    v_cmp_eq_u32 vcc, s39, v5
    s_cbranch_vccnz L_stub_ob7
L_back_ob7:
    s_waitcnt lgkmcnt(6)
    v_mfma_f32_16x16x32_bf16 v[68:71], v[40:43], v[228:231], v[68:71]
    v_mfma_f32_16x16x32_bf16 v[72:75], v[44:47], v[228:231], v[72:75]
    v_mfma_f32_16x16x32_bf16 v[76:79], v[48:51], v[228:231], v[76:79]
    v_mfma_f32_16x16x32_bf16 v[80:83], v[52:55], v[228:231], v[80:83]
    s_add_u32 m0, s35, 85024
    s_nop 0
    buffer_load_dwordx4 v8, s[20:23], s37 offen offset:512 nt lds
    s_waitcnt lgkmcnt(5)
    v_mfma_f32_16x16x32_bf16 v[84:87], v[40:43], v[232:235], v[84:87]
    v_mfma_f32_16x16x32_bf16 v[88:91], v[44:47], v[232:235], v[88:91]
    v_mfma_f32_16x16x32_bf16 v[92:95], v[48:51], v[232:235], v[92:95]
    v_mfma_f32_16x16x32_bf16 v[96:99], v[52:55], v[232:235], v[96:99]
    s_add_u32 m0, s35, 85568
    s_nop 0
    buffer_load_dwordx4 v8, s[20:23], s37 offen offset:1024 nt lds
    s_waitcnt lgkmcnt(4)
    v_mfma_f32_16x16x32_bf16 v[100:103], v[40:43], v[236:239], v[100:103]
    v_add_u32 v1, 4294865920, v1
    ds_read_b64_tr_b16 v[12:13], v1 offset:384
    v_mfma_f32_16x16x32_bf16 v[104:107], v[44:47], v[236:239], v[104:107]
    ds_read_b64_tr_b16 v[14:15], v1 offset:896
    v_mfma_f32_16x16x32_bf16 v[108:111], v[48:51], v[236:239], v[108:111]
    ds_read_b64_tr_b16 v[16:17], v1 offset:416
    v_mfma_f32_16x16x32_bf16 v[112:115], v[52:55], v[236:239], v[112:115]
    ds_read_b64_tr_b16 v[18:19], v1 offset:928
    s_add_u32 m0, s35, 86112
    s_nop 0
    buffer_load_dwordx4 v8, s[20:23], s37 offen offset:1536 nt lds
    s_add_u32 s37, s37, 16384
    s_waitcnt lgkmcnt(7)
    v_mfma_f32_16x16x32_bf16 v[116:119], v[40:43], v[240:243], v[116:119]
    ds_read_b64_tr_b16 v[20:21], v1 offset:448
    v_mfma_f32_16x16x32_bf16 v[120:123], v[44:47], v[240:243], v[120:123]
    ds_read_b64_tr_b16 v[22:23], v1 offset:960
    v_mfma_f32_16x16x32_bf16 v[124:127], v[48:51], v[240:243], v[124:127]
    ds_read_b64_tr_b16 v[24:25], v1 offset:480
    v_mfma_f32_16x16x32_bf16 v[128:131], v[52:55], v[240:243], v[128:131]
    ds_read_b64_tr_b16 v[26:27], v1 offset:992
    s_waitcnt lgkmcnt(10)
    v_mfma_f32_16x16x32_bf16 v[132:135], v[40:43], v[244:247], v[132:135]
    ds_read_b64_tr_b16 v[28:29], v1 offset:96
    v_mfma_f32_16x16x32_bf16 v[136:139], v[44:47], v[244:247], v[136:139]
    ds_read_b64_tr_b16 v[30:31], v1 offset:608
    v_mfma_f32_16x16x32_bf16 v[140:143], v[48:51], v[244:247], v[140:143]
    ds_read_b64_tr_b16 v[32:33], v1 offset:224
    v_mfma_f32_16x16x32_bf16 v[144:147], v[52:55], v[244:247], v[144:147]
    ds_read_b64_tr_b16 v[34:35], v1 offset:736
    v_mfma_f32_16x16x32_bf16 v[192:195], v[56:59], v[244:247], v[192:195]
    ds_read_b64_tr_b16 v[36:37], v1 offset:352
    v_mfma_f32_16x16x32_bf16 v[196:199], v[60:63], v[244:247], v[196:199]
    ds_read_b64_tr_b16 v[38:39], v1 offset:864
    v_mfma_f32_16x16x32_bf16 v[200:203], v[64:67], v[244:247], v[200:203]
    s_waitcnt lgkmcnt(15)
    v_mfma_f32_16x16x32_bf16 v[148:151], v[40:43], v[248:251], v[148:151]
    v_mfma_f32_16x16x32_bf16 v[152:155], v[44:47], v[248:251], v[152:155]
    v_mfma_f32_16x16x32_bf16 v[156:159], v[48:51], v[248:251], v[156:159]
    v_mfma_f32_16x16x32_bf16 v[160:163], v[52:55], v[248:251], v[160:163]
    v_mfma_f32_16x16x32_bf16 v[204:207], v[56:59], v[248:251], v[204:207]
    v_mfma_f32_16x16x32_bf16 v[208:211], v[60:63], v[248:251], v[208:211]
    v_mfma_f32_16x16x32_bf16 v[212:215], v[64:67], v[248:251], v[212:215]
    s_waitcnt lgkmcnt(14)
    v_mfma_f32_16x16x32_bf16 v[164:167], v[40:43], v[252:255], v[164:167]
    v_mfma_f32_16x16x32_bf16 v[168:171], v[44:47], v[252:255], v[168:171]
    v_mfma_f32_16x16x32_bf16 v[172:175], v[48:51], v[252:255], v[172:175]
    v_mfma_f32_16x16x32_bf16 v[176:179], v[52:55], v[252:255], v[176:179]
    v_mfma_f32_16x16x32_bf16 v[216:219], v[56:59], v[252:255], v[216:219]
    v_mfma_f32_16x16x32_bf16 v[220:223], v[60:63], v[252:255], v[220:223]
    v_mfma_f32_16x16x32_bf16 v[224:227], v[64:67], v[252:255], v[224:227]
    s_waitcnt vmcnt(4)
    s_barrier
    ds_read_b32 v5, v4 offset:0
    ds_read_b128 v[228:231], v2 offset:0
    ds_read_b128 v[232:235], v2 offset:1024
    ds_read_b128 v[236:239], v2 offset:2048
    ds_read_b128 v[240:243], v2 offset:3072
    ds_read_b128 v[244:247], v2 offset:4096
    ds_read_b128 v[248:251], v2 offset:5120
    ds_read_b128 v[252:255], v2 offset:6144
    s_add_u32 s39, s39, 1
    s_add_u32 m0, s35, 118272
    s_nop 0
    buffer_load_dwordx4 v8, s[20:23], s37 offen offset:0 nt lds
    s_waitcnt lgkmcnt(7)
    v_cmp_eq_u32 vcc, s39, v5
    s_cbranch_vccnz L_stub_ob8
L_back_ob8:
    s_waitcnt lgkmcnt(6)
    v_mfma_f32_16x16x32_bf16 v[68:71], v[12:15], v[228:231], v[68:71]
    v_mfma_f32_16x16x32_bf16 v[72:75], v[16:19], v[228:231], v[72:75]
    v_mfma_f32_16x16x32_bf16 v[76:79], v[20:23], v[228:231], v[76:79]
    v_mfma_f32_16x16x32_bf16 v[80:83], v[24:27], v[228:231], v[80:83]
    s_add_u32 m0, s35, 118816
    s_nop 0
    buffer_load_dwordx4 v8, s[20:23], s37 offen offset:512 nt lds
    s_waitcnt lgkmcnt(5)
    v_mfma_f32_16x16x32_bf16 v[84:87], v[12:15], v[232:235], v[84:87]
    v_mfma_f32_16x16x32_bf16 v[88:91], v[16:19], v[232:235], v[88:91]
    v_mfma_f32_16x16x32_bf16 v[92:95], v[20:23], v[232:235], v[92:95]
    v_mfma_f32_16x16x32_bf16 v[96:99], v[24:27], v[232:235], v[96:99]
    s_add_u32 m0, s35, 119360
    s_nop 0
    buffer_load_dwordx4 v8, s[20:23], s37 offen offset:1024 nt lds
    s_waitcnt lgkmcnt(4)
    v_mfma_f32_16x16x32_bf16 v[100:103], v[12:15], v[236:239], v[100:103]
    v_add_u32 v1, 16896, v1
    ds_read_b64_tr_b16 v[40:41], v1 offset:384
    v_mfma_f32_16x16x32_bf16 v[104:107], v[16:19], v[236:239], v[104:107]
    ds_read_b64_tr_b16 v[42:43], v1 offset:896
    v_mfma_f32_16x16x32_bf16 v[108:111], v[20:23], v[236:239], v[108:111]
    ds_read_b64_tr_b16 v[44:45], v1 offset:416
    v_mfma_f32_16x16x32_bf16 v[112:115], v[24:27], v[236:239], v[112:115]
    ds_read_b64_tr_b16 v[46:47], v1 offset:928
    s_add_u32 m0, s35, 119904
    s_nop 0
    buffer_load_dwordx4 v8, s[20:23], s37 offen offset:1536 nt lds
    s_add_u32 s37, s37, 16384
    s_waitcnt lgkmcnt(7)
    v_mfma_f32_16x16x32_bf16 v[116:119], v[12:15], v[240:243], v[116:119]
    ds_read_b64_tr_b16 v[48:49], v1 offset:448
    v_mfma_f32_16x16x32_bf16 v[120:123], v[16:19], v[240:243], v[120:123]
    ds_read_b64_tr_b16 v[50:51], v1 offset:960
    v_mfma_f32_16x16x32_bf16 v[124:127], v[20:23], v[240:243], v[124:127]
    ds_read_b64_tr_b16 v[52:53], v1 offset:480
    v_mfma_f32_16x16x32_bf16 v[128:131], v[24:27], v[240:243], v[128:131]
    ds_read_b64_tr_b16 v[54:55], v1 offset:992
    s_waitcnt lgkmcnt(10)
    v_mfma_f32_16x16x32_bf16 v[132:135], v[12:15], v[244:247], v[132:135]
    ds_read_b64_tr_b16 v[56:57], v1 offset:96
    v_mfma_f32_16x16x32_bf16 v[136:139], v[16:19], v[244:247], v[136:139]
    ds_read_b64_tr_b16 v[58:59], v1 offset:608
    v_mfma_f32_16x16x32_bf16 v[140:143], v[20:23], v[244:247], v[140:143]
    ds_read_b64_tr_b16 v[60:61], v1 offset:224
    v_mfma_f32_16x16x32_bf16 v[144:147], v[24:27], v[244:247], v[144:147]
    ds_read_b64_tr_b16 v[62:63], v1 offset:736
    v_mfma_f32_16x16x32_bf16 v[192:195], v[28:31], v[244:247], v[192:195]
    ds_read_b64_tr_b16 v[64:65], v1 offset:352
    v_mfma_f32_16x16x32_bf16 v[196:199], v[32:35], v[244:247], v[196:199]
    ds_read_b64_tr_b16 v[66:67], v1 offset:864
    v_mfma_f32_16x16x32_bf16 v[200:203], v[36:39], v[244:247], v[200:203]
    s_waitcnt lgkmcnt(15)
    v_mfma_f32_16x16x32_bf16 v[148:151], v[12:15], v[248:251], v[148:151]
    v_mfma_f32_16x16x32_bf16 v[152:155], v[16:19], v[248:251], v[152:155]
    v_mfma_f32_16x16x32_bf16 v[156:159], v[20:23], v[248:251], v[156:159]
    v_mfma_f32_16x16x32_bf16 v[160:163], v[24:27], v[248:251], v[160:163]
    v_mfma_f32_16x16x32_bf16 v[204:207], v[28:31], v[248:251], v[204:207]
    v_mfma_f32_16x16x32_bf16 v[208:211], v[32:35], v[248:251], v[208:211]
    v_mfma_f32_16x16x32_bf16 v[212:215], v[36:39], v[248:251], v[212:215]
    s_waitcnt lgkmcnt(14)
    v_mfma_f32_16x16x32_bf16 v[164:167], v[12:15], v[252:255], v[164:167]
    v_mfma_f32_16x16x32_bf16 v[168:171], v[16:19], v[252:255], v[168:171]
    v_mfma_f32_16x16x32_bf16 v[172:175], v[20:23], v[252:255], v[172:175]
    v_mfma_f32_16x16x32_bf16 v[176:179], v[24:27], v[252:255], v[176:179]
    v_mfma_f32_16x16x32_bf16 v[216:219], v[28:31], v[252:255], v[216:219]
    v_mfma_f32_16x16x32_bf16 v[220:223], v[32:35], v[252:255], v[220:223]
    v_mfma_f32_16x16x32_bf16 v[224:227], v[36:39], v[252:255], v[224:227]
    s_waitcnt vmcnt(4)
    s_barrier
    s_sub_u32 s38, s38, 1
    s_cmp_lg_u32 s38, 0
    s_cbranch_scc1 L_oloopb
    ds_read_b32 v5, v4 offset:128
    ds_read_b128 v[228:231], v2 offset:7168
    ds_read_b128 v[232:235], v2 offset:8192
    ds_read_b128 v[236:239], v2 offset:9216
    ds_read_b128 v[240:243], v2 offset:10240
    ds_read_b128 v[244:247], v2 offset:11264
    ds_read_b128 v[248:251], v2 offset:12288
    ds_read_b128 v[252:255], v2 offset:13312
    s_add_u32 s39, s39, 1
    s_add_u32 m0, s35, 16896
    s_nop 0
    buffer_load_dwordx4 v8, s[20:23], s37 offen offset:0 nt lds
    s_add_u32 m0, s35, 17440
    s_nop 0
    buffer_load_dwordx4 v8, s[20:23], s37 offen offset:512 nt lds
    s_waitcnt lgkmcnt(7)
    v_cmp_eq_u32 vcc, s39, v5
    s_cbranch_vccnz L_stub_ob61
L_back_ob61:
    s_waitcnt lgkmcnt(6)
    v_mfma_f32_16x16x32_bf16 v[68:71], v[40:43], v[228:231], v[68:71]
    v_mfma_f32_16x16x32_bf16 v[72:75], v[44:47], v[228:231], v[72:75]
    v_mfma_f32_16x16x32_bf16 v[76:79], v[48:51], v[228:231], v[76:79]
    v_mfma_f32_16x16x32_bf16 v[80:83], v[52:55], v[228:231], v[80:83]
    s_add_u32 m0, s35, 17984
    s_nop 0
    buffer_load_dwordx4 v8, s[20:23], s37 offen offset:1024 nt lds
    s_add_u32 m0, s35, 18528
    s_nop 0
    buffer_load_dwordx4 v8, s[20:23], s37 offen offset:1536 nt lds
    s_add_u32 s37, s37, 16384
    s_waitcnt lgkmcnt(5)
    v_mfma_f32_16x16x32_bf16 v[84:87], v[40:43], v[232:235], v[84:87]
    v_mfma_f32_16x16x32_bf16 v[88:91], v[44:47], v[232:235], v[88:91]
    v_mfma_f32_16x16x32_bf16 v[92:95], v[48:51], v[232:235], v[92:95]
    v_mfma_f32_16x16x32_bf16 v[96:99], v[52:55], v[232:235], v[96:99]
    s_add_u32 m0, s35, 50688
    s_add_u32 s44, s47, 0
    buffer_load_dwordx4 v9, s[24:27], s44 offen lds
    s_add_u32 m0, s35, 51744
    s_add_u32 s44, s47, 896
    buffer_load_dwordx4 v9, s[24:27], s44 offen lds
    s_waitcnt lgkmcnt(4)
    v_mfma_f32_16x16x32_bf16 v[100:103], v[40:43], v[236:239], v[100:103]
    v_add_u32 v1, 50688, v1
    ds_read_b64_tr_b16 v[12:13], v1 offset:384
    v_mfma_f32_16x16x32_bf16 v[104:107], v[44:47], v[236:239], v[104:107]
    ds_read_b64_tr_b16 v[14:15], v1 offset:896
    v_mfma_f32_16x16x32_bf16 v[108:111], v[48:51], v[236:239], v[108:111]
    ds_read_b64_tr_b16 v[16:17], v1 offset:416
    v_mfma_f32_16x16x32_bf16 v[112:115], v[52:55], v[236:239], v[112:115]
    ds_read_b64_tr_b16 v[18:19], v1 offset:928
    s_add_u32 m0, s35, 52800
    s_add_u32 s44, s47, 1792
    buffer_load_dwordx4 v9, s[24:27], s44 offen lds
    s_add_u32 m0, s35, 53856
    s_add_u32 s44, s47, 2688
    buffer_load_dwordx4 v9, s[24:27], s44 offen lds
    s_waitcnt lgkmcnt(7)
    v_mfma_f32_16x16x32_bf16 v[116:119], v[40:43], v[240:243], v[116:119]
    ds_read_b64_tr_b16 v[20:21], v1 offset:448
    v_mfma_f32_16x16x32_bf16 v[120:123], v[44:47], v[240:243], v[120:123]
    ds_read_b64_tr_b16 v[22:23], v1 offset:960
    v_mfma_f32_16x16x32_bf16 v[124:127], v[48:51], v[240:243], v[124:127]
    ds_read_b64_tr_b16 v[24:25], v1 offset:480
    v_mfma_f32_16x16x32_bf16 v[128:131], v[52:55], v[240:243], v[128:131]
    ds_read_b64_tr_b16 v[26:27], v1 offset:992
    s_waitcnt lgkmcnt(10)
    v_mfma_f32_16x16x32_bf16 v[132:135], v[40:43], v[244:247], v[132:135]
    ds_read_b64_tr_b16 v[28:29], v1 offset:96
    v_mfma_f32_16x16x32_bf16 v[136:139], v[44:47], v[244:247], v[136:139]
    ds_read_b64_tr_b16 v[30:31], v1 offset:608
    v_mfma_f32_16x16x32_bf16 v[140:143], v[48:51], v[244:247], v[140:143]
    ds_read_b64_tr_b16 v[32:33], v1 offset:224
    v_mfma_f32_16x16x32_bf16 v[144:147], v[52:55], v[244:247], v[144:147]
    ds_read_b64_tr_b16 v[34:35], v1 offset:736
    v_mfma_f32_16x16x32_bf16 v[192:195], v[56:59], v[244:247], v[192:195]
    ds_read_b64_tr_b16 v[36:37], v1 offset:352
    v_mfma_f32_16x16x32_bf16 v[196:199], v[60:63], v[244:247], v[196:199]
    ds_read_b64_tr_b16 v[38:39], v1 offset:864
    v_mfma_f32_16x16x32_bf16 v[200:203], v[64:67], v[244:247], v[200:203]
    s_waitcnt lgkmcnt(15)
    v_mfma_f32_16x16x32_bf16 v[148:151], v[40:43], v[248:251], v[148:151]
    v_mfma_f32_16x16x32_bf16 v[152:155], v[44:47], v[248:251], v[152:155]
    v_mfma_f32_16x16x32_bf16 v[156:159], v[48:51], v[248:251], v[156:159]
    v_mfma_f32_16x16x32_bf16 v[160:163], v[52:55], v[248:251], v[160:163]
    v_mfma_f32_16x16x32_bf16 v[204:207], v[56:59], v[248:251], v[204:207]
    v_mfma_f32_16x16x32_bf16 v[208:211], v[60:63], v[248:251], v[208:211]
    v_mfma_f32_16x16x32_bf16 v[212:215], v[64:67], v[248:251], v[212:215]
    s_waitcnt lgkmcnt(14)
    v_mfma_f32_16x16x32_bf16 v[164:167], v[40:43], v[252:255], v[164:167]
    v_mfma_f32_16x16x32_bf16 v[168:171], v[44:47], v[252:255], v[168:171]
    v_mfma_f32_16x16x32_bf16 v[172:175], v[48:51], v[252:255], v[172:175]
    v_mfma_f32_16x16x32_bf16 v[176:179], v[52:55], v[252:255], v[176:179]
    v_mfma_f32_16x16x32_bf16 v[216:219], v[56:59], v[252:255], v[216:219]
    v_mfma_f32_16x16x32_bf16 v[220:223], v[60:63], v[252:255], v[220:223]
    v_mfma_f32_16x16x32_bf16 v[224:227], v[64:67], v[252:255], v[224:227]
    s_waitcnt vmcnt(8)
    s_barrier
    ds_read_b32 v5, v4 offset:0
    ds_read_b128 v[228:231], v2 offset:0
    ds_read_b128 v[232:235], v2 offset:1024
    ds_read_b128 v[236:239], v2 offset:2048
    ds_read_b128 v[240:243], v2 offset:3072
    ds_read_b128 v[244:247], v2 offset:4096
    ds_read_b128 v[248:251], v2 offset:5120
    ds_read_b128 v[252:255], v2 offset:6144
    s_add_u32 s39, s39, 1
    s_add_u32 m0, s35, 33792
    s_nop 0
    buffer_load_dwordx4 v8, s[20:23], s37 offen offset:0 nt lds
    s_add_u32 m0, s35, 34336
    s_nop 0
    buffer_load_dwordx4 v8, s[20:23], s37 offen offset:512 nt lds
    s_waitcnt lgkmcnt(7)
    v_cmp_eq_u32 vcc, s39, v5
    s_cbranch_vccnz L_stub_ob62
L_back_ob62:
    s_waitcnt lgkmcnt(6)
    v_mfma_f32_16x16x32_bf16 v[68:71], v[12:15], v[228:231], v[68:71]
    v_mfma_f32_16x16x32_bf16 v[72:75], v[16:19], v[228:231], v[72:75]
    v_mfma_f32_16x16x32_bf16 v[76:79], v[20:23], v[228:231], v[76:79]
    v_mfma_f32_16x16x32_bf16 v[80:83], v[24:27], v[228:231], v[80:83]
    s_add_u32 m0, s35, 34880
    s_nop 0
    buffer_load_dwordx4 v8, s[20:23], s37 offen offset:1024 nt lds
    s_add_u32 m0, s35, 35424
    s_nop 0
    buffer_load_dwordx4 v8, s[20:23], s37 offen offset:1536 nt lds
    s_add_u32 s37, s37, 16384
    s_waitcnt lgkmcnt(5)
    v_mfma_f32_16x16x32_bf16 v[84:87], v[12:15], v[232:235], v[84:87]
    v_mfma_f32_16x16x32_bf16 v[88:91], v[16:19], v[232:235], v[88:91]
    v_mfma_f32_16x16x32_bf16 v[92:95], v[20:23], v[232:235], v[92:95]
    v_mfma_f32_16x16x32_bf16 v[96:99], v[24:27], v[232:235], v[96:99]
    s_add_u32 m0, s35, 67584
    s_add_u32 s44, s47, 114688
    buffer_load_dwordx4 v9, s[24:27], s44 offen lds
    s_add_u32 m0, s35, 68640
    s_add_u32 s44, s47, 115584
    buffer_load_dwordx4 v9, s[24:27], s44 offen lds
    s_waitcnt lgkmcnt(4)
    v_mfma_f32_16x16x32_bf16 v[100:103], v[12:15], v[236:239], v[100:103]
    v_add_u32 v1, 33792, v1
    ds_read_b64_tr_b16 v[40:41], v1 offset:384
    v_mfma_f32_16x16x32_bf16 v[104:107], v[16:19], v[236:239], v[104:107]
    ds_read_b64_tr_b16 v[42:43], v1 offset:896
    v_mfma_f32_16x16x32_bf16 v[108:111], v[20:23], v[236:239], v[108:111]
    ds_read_b64_tr_b16 v[44:45], v1 offset:416
    v_mfma_f32_16x16x32_bf16 v[112:115], v[24:27], v[236:239], v[112:115]
    ds_read_b64_tr_b16 v[46:47], v1 offset:928
    s_add_u32 m0, s35, 69696
    s_add_u32 s44, s47, 116480
    buffer_load_dwordx4 v9, s[24:27], s44 offen lds
    s_add_u32 m0, s35, 70752
    s_add_u32 s44, s47, 117376
    buffer_load_dwordx4 v9, s[24:27], s44 offen lds
    s_add_u32 s47, s47, 128
    s_cmp_eq_u32 s47, 896
    s_cselect_b32 s47, 0, s47
    s_waitcnt lgkmcnt(7)
    v_mfma_f32_16x16x32_bf16 v[116:119], v[12:15], v[240:243], v[116:119]
    ds_read_b64_tr_b16 v[48:49], v1 offset:448
    v_mfma_f32_16x16x32_bf16 v[120:123], v[16:19], v[240:243], v[120:123]
    ds_read_b64_tr_b16 v[50:51], v1 offset:960
    v_mfma_f32_16x16x32_bf16 v[124:127], v[20:23], v[240:243], v[124:127]
    ds_read_b64_tr_b16 v[52:53], v1 offset:480
    v_mfma_f32_16x16x32_bf16 v[128:131], v[24:27], v[240:243], v[128:131]
    ds_read_b64_tr_b16 v[54:55], v1 offset:992
    s_waitcnt lgkmcnt(10)
    v_mfma_f32_16x16x32_bf16 v[132:135], v[12:15], v[244:247], v[132:135]
    ds_read_b64_tr_b16 v[56:57], v1 offset:96
    v_mfma_f32_16x16x32_bf16 v[136:139], v[16:19], v[244:247], v[136:139]
    ds_read_b64_tr_b16 v[58:59], v1 offset:608
    v_mfma_f32_16x16x32_bf16 v[140:143], v[20:23], v[244:247], v[140:143]
    ds_read_b64_tr_b16 v[60:61], v1 offset:224
    v_mfma_f32_16x16x32_bf16 v[144:147], v[24:27], v[244:247], v[144:147]
    ds_read_b64_tr_b16 v[62:63], v1 offset:736
    v_mfma_f32_16x16x32_bf16 v[192:195], v[28:31], v[244:247], v[192:195]
    ds_read_b64_tr_b16 v[64:65], v1 offset:352
    v_mfma_f32_16x16x32_bf16 v[196:199], v[32:35], v[244:247], v[196:199]
    ds_read_b64_tr_b16 v[66:67], v1 offset:864
    v_mfma_f32_16x16x32_bf16 v[200:203], v[36:39], v[244:247], v[200:203]
    s_waitcnt lgkmcnt(15)
    v_mfma_f32_16x16x32_bf16 v[148:151], v[12:15], v[248:251], v[148:151]
    v_mfma_f32_16x16x32_bf16 v[152:155], v[16:19], v[248:251], v[152:155]
    v_mfma_f32_16x16x32_bf16 v[156:159], v[20:23], v[248:251], v[156:159]
    v_mfma_f32_16x16x32_bf16 v[160:163], v[24:27], v[248:251], v[160:163]
    v_mfma_f32_16x16x32_bf16 v[204:207], v[28:31], v[248:251], v[204:207]
    v_mfma_f32_16x16x32_bf16 v[208:211], v[32:35], v[248:251], v[208:211]
    v_mfma_f32_16x16x32_bf16 v[212:215], v[36:39], v[248:251], v[212:215]
    s_waitcnt lgkmcnt(14)
    v_mfma_f32_16x16x32_bf16 v[164:167], v[12:15], v[252:255], v[164:167]
    v_mfma_f32_16x16x32_bf16 v[168:171], v[16:19], v[252:255], v[168:171]
    v_mfma_f32_16x16x32_bf16 v[172:175], v[20:23], v[252:255], v[172:175]
    v_mfma_f32_16x16x32_bf16 v[176:179], v[24:27], v[252:255], v[176:179]
    v_mfma_f32_16x16x32_bf16 v[216:219], v[28:31], v[252:255], v[216:219]
    v_mfma_f32_16x16x32_bf16 v[220:223], v[32:35], v[252:255], v[220:223]
    v_mfma_f32_16x16x32_bf16 v[224:227], v[36:39], v[252:255], v[224:227]
    s_waitcnt vmcnt(12)
    s_barrier
    ds_read_b32 v5, v4 offset:128
    ds_read_b128 v[228:231], v2 offset:7168
    ds_read_b128 v[232:235], v2 offset:8192
    ds_read_b128 v[236:239], v2 offset:9216
    ds_read_b128 v[240:243], v2 offset:10240
    ds_read_b128 v[244:247], v2 offset:11264
    ds_read_b128 v[248:251], v2 offset:12288
    ds_read_b128 v[252:255], v2 offset:13312
    s_add_u32 s39, s39, 1
    s_add_u32 m0, s35, 101376
    s_add_u32 s44, s47, 0
    buffer_load_dwordx4 v9, s[24:27], s44 offen lds
    s_waitcnt lgkmcnt(7)
    v_cmp_eq_u32 vcc, s39, v5
    s_cbranch_vccnz L_stub_ob63
L_back_ob63:
    s_waitcnt lgkmcnt(6)
    v_mfma_f32_16x16x32_bf16 v[68:71], v[40:43], v[228:231], v[68:71]
    v_mfma_f32_16x16x32_bf16 v[72:75], v[44:47], v[228:231], v[72:75]
    v_mfma_f32_16x16x32_bf16 v[76:79], v[48:51], v[228:231], v[76:79]
    v_mfma_f32_16x16x32_bf16 v[80:83], v[52:55], v[228:231], v[80:83]
    s_add_u32 m0, s35, 102432
    s_add_u32 s44, s47, 896
    buffer_load_dwordx4 v9, s[24:27], s44 offen lds
    s_waitcnt lgkmcnt(5)
    v_mfma_f32_16x16x32_bf16 v[84:87], v[40:43], v[232:235], v[84:87]
    v_mfma_f32_16x16x32_bf16 v[88:91], v[44:47], v[232:235], v[88:91]
    v_mfma_f32_16x16x32_bf16 v[92:95], v[48:51], v[232:235], v[92:95]
    v_mfma_f32_16x16x32_bf16 v[96:99], v[52:55], v[232:235], v[96:99]
    s_add_u32 m0, s35, 103488
    s_add_u32 s44, s47, 1792
    buffer_load_dwordx4 v9, s[24:27], s44 offen lds
    s_waitcnt lgkmcnt(4)
    v_mfma_f32_16x16x32_bf16 v[100:103], v[40:43], v[236:239], v[100:103]
    v_add_u32 v1, 4294865920, v1
    ds_read_b64_tr_b16 v[12:13], v1 offset:384
    v_mfma_f32_16x16x32_bf16 v[104:107], v[44:47], v[236:239], v[104:107]
    ds_read_b64_tr_b16 v[14:15], v1 offset:896
    v_mfma_f32_16x16x32_bf16 v[108:111], v[48:51], v[236:239], v[108:111]
    ds_read_b64_tr_b16 v[16:17], v1 offset:416
    v_mfma_f32_16x16x32_bf16 v[112:115], v[52:55], v[236:239], v[112:115]
    ds_read_b64_tr_b16 v[18:19], v1 offset:928
    s_add_u32 m0, s35, 104544
    s_add_u32 s44, s47, 2688
    buffer_load_dwordx4 v9, s[24:27], s44 offen lds
    s_waitcnt lgkmcnt(7)
    v_mfma_f32_16x16x32_bf16 v[116:119], v[40:43], v[240:243], v[116:119]
    ds_read_b64_tr_b16 v[20:21], v1 offset:448
    v_mfma_f32_16x16x32_bf16 v[120:123], v[44:47], v[240:243], v[120:123]
    ds_read_b64_tr_b16 v[22:23], v1 offset:960
    v_mfma_f32_16x16x32_bf16 v[124:127], v[48:51], v[240:243], v[124:127]
    ds_read_b64_tr_b16 v[24:25], v1 offset:480
    v_mfma_f32_16x16x32_bf16 v[128:131], v[52:55], v[240:243], v[128:131]
    ds_read_b64_tr_b16 v[26:27], v1 offset:992
    s_waitcnt lgkmcnt(10)
    v_mfma_f32_16x16x32_bf16 v[132:135], v[40:43], v[244:247], v[132:135]
    ds_read_b64_tr_b16 v[28:29], v1 offset:96
    v_mfma_f32_16x16x32_bf16 v[136:139], v[44:47], v[244:247], v[136:139]
    ds_read_b64_tr_b16 v[30:31], v1 offset:608
    v_mfma_f32_16x16x32_bf16 v[140:143], v[48:51], v[244:247], v[140:143]
    ds_read_b64_tr_b16 v[32:33], v1 offset:224
    v_mfma_f32_16x16x32_bf16 v[144:147], v[52:55], v[244:247], v[144:147]
    ds_read_b64_tr_b16 v[34:35], v1 offset:736
    v_mfma_f32_16x16x32_bf16 v[192:195], v[56:59], v[244:247], v[192:195]
    ds_read_b64_tr_b16 v[36:37], v1 offset:352
    v_mfma_f32_16x16x32_bf16 v[196:199], v[60:63], v[244:247], v[196:199]
    ds_read_b64_tr_b16 v[38:39], v1 offset:864
    v_mfma_f32_16x16x32_bf16 v[200:203], v[64:67], v[244:247], v[200:203]
    s_waitcnt lgkmcnt(15)
    v_mfma_f32_16x16x32_bf16 v[148:151], v[40:43], v[248:251], v[148:151]
    v_mfma_f32_16x16x32_bf16 v[152:155], v[44:47], v[248:251], v[152:155]
    v_mfma_f32_16x16x32_bf16 v[156:159], v[48:51], v[248:251], v[156:159]
    v_mfma_f32_16x16x32_bf16 v[160:163], v[52:55], v[248:251], v[160:163]
    v_mfma_f32_16x16x32_bf16 v[204:207], v[56:59], v[248:251], v[204:207]
    v_mfma_f32_16x16x32_bf16 v[208:211], v[60:63], v[248:251], v[208:211]
    v_mfma_f32_16x16x32_bf16 v[212:215], v[64:67], v[248:251], v[212:215]
    s_waitcnt lgkmcnt(14)
    v_mfma_f32_16x16x32_bf16 v[164:167], v[40:43], v[252:255], v[164:167]
    v_mfma_f32_16x16x32_bf16 v[168:171], v[44:47], v[252:255], v[168:171]
    v_mfma_f32_16x16x32_bf16 v[172:175], v[48:51], v[252:255], v[172:175]
    v_mfma_f32_16x16x32_bf16 v[176:179], v[52:55], v[252:255], v[176:179]
    v_mfma_f32_16x16x32_bf16 v[216:219], v[56:59], v[252:255], v[216:219]
    v_mfma_f32_16x16x32_bf16 v[220:223], v[60:63], v[252:255], v[220:223]
    v_mfma_f32_16x16x32_bf16 v[224:227], v[64:67], v[252:255], v[224:227]
    s_waitcnt vmcnt(8)
    s_barrier
    ds_read_b32 v5, v4 offset:0
    ds_read_b128 v[228:231], v2 offset:0
    ds_read_b128 v[232:235], v2 offset:1024
    ds_read_b128 v[236:239], v2 offset:2048
    ds_read_b128 v[240:243], v2 offset:3072
    ds_read_b128 v[244:247], v2 offset:4096
    ds_read_b128 v[248:251], v2 offset:5120
    ds_read_b128 v[252:255], v2 offset:6144
    s_add_u32 s39, s39, 1
    s_add_u32 m0, s35, 135168
    s_add_u32 s44, s47, 114688
    buffer_load_dwordx4 v9, s[24:27], s44 offen lds
    s_add_u32 m0, s35, 136224
    s_add_u32 s44, s47, 115584
    buffer_load_dwordx4 v9, s[24:27], s44 offen lds
    s_waitcnt lgkmcnt(7)
    v_cmp_eq_u32 vcc, s39, v5
    s_cbranch_vccnz L_stub_ob64
L_back_ob64:
    s_waitcnt lgkmcnt(6)
    v_mfma_f32_16x16x32_bf16 v[68:71], v[12:15], v[228:231], v[68:71]
    v_mfma_f32_16x16x32_bf16 v[72:75], v[16:19], v[228:231], v[72:75]
    v_mfma_f32_16x16x32_bf16 v[76:79], v[20:23], v[228:231], v[76:79]
    v_mfma_f32_16x16x32_bf16 v[80:83], v[24:27], v[228:231], v[80:83]
    s_add_u32 m0, s35, 137280
    s_add_u32 s44, s47, 116480
    buffer_load_dwordx4 v9, s[24:27], s44 offen lds
    s_add_u32 m0, s35, 138336
    s_add_u32 s44, s47, 117376
    buffer_load_dwordx4 v9, s[24:27], s44 offen lds
    s_add_u32 s47, s47, 128
    s_cmp_eq_u32 s47, 896
    s_cselect_b32 s47, 0, s47
    s_waitcnt lgkmcnt(5)
    v_mfma_f32_16x16x32_bf16 v[84:87], v[12:15], v[232:235], v[84:87]
    v_mfma_f32_16x16x32_bf16 v[88:91], v[16:19], v[232:235], v[88:91]
    v_mfma_f32_16x16x32_bf16 v[92:95], v[20:23], v[232:235], v[92:95]
    v_mfma_f32_16x16x32_bf16 v[96:99], v[24:27], v[232:235], v[96:99]
    s_add_u32 m0, s35, 84480
    s_add_u32 s44, s47, 0
    buffer_load_dwordx4 v9, s[24:27], s44 offen lds
    s_add_u32 m0, s35, 85536
    s_add_u32 s44, s47, 896
    buffer_load_dwordx4 v9, s[24:27], s44 offen lds
    s_waitcnt lgkmcnt(4)
    v_mfma_f32_16x16x32_bf16 v[100:103], v[12:15], v[236:239], v[100:103]
    v_add_u32 v1, 16896, v1
    ds_read_b64_tr_b16 v[40:41], v1 offset:384
    v_mfma_f32_16x16x32_bf16 v[104:107], v[16:19], v[236:239], v[104:107]
    ds_read_b64_tr_b16 v[42:43], v1 offset:896
    v_mfma_f32_16x16x32_bf16 v[108:111], v[20:23], v[236:239], v[108:111]
    ds_read_b64_tr_b16 v[44:45], v1 offset:416
    v_mfma_f32_16x16x32_bf16 v[112:115], v[24:27], v[236:239], v[112:115]
    ds_read_b64_tr_b16 v[46:47], v1 offset:928
    s_add_u32 m0, s35, 86592
    s_add_u32 s44, s47, 1792
    buffer_load_dwordx4 v9, s[24:27], s44 offen lds
    s_add_u32 m0, s35, 87648
    s_add_u32 s44, s47, 2688
    buffer_load_dwordx4 v9, s[24:27], s44 offen lds
    s_waitcnt lgkmcnt(7)
    v_mfma_f32_16x16x32_bf16 v[116:119], v[12:15], v[240:243], v[116:119]
    ds_read_b64_tr_b16 v[48:49], v1 offset:448
    v_mfma_f32_16x16x32_bf16 v[120:123], v[16:19], v[240:243], v[120:123]
    ds_read_b64_tr_b16 v[50:51], v1 offset:960
    v_mfma_f32_16x16x32_bf16 v[124:127], v[20:23], v[240:243], v[124:127]
    ds_read_b64_tr_b16 v[52:53], v1 offset:480
    v_mfma_f32_16x16x32_bf16 v[128:131], v[24:27], v[240:243], v[128:131]
    ds_read_b64_tr_b16 v[54:55], v1 offset:992
    s_waitcnt lgkmcnt(10)
    v_mfma_f32_16x16x32_bf16 v[132:135], v[12:15], v[244:247], v[132:135]
    ds_read_b64_tr_b16 v[56:57], v1 offset:96
    v_mfma_f32_16x16x32_bf16 v[136:139], v[16:19], v[244:247], v[136:139]
    ds_read_b64_tr_b16 v[58:59], v1 offset:608
    v_mfma_f32_16x16x32_bf16 v[140:143], v[20:23], v[244:247], v[140:143]
    ds_read_b64_tr_b16 v[60:61], v1 offset:224
    v_mfma_f32_16x16x32_bf16 v[144:147], v[24:27], v[244:247], v[144:147]
    ds_read_b64_tr_b16 v[62:63], v1 offset:736
    v_mfma_f32_16x16x32_bf16 v[192:195], v[28:31], v[244:247], v[192:195]
    ds_read_b64_tr_b16 v[64:65], v1 offset:352
    v_mfma_f32_16x16x32_bf16 v[196:199], v[32:35], v[244:247], v[196:199]
    ds_read_b64_tr_b16 v[66:67], v1 offset:864
    v_mfma_f32_16x16x32_bf16 v[200:203], v[36:39], v[244:247], v[200:203]
    s_waitcnt lgkmcnt(15)
    v_mfma_f32_16x16x32_bf16 v[148:151], v[12:15], v[248:251], v[148:151]
    v_mfma_f32_16x16x32_bf16 v[152:155], v[16:19], v[248:251], v[152:155]
    v_mfma_f32_16x16x32_bf16 v[156:159], v[20:23], v[248:251], v[156:159]
    v_mfma_f32_16x16x32_bf16 v[160:163], v[24:27], v[248:251], v[160:163]
    v_mfma_f32_16x16x32_bf16 v[204:207], v[28:31], v[248:251], v[204:207]
    v_mfma_f32_16x16x32_bf16 v[208:211], v[32:35], v[248:251], v[208:211]
    v_mfma_f32_16x16x32_bf16 v[212:215], v[36:39], v[248:251], v[212:215]
    s_waitcnt lgkmcnt(14)
    v_mfma_f32_16x16x32_bf16 v[164:167], v[12:15], v[252:255], v[164:167]
    v_mfma_f32_16x16x32_bf16 v[168:171], v[16:19], v[252:255], v[168:171]
    v_mfma_f32_16x16x32_bf16 v[172:175], v[20:23], v[252:255], v[172:175]
    v_mfma_f32_16x16x32_bf16 v[176:179], v[24:27], v[252:255], v[176:179]
    v_mfma_f32_16x16x32_bf16 v[216:219], v[28:31], v[252:255], v[216:219]
    v_mfma_f32_16x16x32_bf16 v[220:223], v[32:35], v[252:255], v[220:223]
    v_mfma_f32_16x16x32_bf16 v[224:227], v[36:39], v[252:255], v[224:227]
    s_waitcnt lgkmcnt(0)
    s_barrier
    ds_read_b32 v5, v4 offset:128
    ds_read_b128 v[228:231], v2 offset:7168
    ds_read_b128 v[232:235], v2 offset:8192
    ds_read_b128 v[236:239], v2 offset:9216
    ds_read_b128 v[240:243], v2 offset:10240
    ds_read_b128 v[244:247], v2 offset:11264
    ds_read_b128 v[248:251], v2 offset:12288
    ds_read_b128 v[252:255], v2 offset:13312
    s_add_u32 s39, s39, 1
    s_waitcnt lgkmcnt(7)
    v_cmp_eq_u32 vcc, s39, v5
    s_cbranch_vccnz L_stub_ob65
L_back_ob65:
    s_lshl_b32 s42, s33, 11
    v_add_u32 v6, s42, v2
    v_mov_b32 v7, v2
    s_waitcnt lgkmcnt(6)
    v_mfma_f32_16x16x32_bf16 v[68:71], v[40:43], v[228:231], v[68:71]
    v_mfma_f32_16x16x32_bf16 v[72:75], v[44:47], v[228:231], v[72:75]
    v_mfma_f32_16x16x32_bf16 v[76:79], v[48:51], v[228:231], v[76:79]
    v_mfma_f32_16x16x32_bf16 v[80:83], v[52:55], v[228:231], v[80:83]
    s_waitcnt lgkmcnt(5)
    v_mfma_f32_16x16x32_bf16 v[84:87], v[40:43], v[232:235], v[84:87]
    v_mfma_f32_16x16x32_bf16 v[88:91], v[44:47], v[232:235], v[88:91]
    v_mfma_f32_16x16x32_bf16 v[92:95], v[48:51], v[232:235], v[92:95]
    v_mfma_f32_16x16x32_bf16 v[96:99], v[52:55], v[232:235], v[96:99]
    s_waitcnt lgkmcnt(4)
    v_mfma_f32_16x16x32_bf16 v[100:103], v[40:43], v[236:239], v[100:103]
    v_mfma_f32_16x16x32_bf16 v[104:107], v[44:47], v[236:239], v[104:107]
    v_mfma_f32_16x16x32_bf16 v[108:111], v[48:51], v[236:239], v[108:111]
    v_mfma_f32_16x16x32_bf16 v[112:115], v[52:55], v[236:239], v[112:115]
    v_cvt_pk_bf16_f32 v68, v68, v69
    v_cvt_pk_bf16_f32 v69, v70, v71
    v_cvt_pk_bf16_f32 v70, v72, v73
    v_cvt_pk_bf16_f32 v71, v74, v75
    v_cvt_pk_bf16_f32 v76, v76, v77
    v_cvt_pk_bf16_f32 v77, v78, v79
    v_cvt_pk_bf16_f32 v78, v80, v81
    v_cvt_pk_bf16_f32 v79, v82, v83
    ds_write_b128 v6, v[68:71] offset:16896
    ds_write_b128 v6, v[76:79] offset:17920
    v_cvt_pk_bf16_f32 v84, v84, v85
    v_cvt_pk_bf16_f32 v85, v86, v87
    v_cvt_pk_bf16_f32 v86, v88, v89
    v_cvt_pk_bf16_f32 v87, v90, v91
    v_cvt_pk_bf16_f32 v92, v92, v93
    v_cvt_pk_bf16_f32 v93, v94, v95
    v_cvt_pk_bf16_f32 v94, v96, v97
    v_cvt_pk_bf16_f32 v95, v98, v99
    ds_write_b128 v6, v[84:87] offset:25088
    ds_write_b128 v6, v[92:95] offset:26112
    s_waitcnt lgkmcnt(7)
    v_mfma_f32_16x16x32_bf16 v[116:119], v[40:43], v[240:243], v[116:119]
    v_mfma_f32_16x16x32_bf16 v[120:123], v[44:47], v[240:243], v[120:123]
    v_mfma_f32_16x16x32_bf16 v[124:127], v[48:51], v[240:243], v[124:127]
    v_mfma_f32_16x16x32_bf16 v[128:131], v[52:55], v[240:243], v[128:131]
    v_cvt_pk_bf16_f32 v100, v100, v101
    v_cvt_pk_bf16_f32 v101, v102, v103
    v_cvt_pk_bf16_f32 v102, v104, v105
    v_cvt_pk_bf16_f32 v103, v106, v107
    v_cvt_pk_bf16_f32 v108, v108, v109
    v_cvt_pk_bf16_f32 v109, v110, v111
    v_cvt_pk_bf16_f32 v110, v112, v113
    v_cvt_pk_bf16_f32 v111, v114, v115
    ds_write_b128 v6, v[100:103] offset:33792
    ds_write_b128 v6, v[108:111] offset:34816
    s_waitcnt lgkmcnt(8)
    v_mfma_f32_16x16x32_bf16 v[132:135], v[40:43], v[244:247], v[132:135]
    v_mfma_f32_16x16x32_bf16 v[136:139], v[44:47], v[244:247], v[136:139]
    v_mfma_f32_16x16x32_bf16 v[140:143], v[48:51], v[244:247], v[140:143]
    v_mfma_f32_16x16x32_bf16 v[144:147], v[52:55], v[244:247], v[144:147]
    v_mfma_f32_16x16x32_bf16 v[192:195], v[56:59], v[244:247], v[192:195]
    v_mfma_f32_16x16x32_bf16 v[196:199], v[60:63], v[244:247], v[196:199]
    v_mfma_f32_16x16x32_bf16 v[200:203], v[64:67], v[244:247], v[200:203]
    v_cvt_pk_bf16_f32 v116, v116, v117
    v_cvt_pk_bf16_f32 v117, v118, v119
    v_cvt_pk_bf16_f32 v118, v120, v121
    v_cvt_pk_bf16_f32 v119, v122, v123
    v_cvt_pk_bf16_f32 v124, v124, v125
    v_cvt_pk_bf16_f32 v125, v126, v127
    v_cvt_pk_bf16_f32 v126, v128, v129
    v_cvt_pk_bf16_f32 v127, v130, v131
    ds_write_b128 v6, v[116:119] offset:41984
    ds_write_b128 v6, v[124:127] offset:43008
    s_waitcnt lgkmcnt(9)
    v_mfma_f32_16x16x32_bf16 v[148:151], v[40:43], v[248:251], v[148:151]
    v_mfma_f32_16x16x32_bf16 v[152:155], v[44:47], v[248:251], v[152:155]
    v_mfma_f32_16x16x32_bf16 v[156:159], v[48:51], v[248:251], v[156:159]
    v_mfma_f32_16x16x32_bf16 v[160:163], v[52:55], v[248:251], v[160:163]
    v_mfma_f32_16x16x32_bf16 v[204:207], v[56:59], v[248:251], v[204:207]
    v_mfma_f32_16x16x32_bf16 v[208:211], v[60:63], v[248:251], v[208:211]
    v_mfma_f32_16x16x32_bf16 v[212:215], v[64:67], v[248:251], v[212:215]
    v_cvt_pk_bf16_f32 v132, v132, v133
    v_cvt_pk_bf16_f32 v133, v134, v135
    v_cvt_pk_bf16_f32 v134, v136, v137
    v_cvt_pk_bf16_f32 v135, v138, v139
    v_cvt_pk_bf16_f32 v140, v140, v141
    v_cvt_pk_bf16_f32 v141, v142, v143
    v_cvt_pk_bf16_f32 v142, v144, v145
    v_cvt_pk_bf16_f32 v143, v146, v147
    v_cvt_pk_bf16_f32 v192, v192, v193
    v_cvt_pk_bf16_f32 v193, v194, v195
    v_cvt_pk_bf16_f32 v196, v196, v197
    v_cvt_pk_bf16_f32 v197, v198, v199
    v_cvt_pk_bf16_f32 v200, v200, v201
    v_cvt_pk_bf16_f32 v201, v202, v203
    v_add_u32 v6, 118272, v6
    v_add_u32 v7, 118272, v7
    ds_write_b128 v6, v[132:135] offset:0
    ds_write_b128 v6, v[140:143] offset:1024
    ds_write_b64 v7, v[192:193] offset:1032
    ds_write_b64 v7, v[196:197] offset:3080
    ds_write_b64 v7, v[200:201] offset:5128
    s_waitcnt lgkmcnt(13)
    v_mfma_f32_16x16x32_bf16 v[164:167], v[40:43], v[252:255], v[164:167]
    v_mfma_f32_16x16x32_bf16 v[168:171], v[44:47], v[252:255], v[168:171]
    v_mfma_f32_16x16x32_bf16 v[172:175], v[48:51], v[252:255], v[172:175]
    v_mfma_f32_16x16x32_bf16 v[176:179], v[52:55], v[252:255], v[176:179]
    v_mfma_f32_16x16x32_bf16 v[216:219], v[56:59], v[252:255], v[216:219]
    v_mfma_f32_16x16x32_bf16 v[220:223], v[60:63], v[252:255], v[220:223]
    v_mfma_f32_16x16x32_bf16 v[224:227], v[64:67], v[252:255], v[224:227]
    v_cvt_pk_bf16_f32 v148, v148, v149
    v_cvt_pk_bf16_f32 v149, v150, v151
    v_cvt_pk_bf16_f32 v150, v152, v153
    v_cvt_pk_bf16_f32 v151, v154, v155
    v_cvt_pk_bf16_f32 v156, v156, v157
    v_cvt_pk_bf16_f32 v157, v158, v159
    v_cvt_pk_bf16_f32 v158, v160, v161
    v_cvt_pk_bf16_f32 v159, v162, v163
    v_cvt_pk_bf16_f32 v204, v204, v205
    v_cvt_pk_bf16_f32 v205, v206, v207
    v_cvt_pk_bf16_f32 v208, v208, v209
    v_cvt_pk_bf16_f32 v209, v210, v211
    v_cvt_pk_bf16_f32 v212, v212, v213
    v_cvt_pk_bf16_f32 v213, v214, v215
    ds_write_b128 v6, v[148:151] offset:8192
    ds_write_b128 v6, v[156:159] offset:9216
    ds_write_b64 v7, v[204:205] offset:9224
    ds_write_b64 v7, v[208:209] offset:11272
    ds_write_b64 v7, v[212:213] offset:13320
    v_cvt_pk_bf16_f32 v164, v164, v165
    v_cvt_pk_bf16_f32 v165, v166, v167
    v_cvt_pk_bf16_f32 v166, v168, v169
    v_cvt_pk_bf16_f32 v167, v170, v171
    v_cvt_pk_bf16_f32 v172, v172, v173
    v_cvt_pk_bf16_f32 v173, v174, v175
    v_cvt_pk_bf16_f32 v174, v176, v177
    v_cvt_pk_bf16_f32 v175, v178, v179
    v_cvt_pk_bf16_f32 v216, v216, v217
    v_cvt_pk_bf16_f32 v217, v218, v219
    v_cvt_pk_bf16_f32 v220, v220, v221
    v_cvt_pk_bf16_f32 v221, v222, v223
    v_cvt_pk_bf16_f32 v224, v224, v225
    v_cvt_pk_bf16_f32 v225, v226, v227
    ds_write_b128 v6, v[164:167] offset:33792
    ds_write_b128 v6, v[172:175] offset:34816
    ds_write_b64 v7, v[216:217] offset:34824
    ds_write_b64 v7, v[220:221] offset:36872
    ds_write_b64 v7, v[224:225] offset:38920
    s_waitcnt vmcnt(8)
    s_waitcnt lgkmcnt(0)
L_ojoin:
    s_barrier
    v_lshlrev_b32 v3, 4, v0
    v_and_b32 v2, 15, v0
    v_lshlrev_b32 v2, 2, v2
    v_add_u32 v2, 161536, v2
    ds_read_b32 v4, v2 offset:256
    ds_read_b32 v5, v2 offset:320
    ds_read_b32 v6, v2 offset:384
    v_lshrrev_b32 v1, 2, v0
    v_mul_u32_u24 v1, 1056, v1
    v_and_b32 v2, 3, v0
    v_lshl_add_u32 v1, v2, 3, v1
    s_lshl_b32 s42, s33, 5
    v_add_u32 v1, s42, v1
    s_lshl_b32 s42, s32, 11
    v_add_u32 v2, s42, v3
    v_lshlrev_b32 v8, 3, v0
    v_add_u32 v8, s42, v8
    s_mov_b32 s48, s6
    s_setprio 0
    v_add_u32 v1, 50688, v1
    ds_read_b64_tr_b16 v[12:13], v1 offset:0
    ds_read_b64_tr_b16 v[14:15], v1 offset:128
    v_add_u32 v3, 118272, v3
    ds_read_b128 v[72:75], v3 offset:0
    ds_read_b128 v[104:107], v3 offset:8192
    ds_read_b128 v[136:139], v3 offset:33792
    ds_read_b64_tr_b16 v[16:17], v1 offset:256
    ds_read_b64_tr_b16 v[18:19], v1 offset:384
    ds_read_b128 v[76:79], v3 offset:1024
    ds_read_b128 v[108:111], v3 offset:9216
    ds_read_b128 v[140:143], v3 offset:34816
    ds_read_b64_tr_b16 v[20:21], v1 offset:512
    ds_read_b64_tr_b16 v[22:23], v1 offset:640
    ds_read_b64_tr_b16 v[24:25], v1 offset:768
    ds_read_b64_tr_b16 v[26:27], v1 offset:896
    s_waitcnt lgkmcnt(11)
    v_mfma_f32_16x16x32_bf16 v[40:43], v[12:15], v[72:75], 0
    s_add_u32 m0, s35, 0
    s_add_u32 s44, s47, 114688
    buffer_load_dwordx4 v9, s[24:27], s44 offen lds
    s_waitcnt lgkmcnt(10)
    v_mfma_f32_16x16x32_bf16 v[44:47], v[12:15], v[104:107], 0
    s_add_u32 m0, s35, 1056
    s_add_u32 s44, s47, 115584
    buffer_load_dwordx4 v9, s[24:27], s44 offen lds
    s_waitcnt lgkmcnt(9)
    v_mfma_f32_16x16x32_bf16 v[48:51], v[12:15], v[136:139], 0
    ds_read_b128 v[80:83], v3 offset:2048
    ds_read_b128 v[112:115], v3 offset:10240
    ds_read_b128 v[144:147], v3 offset:35840
    v_add_u32 v1, 16896, v1
    ds_read_b64_tr_b16 v[12:13], v1 offset:0
    ds_read_b64_tr_b16 v[14:15], v1 offset:128
    s_add_u32 m0, s35, 2112
    s_add_u32 s44, s47, 116480
    buffer_load_dwordx4 v9, s[24:27], s44 offen lds
    s_waitcnt lgkmcnt(11)
    v_mfma_f32_16x16x32_bf16 v[40:43], v[16:19], v[76:79], v[40:43]
    s_add_u32 m0, s35, 3168
    s_add_u32 s44, s47, 117376
    buffer_load_dwordx4 v9, s[24:27], s44 offen lds
    s_add_u32 s47, s47, 128
    s_cmp_eq_u32 s47, 896
    s_cselect_b32 s47, 0, s47
    s_waitcnt lgkmcnt(10)
    v_mfma_f32_16x16x32_bf16 v[44:47], v[16:19], v[108:111], v[44:47]
    s_waitcnt lgkmcnt(9)
    v_mfma_f32_16x16x32_bf16 v[48:51], v[16:19], v[140:143], v[48:51]
    ds_read_b128 v[84:87], v3 offset:3072
    ds_read_b128 v[116:119], v3 offset:11264
    ds_read_b128 v[148:151], v3 offset:36864
    ds_read_b64_tr_b16 v[16:17], v1 offset:256
    ds_read_b64_tr_b16 v[18:19], v1 offset:384
    s_waitcnt lgkmcnt(9)
    v_mfma_f32_16x16x32_bf16 v[40:43], v[20:23], v[80:83], v[40:43]
    s_waitcnt lgkmcnt(8)
    v_mfma_f32_16x16x32_bf16 v[44:47], v[20:23], v[112:115], v[44:47]
    s_waitcnt lgkmcnt(7)
    v_mfma_f32_16x16x32_bf16 v[48:51], v[20:23], v[144:147], v[48:51]
    ds_read_b128 v[88:91], v3 offset:4096
    ds_read_b128 v[120:123], v3 offset:12288
    ds_read_b128 v[152:155], v3 offset:37888
    ds_read_b64_tr_b16 v[20:21], v1 offset:512
    ds_read_b64_tr_b16 v[22:23], v1 offset:640
    s_waitcnt lgkmcnt(9)
    v_mfma_f32_16x16x32_bf16 v[40:43], v[24:27], v[84:87], v[40:43]
    s_waitcnt lgkmcnt(8)
    v_mfma_f32_16x16x32_bf16 v[44:47], v[24:27], v[116:119], v[44:47]
    s_waitcnt lgkmcnt(7)
    v_mfma_f32_16x16x32_bf16 v[48:51], v[24:27], v[148:151], v[48:51]
    ds_read_b128 v[92:95], v3 offset:5120
    ds_read_b128 v[124:127], v3 offset:13312
    ds_read_b128 v[156:159], v3 offset:38912
    ds_read_b64_tr_b16 v[24:25], v1 offset:768
    ds_read_b64_tr_b16 v[26:27], v1 offset:896
    s_waitcnt lgkmcnt(9)
    v_mfma_f32_16x16x32_bf16 v[40:43], v[12:15], v[88:91], v[40:43]
    s_waitcnt lgkmcnt(8)
    v_mfma_f32_16x16x32_bf16 v[44:47], v[12:15], v[120:123], v[44:47]
    s_waitcnt lgkmcnt(7)
    v_mfma_f32_16x16x32_bf16 v[48:51], v[12:15], v[152:155], v[48:51]
    ds_read_b128 v[96:99], v3 offset:6144
    ds_read_b128 v[128:131], v3 offset:14336
    ds_read_b128 v[160:163], v3 offset:39936
    v_add_u32 v1, 33792, v1
    ds_read_b64_tr_b16 v[12:13], v1 offset:0
    ds_read_b64_tr_b16 v[14:15], v1 offset:128
    s_waitcnt lgkmcnt(9)
    v_mfma_f32_16x16x32_bf16 v[40:43], v[16:19], v[92:95], v[40:43]
    s_waitcnt lgkmcnt(8)
    v_mfma_f32_16x16x32_bf16 v[44:47], v[16:19], v[124:127], v[44:47]
    s_waitcnt lgkmcnt(7)
    v_mfma_f32_16x16x32_bf16 v[48:51], v[16:19], v[156:159], v[48:51]
    ds_read_b128 v[100:103], v3 offset:7168
    ds_read_b128 v[132:135], v3 offset:15360
    ds_read_b128 v[164:167], v3 offset:40960
    ds_read_b64_tr_b16 v[16:17], v1 offset:256
    ds_read_b64_tr_b16 v[18:19], v1 offset:384
    s_waitcnt lgkmcnt(9)
    v_mfma_f32_16x16x32_bf16 v[40:43], v[20:23], v[96:99], v[40:43]
    s_waitcnt lgkmcnt(8)
    v_mfma_f32_16x16x32_bf16 v[44:47], v[20:23], v[128:131], v[44:47]
    s_waitcnt lgkmcnt(7)
    v_mfma_f32_16x16x32_bf16 v[48:51], v[20:23], v[160:163], v[48:51]
    ds_read_b64_tr_b16 v[20:21], v1 offset:512
    ds_read_b64_tr_b16 v[22:23], v1 offset:640
    s_waitcnt lgkmcnt(6)
    v_mfma_f32_16x16x32_bf16 v[40:43], v[24:27], v[100:103], v[40:43]
    s_waitcnt lgkmcnt(5)
    v_mfma_f32_16x16x32_bf16 v[44:47], v[24:27], v[132:135], v[44:47]
    s_waitcnt lgkmcnt(4)
    v_mfma_f32_16x16x32_bf16 v[48:51], v[24:27], v[164:167], v[48:51]
    ds_read_b64_tr_b16 v[24:25], v1 offset:768
    ds_read_b64_tr_b16 v[26:27], v1 offset:896
    s_waitcnt vmcnt(4)
    s_barrier
    v_mfma_f32_16x16x32_bf16 v[56:59], v[12:15], v[72:75], 0
    s_add_u32 m0, s35, 118272
    s_add_u32 s44, s47, 0
    buffer_load_dwordx4 v9, s[24:27], s44 offen lds
    v_mfma_f32_16x16x32_bf16 v[60:63], v[12:15], v[104:107], 0
    s_add_u32 m0, s35, 119328
    s_add_u32 s44, s47, 896
    buffer_load_dwordx4 v9, s[24:27], s44 offen lds
    v_mfma_f32_16x16x32_bf16 v[64:67], v[12:15], v[136:139], 0
    v_add_u32 v1, 33792, v1
    ds_read_b64_tr_b16 v[12:13], v1 offset:0
    ds_read_b64_tr_b16 v[14:15], v1 offset:128
    s_add_u32 m0, s35, 120384
    s_add_u32 s44, s47, 1792
    buffer_load_dwordx4 v9, s[24:27], s44 offen lds
    s_waitcnt lgkmcnt(6)
    v_mfma_f32_16x16x32_bf16 v[56:59], v[16:19], v[76:79], v[56:59]
    s_add_u32 m0, s35, 121440
    s_add_u32 s44, s47, 2688
    buffer_load_dwordx4 v9, s[24:27], s44 offen lds
    v_mul_f32 v40, v4, v40
    v_mul_f32 v41, v4, v41
    v_mul_f32 v42, v4, v42
    v_mul_f32 v43, v4, v43
    v_mfma_f32_16x16x32_bf16 v[60:63], v[16:19], v[108:111], v[60:63]
    s_add_u32 m0, s35, 16896
    s_add_u32 s44, s47, 114688
    buffer_load_dwordx4 v9, s[24:27], s44 offen lds
    v_cvt_pk_bf16_f32 v28, v40, v41
    v_cvt_pk_bf16_f32 v29, v42, v43
    v_mul_f32 v44, v5, v44
    v_mul_f32 v45, v5, v45
    v_mfma_f32_16x16x32_bf16 v[64:67], v[16:19], v[140:143], v[64:67]
    ds_read_b64_tr_b16 v[16:17], v1 offset:256
    ds_read_b64_tr_b16 v[18:19], v1 offset:384
    s_add_u32 m0, s35, 17952
    s_add_u32 s44, s47, 115584
    buffer_load_dwordx4 v9, s[24:27], s44 offen lds
    v_mul_f32 v46, v5, v46
    v_mul_f32 v47, v5, v47
    v_cvt_pk_bf16_f32 v30, v44, v45
    v_cvt_pk_bf16_f32 v31, v46, v47
    s_waitcnt lgkmcnt(6)
    v_mfma_f32_16x16x32_bf16 v[56:59], v[20:23], v[80:83], v[56:59]
    s_add_u32 m0, s35, 19008
    s_add_u32 s44, s47, 116480
    buffer_load_dwordx4 v9, s[24:27], s44 offen lds
    v_mul_f32 v48, v6, v48
    v_mul_f32 v49, v6, v49
    v_mul_f32 v50, v6, v50
    v_mul_f32 v51, v6, v51
    v_mfma_f32_16x16x32_bf16 v[60:63], v[20:23], v[112:115], v[60:63]
    s_add_u32 m0, s35, 20064
    s_add_u32 s44, s47, 117376
    buffer_load_dwordx4 v9, s[24:27], s44 offen lds
    s_add_u32 s47, s47, 128
    s_cmp_eq_u32 s47, 896
    s_cselect_b32 s47, 0, s47
    v_cvt_pk_bf16_f32 v32, v48, v49
    v_cvt_pk_bf16_f32 v33, v50, v51
    v_mov_b32 v36, v32
    v_mov_b32 v37, v33
    v_mfma_f32_16x16x32_bf16 v[64:67], v[20:23], v[144:147], v[64:67]
    ds_read_b64_tr_b16 v[20:21], v1 offset:512
    ds_read_b64_tr_b16 v[22:23], v1 offset:640
    s_add_u32 m0, s35, 33792
    s_add_u32 s44, s47, 0
    buffer_load_dwordx4 v9, s[24:27], s44 offen lds
    s_nop 0
    v_permlane32_swap_b32 v36, v34
    v_permlane32_swap_b32 v37, v35
    s_lshl_b32 s42, s48, 14
    s_add_u32 s48, s48, 1
    buffer_store_dwordx4 v[28:31], v2, s[28:31], s42 offen sc1
    s_mov_b32 exec_hi, 0
    buffer_store_dwordx4 v[32:35], v2, s[28:31], s42 offen offset:1024 sc1
    s_mov_b32 exec_hi, -1
    s_cmp_eq_u32 s48, 7
    s_cselect_b32 s48, 0, s48
    s_waitcnt lgkmcnt(6)
    v_mfma_f32_16x16x32_bf16 v[56:59], v[24:27], v[84:87], v[56:59]
    s_add_u32 m0, s35, 34848
    s_add_u32 s44, s47, 896
    buffer_load_dwordx4 v9, s[24:27], s44 offen lds
    v_mfma_f32_16x16x32_bf16 v[60:63], v[24:27], v[116:119], v[60:63]
    s_add_u32 m0, s35, 35904
    s_add_u32 s44, s47, 1792
    buffer_load_dwordx4 v9, s[24:27], s44 offen lds
    v_mfma_f32_16x16x32_bf16 v[64:67], v[24:27], v[148:151], v[64:67]
    ds_read_b64_tr_b16 v[24:25], v1 offset:768
    ds_read_b64_tr_b16 v[26:27], v1 offset:896
    s_add_u32 m0, s35, 36960
    s_add_u32 s44, s47, 2688
    buffer_load_dwordx4 v9, s[24:27], s44 offen lds
    s_waitcnt lgkmcnt(6)
    v_mfma_f32_16x16x32_bf16 v[56:59], v[12:15], v[88:91], v[56:59]
    s_add_u32 m0, s35, 50688
    s_add_u32 s44, s47, 114688
    buffer_load_dwordx4 v9, s[24:27], s44 offen lds
    v_mfma_f32_16x16x32_bf16 v[60:63], v[12:15], v[120:123], v[60:63]
    s_add_u32 m0, s35, 51744
    s_add_u32 s44, s47, 115584
    buffer_load_dwordx4 v9, s[24:27], s44 offen lds
    v_mfma_f32_16x16x32_bf16 v[64:67], v[12:15], v[152:155], v[64:67]
    v_add_u32 v1, 4294916608, v1
    ds_read_b64_tr_b16 v[12:13], v1 offset:0
    ds_read_b64_tr_b16 v[14:15], v1 offset:128
    s_add_u32 m0, s35, 52800
    s_add_u32 s44, s47, 116480
    buffer_load_dwordx4 v9, s[24:27], s44 offen lds
    s_waitcnt lgkmcnt(6)
    v_mfma_f32_16x16x32_bf16 v[56:59], v[16:19], v[92:95], v[56:59]
    s_add_u32 m0, s35, 53856
    s_add_u32 s44, s47, 117376
    buffer_load_dwordx4 v9, s[24:27], s44 offen lds
    s_add_u32 s47, s47, 128
    s_cmp_eq_u32 s47, 896
    s_cselect_b32 s47, 0, s47
    v_mfma_f32_16x16x32_bf16 v[60:63], v[16:19], v[124:127], v[60:63]
    s_add_u32 m0, s35, 67584
    s_add_u32 s44, s47, 0
    buffer_load_dwordx4 v9, s[24:27], s44 offen lds
    v_mfma_f32_16x16x32_bf16 v[64:67], v[16:19], v[156:159], v[64:67]
    ds_read_b64_tr_b16 v[16:17], v1 offset:256
    ds_read_b64_tr_b16 v[18:19], v1 offset:384
    s_add_u32 m0, s35, 68640
    s_add_u32 s44, s47, 896
    buffer_load_dwordx4 v9, s[24:27], s44 offen lds
    s_waitcnt lgkmcnt(6)
    v_mfma_f32_16x16x32_bf16 v[56:59], v[20:23], v[96:99], v[56:59]
    s_add_u32 m0, s35, 69696
    s_add_u32 s44, s47, 1792
    buffer_load_dwordx4 v9, s[24:27], s44 offen lds
    v_mfma_f32_16x16x32_bf16 v[60:63], v[20:23], v[128:131], v[60:63]
    s_add_u32 m0, s35, 70752
    s_add_u32 s44, s47, 2688
    buffer_load_dwordx4 v9, s[24:27], s44 offen lds
    v_mfma_f32_16x16x32_bf16 v[64:67], v[20:23], v[160:163], v[64:67]
    ds_read_b64_tr_b16 v[20:21], v1 offset:512
    ds_read_b64_tr_b16 v[22:23], v1 offset:640
    s_waitcnt lgkmcnt(6)
    v_mfma_f32_16x16x32_bf16 v[56:59], v[24:27], v[100:103], v[56:59]
    v_mfma_f32_16x16x32_bf16 v[60:63], v[24:27], v[132:135], v[60:63]
    v_mfma_f32_16x16x32_bf16 v[64:67], v[24:27], v[164:167], v[64:67]
    ds_read_b64_tr_b16 v[24:25], v1 offset:768
    ds_read_b64_tr_b16 v[26:27], v1 offset:896
    s_waitcnt vmcnt(18)
    s_barrier
    s_waitcnt lgkmcnt(6)
    v_mfma_f32_16x16x32_bf16 v[40:43], v[12:15], v[72:75], 0
    s_add_u32 m0, s35, 101376
    s_add_u32 s44, s47, 114688
    buffer_load_dwordx4 v9, s[24:27], s44 offen lds
    v_mfma_f32_16x16x32_bf16 v[44:47], v[12:15], v[104:107], 0
    s_add_u32 m0, s35, 102432
    s_add_u32 s44, s47, 115584
    buffer_load_dwordx4 v9, s[24:27], s44 offen lds
    v_mfma_f32_16x16x32_bf16 v[48:51], v[12:15], v[136:139], 0
    v_add_u32 v1, 4294882816, v1
    ds_read_b64_tr_b16 v[12:13], v1 offset:0
    ds_read_b64_tr_b16 v[14:15], v1 offset:128
    s_add_u32 m0, s35, 103488
    s_add_u32 s44, s47, 116480
    buffer_load_dwordx4 v9, s[24:27], s44 offen lds
    s_waitcnt lgkmcnt(6)
    v_mfma_f32_16x16x32_bf16 v[40:43], v[16:19], v[76:79], v[40:43]
    s_add_u32 m0, s35, 104544
    s_add_u32 s44, s47, 117376
    buffer_load_dwordx4 v9, s[24:27], s44 offen lds
    s_add_u32 s47, s47, 128
    s_cmp_eq_u32 s47, 896
    s_cselect_b32 s47, 0, s47
    v_mul_f32 v56, v4, v56
    v_mul_f32 v57, v4, v57
    v_mul_f32 v58, v4, v58
    v_mul_f32 v59, v4, v59
    v_mfma_f32_16x16x32_bf16 v[44:47], v[16:19], v[108:111], v[44:47]
    s_add_u32 m0, s35, 135168
    s_add_u32 s44, s47, 0
    buffer_load_dwordx4 v9, s[24:27], s44 offen lds
    v_cvt_pk_bf16_f32 v28, v56, v57
    v_cvt_pk_bf16_f32 v29, v58, v59
    v_mul_f32 v60, v5, v60
    v_mul_f32 v61, v5, v61
    v_mfma_f32_16x16x32_bf16 v[48:51], v[16:19], v[140:143], v[48:51]
    ds_read_b64_tr_b16 v[16:17], v1 offset:256
    ds_read_b64_tr_b16 v[18:19], v1 offset:384
    s_add_u32 m0, s35, 136224
    s_add_u32 s44, s47, 896
    buffer_load_dwordx4 v9, s[24:27], s44 offen lds
    v_mul_f32 v62, v5, v62
    v_mul_f32 v63, v5, v63
    v_cvt_pk_bf16_f32 v30, v60, v61
    v_cvt_pk_bf16_f32 v31, v62, v63
    s_waitcnt lgkmcnt(6)
    v_mfma_f32_16x16x32_bf16 v[40:43], v[20:23], v[80:83], v[40:43]
    s_add_u32 m0, s35, 137280
    s_add_u32 s44, s47, 1792
    buffer_load_dwordx4 v9, s[24:27], s44 offen lds
    v_mul_f32 v64, v6, v64
    v_mul_f32 v65, v6, v65
    v_mul_f32 v66, v6, v66
    v_mul_f32 v67, v6, v67
    v_mfma_f32_16x16x32_bf16 v[44:47], v[20:23], v[112:115], v[44:47]
    s_add_u32 m0, s35, 138336
    s_add_u32 s44, s47, 2688
    buffer_load_dwordx4 v9, s[24:27], s44 offen lds
    v_cvt_pk_bf16_f32 v32, v64, v65
    v_cvt_pk_bf16_f32 v33, v66, v67
    v_mov_b32 v36, v32
    v_mov_b32 v37, v33
    v_mfma_f32_16x16x32_bf16 v[48:51], v[20:23], v[144:147], v[48:51]
    ds_read_b64_tr_b16 v[20:21], v1 offset:512
    ds_read_b64_tr_b16 v[22:23], v1 offset:640
    s_nop 0
    v_permlane32_swap_b32 v36, v34
    v_permlane32_swap_b32 v37, v35
    s_lshl_b32 s42, s48, 14
    s_add_u32 s48, s48, 1
    buffer_store_dwordx4 v[28:31], v2, s[28:31], s42 offen sc1
    s_mov_b32 exec_hi, 0
    buffer_store_dwordx4 v[32:35], v2, s[28:31], s42 offen offset:1024 sc1
    s_mov_b32 exec_hi, -1
    s_cmp_eq_u32 s48, 7
    s_cselect_b32 s48, 0, s48
    s_waitcnt lgkmcnt(6)
    v_mfma_f32_16x16x32_bf16 v[40:43], v[24:27], v[84:87], v[40:43]
    v_mfma_f32_16x16x32_bf16 v[44:47], v[24:27], v[116:119], v[44:47]
    v_mfma_f32_16x16x32_bf16 v[48:51], v[24:27], v[148:151], v[48:51]
    ds_read_b64_tr_b16 v[24:25], v1 offset:768
    ds_read_b64_tr_b16 v[26:27], v1 offset:896
    s_waitcnt lgkmcnt(6)
    v_mfma_f32_16x16x32_bf16 v[40:43], v[12:15], v[88:91], v[40:43]
    v_mfma_f32_16x16x32_bf16 v[44:47], v[12:15], v[120:123], v[44:47]
    v_mfma_f32_16x16x32_bf16 v[48:51], v[12:15], v[152:155], v[48:51]
    v_add_u32 v1, 118272, v1
    ds_read_b64_tr_b16 v[12:13], v1 offset:0
    ds_read_b64_tr_b16 v[14:15], v1 offset:128
    s_waitcnt lgkmcnt(6)
    v_mfma_f32_16x16x32_bf16 v[40:43], v[16:19], v[92:95], v[40:43]
    v_mfma_f32_16x16x32_bf16 v[44:47], v[16:19], v[124:127], v[44:47]
    v_mfma_f32_16x16x32_bf16 v[48:51], v[16:19], v[156:159], v[48:51]
    ds_read_b64_tr_b16 v[16:17], v1 offset:256
    ds_read_b64_tr_b16 v[18:19], v1 offset:384
    s_waitcnt lgkmcnt(6)
    v_mfma_f32_16x16x32_bf16 v[40:43], v[20:23], v[96:99], v[40:43]
    v_mfma_f32_16x16x32_bf16 v[44:47], v[20:23], v[128:131], v[44:47]
    v_mfma_f32_16x16x32_bf16 v[48:51], v[20:23], v[160:163], v[48:51]
    ds_read_b64_tr_b16 v[20:21], v1 offset:512
    ds_read_b64_tr_b16 v[22:23], v1 offset:640
    s_waitcnt lgkmcnt(6)
    v_mfma_f32_16x16x32_bf16 v[40:43], v[24:27], v[100:103], v[40:43]
    v_mfma_f32_16x16x32_bf16 v[44:47], v[24:27], v[132:135], v[44:47]
    v_mfma_f32_16x16x32_bf16 v[48:51], v[24:27], v[164:167], v[48:51]
    ds_read_b64_tr_b16 v[24:25], v1 offset:768
    ds_read_b64_tr_b16 v[26:27], v1 offset:896
    s_waitcnt vmcnt(18)
    s_barrier
    s_waitcnt lgkmcnt(6)
    v_mfma_f32_16x16x32_bf16 v[56:59], v[12:15], v[72:75], 0
    s_add_u32 m0, s35, 84480
    s_add_u32 s44, s47, 114688
    buffer_load_dwordx4 v9, s[24:27], s44 offen lds
    v_mfma_f32_16x16x32_bf16 v[60:63], v[12:15], v[104:107], 0
    s_add_u32 m0, s35, 85536
    s_add_u32 s44, s47, 115584
    buffer_load_dwordx4 v9, s[24:27], s44 offen lds
    v_mfma_f32_16x16x32_bf16 v[64:67], v[12:15], v[136:139], 0
    v_add_u32 v1, 4294865920, v1
    ds_read_b64_tr_b16 v[12:13], v1 offset:0
    ds_read_b64_tr_b16 v[14:15], v1 offset:128
    s_add_u32 m0, s35, 86592
    s_add_u32 s44, s47, 116480
    buffer_load_dwordx4 v9, s[24:27], s44 offen lds
    s_waitcnt lgkmcnt(6)
    v_mfma_f32_16x16x32_bf16 v[56:59], v[16:19], v[76:79], v[56:59]
    s_add_u32 m0, s35, 87648
    s_add_u32 s44, s47, 117376
    buffer_load_dwordx4 v9, s[24:27], s44 offen lds
    s_add_u32 s47, s47, 128
    s_cmp_eq_u32 s47, 896
    s_cselect_b32 s47, 0, s47
    v_mul_f32 v40, v4, v40
    v_mul_f32 v41, v4, v41
    v_mul_f32 v42, v4, v42
    v_mul_f32 v43, v4, v43
    v_mfma_f32_16x16x32_bf16 v[60:63], v[16:19], v[108:111], v[60:63]
    v_cvt_pk_bf16_f32 v28, v40, v41
    v_cvt_pk_bf16_f32 v29, v42, v43
    v_mul_f32 v44, v5, v44
    v_mul_f32 v45, v5, v45
    v_mfma_f32_16x16x32_bf16 v[64:67], v[16:19], v[140:143], v[64:67]
    ds_read_b64_tr_b16 v[16:17], v1 offset:256
    ds_read_b64_tr_b16 v[18:19], v1 offset:384
    v_mul_f32 v46, v5, v46
    v_mul_f32 v47, v5, v47
    v_cvt_pk_bf16_f32 v30, v44, v45
    v_cvt_pk_bf16_f32 v31, v46, v47
    s_waitcnt lgkmcnt(6)
    v_mfma_f32_16x16x32_bf16 v[56:59], v[20:23], v[80:83], v[56:59]
    v_mul_f32 v48, v6, v48
    v_mul_f32 v49, v6, v49
    v_mul_f32 v50, v6, v50
    v_mul_f32 v51, v6, v51
    v_mfma_f32_16x16x32_bf16 v[60:63], v[20:23], v[112:115], v[60:63]
    v_cvt_pk_bf16_f32 v32, v48, v49
    v_cvt_pk_bf16_f32 v33, v50, v51
    v_mov_b32 v36, v32
    v_mov_b32 v37, v33
    v_mfma_f32_16x16x32_bf16 v[64:67], v[20:23], v[144:147], v[64:67]
    ds_read_b64_tr_b16 v[20:21], v1 offset:512
    ds_read_b64_tr_b16 v[22:23], v1 offset:640
    s_nop 0
    v_permlane32_swap_b32 v36, v34
    v_permlane32_swap_b32 v37, v35
    s_lshl_b32 s42, s48, 14
    s_add_u32 s48, s48, 1
    buffer_store_dwordx4 v[28:31], v2, s[28:31], s42 offen sc1
    s_mov_b32 exec_hi, 0
    buffer_store_dwordx4 v[32:35], v2, s[28:31], s42 offen offset:1024 sc1
    s_mov_b32 exec_hi, -1
    s_cmp_eq_u32 s48, 7
    s_cselect_b32 s48, 0, s48
    s_waitcnt lgkmcnt(6)
    v_mfma_f32_16x16x32_bf16 v[56:59], v[24:27], v[84:87], v[56:59]
    v_mfma_f32_16x16x32_bf16 v[60:63], v[24:27], v[116:119], v[60:63]
    v_mfma_f32_16x16x32_bf16 v[64:67], v[24:27], v[148:151], v[64:67]
    ds_read_b64_tr_b16 v[24:25], v1 offset:768
    ds_read_b64_tr_b16 v[26:27], v1 offset:896
    s_waitcnt lgkmcnt(6)
    v_mfma_f32_16x16x32_bf16 v[56:59], v[12:15], v[88:91], v[56:59]
    v_mfma_f32_16x16x32_bf16 v[60:63], v[12:15], v[120:123], v[60:63]
    v_mfma_f32_16x16x32_bf16 v[64:67], v[12:15], v[152:155], v[64:67]
    v_add_u32 v1, 16896, v1
    ds_read_b64_tr_b16 v[12:13], v1 offset:0
    ds_read_b64_tr_b16 v[14:15], v1 offset:128
    s_waitcnt lgkmcnt(6)
    v_mfma_f32_16x16x32_bf16 v[56:59], v[16:19], v[92:95], v[56:59]
    v_mfma_f32_16x16x32_bf16 v[60:63], v[16:19], v[124:127], v[60:63]
    v_mfma_f32_16x16x32_bf16 v[64:67], v[16:19], v[156:159], v[64:67]
    ds_read_b64_tr_b16 v[16:17], v1 offset:256
    ds_read_b64_tr_b16 v[18:19], v1 offset:384
    s_waitcnt lgkmcnt(6)
    v_mfma_f32_16x16x32_bf16 v[56:59], v[20:23], v[96:99], v[56:59]
    v_mfma_f32_16x16x32_bf16 v[60:63], v[20:23], v[128:131], v[60:63]
    v_mfma_f32_16x16x32_bf16 v[64:67], v[20:23], v[160:163], v[64:67]
    ds_read_b64_tr_b16 v[20:21], v1 offset:512
    ds_read_b64_tr_b16 v[22:23], v1 offset:640
    s_waitcnt lgkmcnt(6)
    v_mfma_f32_16x16x32_bf16 v[56:59], v[24:27], v[100:103], v[56:59]
    v_mfma_f32_16x16x32_bf16 v[60:63], v[24:27], v[132:135], v[60:63]
    v_mfma_f32_16x16x32_bf16 v[64:67], v[24:27], v[164:167], v[64:67]
    ds_read_b64_tr_b16 v[24:25], v1 offset:768
    ds_read_b64_tr_b16 v[26:27], v1 offset:896
    s_waitcnt vmcnt(16)
    s_waitcnt vmcnt(2)
    s_barrier
    s_waitcnt lgkmcnt(6)
    v_mfma_f32_16x16x32_bf16 v[40:43], v[12:15], v[72:75], 0
    v_mfma_f32_16x16x32_bf16 v[44:47], v[12:15], v[104:107], 0
    v_mfma_f32_16x16x32_bf16 v[48:51], v[12:15], v[136:139], 0
    v_add_u32 v1, 16896, v1
    ds_read_b64_tr_b16 v[12:13], v1 offset:0
    ds_read_b64_tr_b16 v[14:15], v1 offset:128
    s_waitcnt lgkmcnt(6)
    v_mfma_f32_16x16x32_bf16 v[40:43], v[16:19], v[76:79], v[40:43]
    v_mul_f32 v56, v4, v56
    v_mul_f32 v57, v4, v57
    v_mul_f32 v58, v4, v58
    v_mul_f32 v59, v4, v59
    v_mfma_f32_16x16x32_bf16 v[44:47], v[16:19], v[108:111], v[44:47]
    v_cvt_pk_bf16_f32 v28, v56, v57
    v_cvt_pk_bf16_f32 v29, v58, v59
    v_mul_f32 v60, v5, v60
    v_mul_f32 v61, v5, v61
    v_mfma_f32_16x16x32_bf16 v[48:51], v[16:19], v[140:143], v[48:51]
    ds_read_b64_tr_b16 v[16:17], v1 offset:256
    ds_read_b64_tr_b16 v[18:19], v1 offset:384
    v_mul_f32 v62, v5, v62
    v_mul_f32 v63, v5, v63
    v_cvt_pk_bf16_f32 v30, v60, v61
    v_cvt_pk_bf16_f32 v31, v62, v63
    s_waitcnt lgkmcnt(6)
    v_mfma_f32_16x16x32_bf16 v[40:43], v[20:23], v[80:83], v[40:43]
    v_mul_f32 v64, v6, v64
    v_mul_f32 v65, v6, v65
    v_mul_f32 v66, v6, v66
    v_mul_f32 v67, v6, v67
    v_mfma_f32_16x16x32_bf16 v[44:47], v[20:23], v[112:115], v[44:47]
    v_cvt_pk_bf16_f32 v32, v64, v65
    v_cvt_pk_bf16_f32 v33, v66, v67
    v_mov_b32 v36, v32
    v_mov_b32 v37, v33
    v_mfma_f32_16x16x32_bf16 v[48:51], v[20:23], v[144:147], v[48:51]
    ds_read_b64_tr_b16 v[20:21], v1 offset:512
    ds_read_b64_tr_b16 v[22:23], v1 offset:640
    s_nop 0
    v_permlane32_swap_b32 v36, v34
    v_permlane32_swap_b32 v37, v35
    s_lshl_b32 s42, s48, 14
    s_add_u32 s48, s48, 1
    buffer_store_dwordx4 v[28:31], v2, s[28:31], s42 offen sc1
    s_mov_b32 exec_hi, 0
    buffer_store_dwordx4 v[32:35], v2, s[28:31], s42 offen offset:1024 sc1
    s_mov_b32 exec_hi, -1
    s_cmp_eq_u32 s48, 7
    s_cselect_b32 s48, 0, s48
    s_waitcnt lgkmcnt(6)
    v_mfma_f32_16x16x32_bf16 v[40:43], v[24:27], v[84:87], v[40:43]
    v_mfma_f32_16x16x32_bf16 v[44:47], v[24:27], v[116:119], v[44:47]
    v_mfma_f32_16x16x32_bf16 v[48:51], v[24:27], v[148:151], v[48:51]
    ds_read_b64_tr_b16 v[24:25], v1 offset:768
    ds_read_b64_tr_b16 v[26:27], v1 offset:896
    s_waitcnt lgkmcnt(6)
    v_mfma_f32_16x16x32_bf16 v[40:43], v[12:15], v[88:91], v[40:43]
    v_mfma_f32_16x16x32_bf16 v[44:47], v[12:15], v[120:123], v[44:47]
    v_mfma_f32_16x16x32_bf16 v[48:51], v[12:15], v[152:155], v[48:51]
    v_add_u32 v1, 16896, v1
    ds_read_b64_tr_b16 v[12:13], v1 offset:0
    ds_read_b64_tr_b16 v[14:15], v1 offset:128
    s_waitcnt lgkmcnt(6)
    v_mfma_f32_16x16x32_bf16 v[40:43], v[16:19], v[92:95], v[40:43]
    v_mfma_f32_16x16x32_bf16 v[44:47], v[16:19], v[124:127], v[44:47]
    v_mfma_f32_16x16x32_bf16 v[48:51], v[16:19], v[156:159], v[48:51]
    ds_read_b64_tr_b16 v[16:17], v1 offset:256
    ds_read_b64_tr_b16 v[18:19], v1 offset:384
    s_waitcnt lgkmcnt(6)
    v_mfma_f32_16x16x32_bf16 v[40:43], v[20:23], v[96:99], v[40:43]
    v_mfma_f32_16x16x32_bf16 v[44:47], v[20:23], v[128:131], v[44:47]
    v_mfma_f32_16x16x32_bf16 v[48:51], v[20:23], v[160:163], v[48:51]
    ds_read_b64_tr_b16 v[20:21], v1 offset:512
    ds_read_b64_tr_b16 v[22:23], v1 offset:640
    s_waitcnt lgkmcnt(6)
    v_mfma_f32_16x16x32_bf16 v[40:43], v[24:27], v[100:103], v[40:43]
    v_mfma_f32_16x16x32_bf16 v[44:47], v[24:27], v[132:135], v[44:47]
    v_mfma_f32_16x16x32_bf16 v[48:51], v[24:27], v[164:167], v[48:51]
    ds_read_b64_tr_b16 v[24:25], v1 offset:768
    ds_read_b64_tr_b16 v[26:27], v1 offset:896
    s_barrier
    s_waitcnt lgkmcnt(6)
    v_mfma_f32_16x16x32_bf16 v[56:59], v[12:15], v[72:75], 0
    v_mfma_f32_16x16x32_bf16 v[60:63], v[12:15], v[104:107], 0
    v_mfma_f32_16x16x32_bf16 v[64:67], v[12:15], v[136:139], 0
    v_add_u32 v1, 33792, v1
    ds_read_b64_tr_b16 v[12:13], v1 offset:0
    ds_read_b64_tr_b16 v[14:15], v1 offset:128
    s_waitcnt lgkmcnt(6)
    v_mfma_f32_16x16x32_bf16 v[56:59], v[16:19], v[76:79], v[56:59]
    v_mul_f32 v40, v4, v40
    v_mul_f32 v41, v4, v41
    v_mul_f32 v42, v4, v42
    v_mul_f32 v43, v4, v43
    v_mfma_f32_16x16x32_bf16 v[60:63], v[16:19], v[108:111], v[60:63]
    v_cvt_pk_bf16_f32 v28, v40, v41
    v_cvt_pk_bf16_f32 v29, v42, v43
    v_mul_f32 v44, v5, v44
    v_mul_f32 v45, v5, v45
    v_mfma_f32_16x16x32_bf16 v[64:67], v[16:19], v[140:143], v[64:67]
    ds_read_b64_tr_b16 v[16:17], v1 offset:256
    ds_read_b64_tr_b16 v[18:19], v1 offset:384
    v_mul_f32 v46, v5, v46
    v_mul_f32 v47, v5, v47
    v_cvt_pk_bf16_f32 v30, v44, v45
    v_cvt_pk_bf16_f32 v31, v46, v47
    s_waitcnt lgkmcnt(6)
    v_mfma_f32_16x16x32_bf16 v[56:59], v[20:23], v[80:83], v[56:59]
    v_mul_f32 v48, v6, v48
    v_mul_f32 v49, v6, v49
    v_mul_f32 v50, v6, v50
    v_mul_f32 v51, v6, v51
    v_mfma_f32_16x16x32_bf16 v[60:63], v[20:23], v[112:115], v[60:63]
    v_cvt_pk_bf16_f32 v32, v48, v49
    v_cvt_pk_bf16_f32 v33, v50, v51
    v_mov_b32 v36, v32
    v_mov_b32 v37, v33
    v_mfma_f32_16x16x32_bf16 v[64:67], v[20:23], v[144:147], v[64:67]
    ds_read_b64_tr_b16 v[20:21], v1 offset:512
    ds_read_b64_tr_b16 v[22:23], v1 offset:640
    s_nop 0
    v_permlane32_swap_b32 v36, v34
    v_permlane32_swap_b32 v37, v35
    s_lshl_b32 s42, s48, 14
    s_add_u32 s48, s48, 1
    buffer_store_dwordx4 v[28:31], v2, s[28:31], s42 offen sc1
    s_mov_b32 exec_hi, 0
    buffer_store_dwordx4 v[32:35], v2, s[28:31], s42 offen offset:1024 sc1
    s_mov_b32 exec_hi, -1
    s_cmp_eq_u32 s48, 7
    s_cselect_b32 s48, 0, s48
    s_waitcnt lgkmcnt(6)
    v_mfma_f32_16x16x32_bf16 v[56:59], v[24:27], v[84:87], v[56:59]
    v_mfma_f32_16x16x32_bf16 v[60:63], v[24:27], v[116:119], v[60:63]
    v_mfma_f32_16x16x32_bf16 v[64:67], v[24:27], v[148:151], v[64:67]
    ds_read_b64_tr_b16 v[24:25], v1 offset:768
    ds_read_b64_tr_b16 v[26:27], v1 offset:896
    s_waitcnt lgkmcnt(6)
    v_mfma_f32_16x16x32_bf16 v[56:59], v[12:15], v[88:91], v[56:59]
    v_mfma_f32_16x16x32_bf16 v[60:63], v[12:15], v[120:123], v[60:63]
    v_mfma_f32_16x16x32_bf16 v[64:67], v[12:15], v[152:155], v[64:67]
    v_add_u32 v1, 33792, v1
    ds_read_b64_tr_b16 v[12:13], v1 offset:0
    ds_read_b64_tr_b16 v[14:15], v1 offset:128
    s_waitcnt lgkmcnt(6)
    v_mfma_f32_16x16x32_bf16 v[56:59], v[16:19], v[92:95], v[56:59]
    v_mfma_f32_16x16x32_bf16 v[60:63], v[16:19], v[124:127], v[60:63]
    v_mfma_f32_16x16x32_bf16 v[64:67], v[16:19], v[156:159], v[64:67]
    ds_read_b64_tr_b16 v[16:17], v1 offset:256
    ds_read_b64_tr_b16 v[18:19], v1 offset:384
    s_waitcnt lgkmcnt(6)
    v_mfma_f32_16x16x32_bf16 v[56:59], v[20:23], v[96:99], v[56:59]
    v_mfma_f32_16x16x32_bf16 v[60:63], v[20:23], v[128:131], v[60:63]
    v_mfma_f32_16x16x32_bf16 v[64:67], v[20:23], v[160:163], v[64:67]
    ds_read_b64_tr_b16 v[20:21], v1 offset:512
    ds_read_b64_tr_b16 v[22:23], v1 offset:640
    s_waitcnt lgkmcnt(6)
    v_mfma_f32_16x16x32_bf16 v[56:59], v[24:27], v[100:103], v[56:59]
    v_mfma_f32_16x16x32_bf16 v[60:63], v[24:27], v[132:135], v[60:63]
    v_mfma_f32_16x16x32_bf16 v[64:67], v[24:27], v[164:167], v[64:67]
    ds_read_b64_tr_b16 v[24:25], v1 offset:768
    ds_read_b64_tr_b16 v[26:27], v1 offset:896
    s_barrier
    s_waitcnt lgkmcnt(6)
    v_mfma_f32_16x16x32_bf16 v[40:43], v[12:15], v[72:75], 0
    v_mfma_f32_16x16x32_bf16 v[44:47], v[12:15], v[104:107], 0
    v_mfma_f32_16x16x32_bf16 v[48:51], v[12:15], v[136:139], 0
    v_add_u32 v1, 4294916608, v1
    ds_read_b64_tr_b16 v[12:13], v1 offset:0
    ds_read_b64_tr_b16 v[14:15], v1 offset:128
    s_waitcnt lgkmcnt(6)
    v_mfma_f32_16x16x32_bf16 v[40:43], v[16:19], v[76:79], v[40:43]
    v_mul_f32 v56, v4, v56
    v_mul_f32 v57, v4, v57
    v_mul_f32 v58, v4, v58
    v_mul_f32 v59, v4, v59
    v_mfma_f32_16x16x32_bf16 v[44:47], v[16:19], v[108:111], v[44:47]
    v_cvt_pk_bf16_f32 v28, v56, v57
    v_cvt_pk_bf16_f32 v29, v58, v59
    v_mul_f32 v60, v5, v60
    v_mul_f32 v61, v5, v61
    v_mfma_f32_16x16x32_bf16 v[48:51], v[16:19], v[140:143], v[48:51]
    ds_read_b64_tr_b16 v[16:17], v1 offset:256
    ds_read_b64_tr_b16 v[18:19], v1 offset:384
    v_mul_f32 v62, v5, v62
    v_mul_f32 v63, v5, v63
    v_cvt_pk_bf16_f32 v30, v60, v61
    v_cvt_pk_bf16_f32 v31, v62, v63
    s_waitcnt lgkmcnt(6)
    v_mfma_f32_16x16x32_bf16 v[40:43], v[20:23], v[80:83], v[40:43]
    v_mul_f32 v64, v6, v64
    v_mul_f32 v65, v6, v65
    v_mul_f32 v66, v6, v66
    v_mul_f32 v67, v6, v67
    v_mfma_f32_16x16x32_bf16 v[44:47], v[20:23], v[112:115], v[44:47]
    v_cvt_pk_bf16_f32 v32, v64, v65
    v_cvt_pk_bf16_f32 v33, v66, v67
    v_mov_b32 v36, v32
    v_mov_b32 v37, v33
    v_mfma_f32_16x16x32_bf16 v[48:51], v[20:23], v[144:147], v[48:51]
    ds_read_b64_tr_b16 v[20:21], v1 offset:512
    ds_read_b64_tr_b16 v[22:23], v1 offset:640
    s_nop 0
    v_permlane32_swap_b32 v36, v34
    v_permlane32_swap_b32 v37, v35
    s_lshl_b32 s42, s48, 14
    s_add_u32 s48, s48, 1
    buffer_store_dwordx4 v[28:31], v2, s[28:31], s42 offen sc1
    s_mov_b32 exec_hi, 0
    buffer_store_dwordx4 v[32:35], v2, s[28:31], s42 offen offset:1024 sc1
    s_mov_b32 exec_hi, -1
    s_cmp_eq_u32 s48, 7
    s_cselect_b32 s48, 0, s48
    s_waitcnt lgkmcnt(6)
    v_mfma_f32_16x16x32_bf16 v[40:43], v[24:27], v[84:87], v[40:43]
    v_mfma_f32_16x16x32_bf16 v[44:47], v[24:27], v[116:119], v[44:47]
    v_mfma_f32_16x16x32_bf16 v[48:51], v[24:27], v[148:151], v[48:51]
    ds_read_b64_tr_b16 v[24:25], v1 offset:768
    ds_read_b64_tr_b16 v[26:27], v1 offset:896
    s_waitcnt lgkmcnt(6)
    v_mfma_f32_16x16x32_bf16 v[40:43], v[12:15], v[88:91], v[40:43]
    v_mfma_f32_16x16x32_bf16 v[44:47], v[12:15], v[120:123], v[44:47]
    v_mfma_f32_16x16x32_bf16 v[48:51], v[12:15], v[152:155], v[48:51]
    s_waitcnt lgkmcnt(4)
    v_mfma_f32_16x16x32_bf16 v[40:43], v[16:19], v[92:95], v[40:43]
    v_mfma_f32_16x16x32_bf16 v[44:47], v[16:19], v[124:127], v[44:47]
    v_mfma_f32_16x16x32_bf16 v[48:51], v[16:19], v[156:159], v[48:51]
    s_waitcnt lgkmcnt(2)
    v_mfma_f32_16x16x32_bf16 v[40:43], v[20:23], v[96:99], v[40:43]
    v_mfma_f32_16x16x32_bf16 v[44:47], v[20:23], v[128:131], v[44:47]
    v_mfma_f32_16x16x32_bf16 v[48:51], v[20:23], v[160:163], v[48:51]
    s_waitcnt lgkmcnt(0)
    v_mfma_f32_16x16x32_bf16 v[40:43], v[24:27], v[100:103], v[40:43]
    v_mfma_f32_16x16x32_bf16 v[44:47], v[24:27], v[132:135], v[44:47]
    v_mfma_f32_16x16x32_bf16 v[48:51], v[24:27], v[164:167], v[48:51]
    s_nop 7
    v_mul_f32 v40, v4, v40
    v_mul_f32 v41, v4, v41
    v_mul_f32 v42, v4, v42
    v_mul_f32 v43, v4, v43
    v_cvt_pk_bf16_f32 v28, v40, v41
    v_cvt_pk_bf16_f32 v29, v42, v43
    v_mul_f32 v44, v5, v44
    v_mul_f32 v45, v5, v45
    v_mul_f32 v46, v5, v46
    v_mul_f32 v47, v5, v47
    v_cvt_pk_bf16_f32 v30, v44, v45
    v_cvt_pk_bf16_f32 v31, v46, v47
    v_mul_f32 v48, v6, v48
    v_mul_f32 v49, v6, v49
    v_mul_f32 v50, v6, v50
    v_mul_f32 v51, v6, v51
    v_cvt_pk_bf16_f32 v32, v48, v49
    v_cvt_pk_bf16_f32 v33, v50, v51
    v_mov_b32 v36, v32
    v_mov_b32 v37, v33
    s_nop 0
    v_permlane32_swap_b32 v36, v34
    v_permlane32_swap_b32 v37, v35
    s_lshl_b32 s42, s48, 14
    s_add_u32 s48, s48, 1
    buffer_store_dwordx4 v[28:31], v2, s[28:31], s42 offen sc1
    s_mov_b32 exec_hi, 0
    buffer_store_dwordx4 v[32:35], v2, s[28:31], s42 offen offset:1024 sc1
    s_mov_b32 exec_hi, -1
    s_cmp_eq_u32 s48, 7
    s_cselect_b32 s48, 0, s48
    s_branch L_final
L_done:
    s_endpgm
L_stub_sa_2:
    s_call_b64 s[54:55], L_rare_sa_q1
    s_branch L_back_sa_2
L_stub_sa_3:
    s_call_b64 s[54:55], L_rare_sa_q0
    s_branch L_back_sa_3
L_stub_sa_4:
    s_call_b64 s[54:55], L_rare_sa_q1
    s_branch L_back_sa_4
L_stub_sa_5:
    s_call_b64 s[54:55], L_rare_sa_q0
    s_branch L_back_sa_5
L_stub_sa_6:
    s_call_b64 s[54:55], L_rare_sa_q1
    s_branch L_back_sa_6
L_stub_sa_7:
    s_call_b64 s[54:55], L_rare_sa_q0
    s_branch L_back_sa_7
L_stub_sa_8:
    s_call_b64 s[54:55], L_rare_sa_q1
    s_branch L_back_sa_8
L_stub_sa_61:
    s_call_b64 s[54:55], L_rare_sa_q0
    s_branch L_back_sa_61
L_stub_sa_62:
    s_call_b64 s[54:55], L_rare_sa_q1
    s_branch L_back_sa_62
L_stub_sa_63:
    s_call_b64 s[54:55], L_rare_sa_q0
    s_branch L_back_sa_63
L_stub_sa_64:
    s_call_b64 s[54:55], L_rare_sa_n1
    s_branch L_back_sa_64
L_stub_sb_2:
    s_call_b64 s[54:55], L_rare_sb_q1
    s_branch L_back_sb_2
L_stub_sb_3:
    s_call_b64 s[54:55], L_rare_sb_q0
    s_branch L_back_sb_3
L_stub_sb_4:
    s_call_b64 s[54:55], L_rare_sb_q1
    s_branch L_back_sb_4
L_stub_sb_5:
    s_call_b64 s[54:55], L_rare_sb_q0
    s_branch L_back_sb_5
L_stub_sb_6:
    s_call_b64 s[54:55], L_rare_sb_q1
    s_branch L_back_sb_6
L_stub_sb_7:
    s_call_b64 s[54:55], L_rare_sb_q0
    s_branch L_back_sb_7
L_stub_sb_8:
    s_call_b64 s[54:55], L_rare_sb_q1
    s_branch L_back_sb_8
L_stub_sb_61:
    s_call_b64 s[54:55], L_rare_sb_q0
    s_branch L_back_sb_61
L_stub_sb_62:
    s_call_b64 s[54:55], L_rare_sb_q1
    s_branch L_back_sb_62
L_stub_sb_63:
    s_call_b64 s[54:55], L_rare_sb_q0
    s_branch L_back_sb_63
L_stub_sb_64:
    s_call_b64 s[54:55], L_rare_sb_n1
    s_branch L_back_sb_64
L_rare_sa_q0:
    v_max3_f32 v9, v80, v81, v82
    v_max3_f32 v9, v9, v83, v84
    v_max3_f32 v9, v9, v85, v86
    v_max_f32 v9, v9, v87
    v_max3_f32 v10, v88, v89, v90
    v_max3_f32 v10, v10, v91, v92
    v_max3_f32 v10, v10, v93, v94
    v_max_f32 v10, v10, v95
    v_mov_b32 v11, v9
    v_mov_b32 v12, v10
    s_nop 1
    v_permlane16_swap_b32 v9, v11
    v_permlane16_swap_b32 v10, v12
    v_max_f32 v9, v9, v11
    v_max_f32 v10, v10, v12
    v_mov_b32 v11, v9
    v_mov_b32 v12, v10
    s_nop 1
    v_permlane32_swap_b32 v9, v11
    v_permlane32_swap_b32 v10, v12
    v_max_f32 v9, v9, v11
    v_max_f32 v10, v10, v12
    v_sub_f32 v9, 0xc0e00000, v9
    v_min_f32 v9, 0, v9
    v_exp_f32 v11, v9
    v_add_f32 v136, v136, v9
    v_add_f32 v137, v137, v9
    v_add_f32 v138, v138, v9
    v_add_f32 v139, v139, v9
    v_add_f32 v80, v80, v9
    v_add_f32 v81, v81, v9
    v_add_f32 v82, v82, v9
    v_add_f32 v83, v83, v9
    v_add_f32 v84, v84, v9
    v_add_f32 v85, v85, v9
    v_add_f32 v86, v86, v9
    v_add_f32 v87, v87, v9
    v_add_f32 v96, v96, v9
    v_add_f32 v97, v97, v9
    v_add_f32 v98, v98, v9
    v_add_f32 v99, v99, v9
    v_add_f32 v100, v100, v9
    v_add_f32 v101, v101, v9
    v_add_f32 v102, v102, v9
    v_add_f32 v103, v103, v9
    v_mul_f32 v6, v6, v11
    ds_write_b32 v3, v11 offset:0
    v_sub_f32 v10, 0xc0e00000, v10
    v_min_f32 v10, 0, v10
    v_exp_f32 v12, v10
    v_add_f32 v140, v140, v10
    v_add_f32 v141, v141, v10
    v_add_f32 v142, v142, v10
    v_add_f32 v143, v143, v10
    v_add_f32 v88, v88, v10
    v_add_f32 v89, v89, v10
    v_add_f32 v90, v90, v10
    v_add_f32 v91, v91, v10
    v_add_f32 v92, v92, v10
    v_add_f32 v93, v93, v10
    v_add_f32 v94, v94, v10
    v_add_f32 v95, v95, v10
    v_add_f32 v104, v104, v10
    v_add_f32 v105, v105, v10
    v_add_f32 v106, v106, v10
    v_add_f32 v107, v107, v10
    v_add_f32 v108, v108, v10
    v_add_f32 v109, v109, v10
    v_add_f32 v110, v110, v10
    v_add_f32 v111, v111, v10
    v_mul_f32 v7, v7, v12
    ds_write_b32 v3, v12 offset:64
    v_exp_f32 v120, v80
    v_exp_f32 v121, v81
    v_exp_f32 v122, v82
    v_exp_f32 v123, v83
    v_cvt_pk_bf16_f32 v112, v120, v121
    v_exp_f32 v124, v84
    v_exp_f32 v125, v85
    v_cvt_pk_bf16_f32 v113, v122, v123
    v_exp_f32 v126, v86
    v_exp_f32 v127, v87
    v_cvt_pk_bf16_f32 v114, v124, v125
    v_exp_f32 v128, v88
    v_exp_f32 v129, v89
    v_cvt_pk_bf16_f32 v115, v126, v127
    v_exp_f32 v130, v90
    v_exp_f32 v131, v91
    v_cvt_pk_bf16_f32 v116, v128, v129
    v_exp_f32 v132, v92
    v_exp_f32 v133, v93
    v_cvt_pk_bf16_f32 v117, v130, v131
    v_exp_f32 v134, v94
    v_exp_f32 v135, v95
    v_cvt_pk_bf16_f32 v118, v132, v133
    v_cvt_pk_bf16_f32 v119, v134, v135
    s_lshl_b32 s42, s33, 3
    s_add_u32 s42, s42, 160256
    v_mov_b32 v9, s42
    v_mov_b32 v13, s39
    ds_write_b32 v9, v13 offset:0
    ds_write_b32 v9, v13 offset:4
    s_waitcnt lgkmcnt(0)
    s_setpc_b64 s[54:55]
L_rare_sa_q1:
    v_max3_f32 v9, v96, v97, v98
    v_max3_f32 v9, v9, v99, v100
    v_max3_f32 v9, v9, v101, v102
    v_max_f32 v9, v9, v103
    v_max3_f32 v10, v104, v105, v106
    v_max3_f32 v10, v10, v107, v108
    v_max3_f32 v10, v10, v109, v110
    v_max_f32 v10, v10, v111
    v_mov_b32 v11, v9
    v_mov_b32 v12, v10
    s_nop 1
    v_permlane16_swap_b32 v9, v11
    v_permlane16_swap_b32 v10, v12
    v_max_f32 v9, v9, v11
    v_max_f32 v10, v10, v12
    v_mov_b32 v11, v9
    v_mov_b32 v12, v10
    s_nop 1
    v_permlane32_swap_b32 v9, v11
    v_permlane32_swap_b32 v10, v12
    v_max_f32 v9, v9, v11
    v_max_f32 v10, v10, v12
    v_sub_f32 v9, 0xc0e00000, v9
    v_min_f32 v9, 0, v9
    v_exp_f32 v11, v9
    v_add_f32 v136, v136, v9
    v_add_f32 v137, v137, v9
    v_add_f32 v138, v138, v9
    v_add_f32 v139, v139, v9
    v_add_f32 v96, v96, v9
    v_add_f32 v97, v97, v9
    v_add_f32 v98, v98, v9
    v_add_f32 v99, v99, v9
    v_add_f32 v100, v100, v9
    v_add_f32 v101, v101, v9
    v_add_f32 v102, v102, v9
    v_add_f32 v103, v103, v9
    v_add_f32 v80, v80, v9
    v_add_f32 v81, v81, v9
    v_add_f32 v82, v82, v9
    v_add_f32 v83, v83, v9
    v_add_f32 v84, v84, v9
    v_add_f32 v85, v85, v9
    v_add_f32 v86, v86, v9
    v_add_f32 v87, v87, v9
    v_mul_f32 v6, v6, v11
    ds_write_b32 v3, v11 offset:448
    v_sub_f32 v10, 0xc0e00000, v10
    v_min_f32 v10, 0, v10
    v_exp_f32 v12, v10
    v_add_f32 v140, v140, v10
    v_add_f32 v141, v141, v10
    v_add_f32 v142, v142, v10
    v_add_f32 v143, v143, v10
    v_add_f32 v104, v104, v10
    v_add_f32 v105, v105, v10
    v_add_f32 v106, v106, v10
    v_add_f32 v107, v107, v10
    v_add_f32 v108, v108, v10
    v_add_f32 v109, v109, v10
    v_add_f32 v110, v110, v10
    v_add_f32 v111, v111, v10
    v_add_f32 v88, v88, v10
    v_add_f32 v89, v89, v10
    v_add_f32 v90, v90, v10
    v_add_f32 v91, v91, v10
    v_add_f32 v92, v92, v10
    v_add_f32 v93, v93, v10
    v_add_f32 v94, v94, v10
    v_add_f32 v95, v95, v10
    v_mul_f32 v7, v7, v12
    ds_write_b32 v3, v12 offset:512
    v_exp_f32 v120, v96
    v_exp_f32 v121, v97
    v_exp_f32 v122, v98
    v_exp_f32 v123, v99
    v_cvt_pk_bf16_f32 v112, v120, v121
    v_exp_f32 v124, v100
    v_exp_f32 v125, v101
    v_cvt_pk_bf16_f32 v113, v122, v123
    v_exp_f32 v126, v102
    v_exp_f32 v127, v103
    v_cvt_pk_bf16_f32 v114, v124, v125
    v_exp_f32 v128, v104
    v_exp_f32 v129, v105
    v_cvt_pk_bf16_f32 v115, v126, v127
    v_exp_f32 v130, v106
    v_exp_f32 v131, v107
    v_cvt_pk_bf16_f32 v116, v128, v129
    v_exp_f32 v132, v108
    v_exp_f32 v133, v109
    v_cvt_pk_bf16_f32 v117, v130, v131
    v_exp_f32 v134, v110
    v_exp_f32 v135, v111
    v_cvt_pk_bf16_f32 v118, v132, v133
    v_cvt_pk_bf16_f32 v119, v134, v135
    s_lshl_b32 s42, s33, 3
    s_add_u32 s42, s42, 160384
    v_mov_b32 v9, s42
    v_mov_b32 v13, s39
    ds_write_b32 v9, v13 offset:0
    ds_write_b32 v9, v13 offset:4
    s_waitcnt lgkmcnt(0)
    s_setpc_b64 s[54:55]
L_rare_sa_n1:
    v_max3_f32 v9, v96, v97, v98
    v_max3_f32 v9, v9, v99, v100
    v_max3_f32 v9, v9, v101, v102
    v_max_f32 v9, v9, v103
    v_max3_f32 v10, v104, v105, v106
    v_max3_f32 v10, v10, v107, v108
    v_max3_f32 v10, v10, v109, v110
    v_max_f32 v10, v10, v111
    v_mov_b32 v11, v9
    v_mov_b32 v12, v10
    s_nop 1
    v_permlane16_swap_b32 v9, v11
    v_permlane16_swap_b32 v10, v12
    v_max_f32 v9, v9, v11
    v_max_f32 v10, v10, v12
    v_mov_b32 v11, v9
    v_mov_b32 v12, v10
    s_nop 1
    v_permlane32_swap_b32 v9, v11
    v_permlane32_swap_b32 v10, v12
    v_max_f32 v9, v9, v11
    v_max_f32 v10, v10, v12
    v_sub_f32 v9, 0xc0e00000, v9
    v_min_f32 v9, 0, v9
    v_exp_f32 v11, v9
    v_add_f32 v136, v136, v9
    v_add_f32 v137, v137, v9
    v_add_f32 v138, v138, v9
    v_add_f32 v139, v139, v9
    v_add_f32 v96, v96, v9
    v_add_f32 v97, v97, v9
    v_add_f32 v98, v98, v9
    v_add_f32 v99, v99, v9
    v_add_f32 v100, v100, v9
    v_add_f32 v101, v101, v9
    v_add_f32 v102, v102, v9
    v_add_f32 v103, v103, v9
    v_mul_f32 v6, v6, v11
    ds_write_b32 v3, v11 offset:448
    v_sub_f32 v10, 0xc0e00000, v10
    v_min_f32 v10, 0, v10
    v_exp_f32 v12, v10
    v_add_f32 v140, v140, v10
    v_add_f32 v141, v141, v10
    v_add_f32 v142, v142, v10
    v_add_f32 v143, v143, v10
    v_add_f32 v104, v104, v10
    v_add_f32 v105, v105, v10
    v_add_f32 v106, v106, v10
    v_add_f32 v107, v107, v10
    v_add_f32 v108, v108, v10
    v_add_f32 v109, v109, v10
    v_add_f32 v110, v110, v10
    v_add_f32 v111, v111, v10
    v_mul_f32 v7, v7, v12
    ds_write_b32 v3, v12 offset:512
    v_exp_f32 v120, v96
    v_exp_f32 v121, v97
    v_exp_f32 v122, v98
    v_exp_f32 v123, v99
    v_cvt_pk_bf16_f32 v112, v120, v121
    v_exp_f32 v124, v100
    v_exp_f32 v125, v101
    v_cvt_pk_bf16_f32 v113, v122, v123
    v_exp_f32 v126, v102
    v_exp_f32 v127, v103
    v_cvt_pk_bf16_f32 v114, v124, v125
    v_exp_f32 v128, v104
    v_exp_f32 v129, v105
    v_cvt_pk_bf16_f32 v115, v126, v127
    v_exp_f32 v130, v106
    v_exp_f32 v131, v107
    v_cvt_pk_bf16_f32 v116, v128, v129
    v_exp_f32 v132, v108
    v_exp_f32 v133, v109
    v_cvt_pk_bf16_f32 v117, v130, v131
    v_exp_f32 v134, v110
    v_exp_f32 v135, v111
    v_cvt_pk_bf16_f32 v118, v132, v133
    v_cvt_pk_bf16_f32 v119, v134, v135
    s_lshl_b32 s42, s33, 3
    s_add_u32 s42, s42, 160384
    v_mov_b32 v9, s42
    v_mov_b32 v13, s39
    ds_write_b32 v9, v13 offset:0
    ds_write_b32 v9, v13 offset:4
    s_waitcnt lgkmcnt(0)
    s_setpc_b64 s[54:55]
L_rare_sb_q0:
    v_max3_f32 v9, v80, v81, v82
    v_max3_f32 v9, v9, v83, v84
    v_max3_f32 v9, v9, v85, v86
    v_max_f32 v9, v9, v87
    v_mov_b32 v11, v9
    s_nop 1
    v_permlane16_swap_b32 v9, v11
    v_max_f32 v9, v9, v11
    v_mov_b32 v11, v9
    s_nop 1
    v_permlane32_swap_b32 v9, v11
    v_max_f32 v9, v9, v11
    v_sub_f32 v9, 0xc0e00000, v9
    v_min_f32 v9, 0, v9
    v_exp_f32 v11, v9
    v_add_f32 v136, v136, v9
    v_add_f32 v137, v137, v9
    v_add_f32 v138, v138, v9
    v_add_f32 v139, v139, v9
    v_add_f32 v80, v80, v9
    v_add_f32 v81, v81, v9
    v_add_f32 v82, v82, v9
    v_add_f32 v83, v83, v9
    v_add_f32 v84, v84, v9
    v_add_f32 v85, v85, v9
    v_add_f32 v86, v86, v9
    v_add_f32 v87, v87, v9
    v_add_f32 v96, v96, v9
    v_add_f32 v97, v97, v9
    v_add_f32 v98, v98, v9
    v_add_f32 v99, v99, v9
    v_add_f32 v100, v100, v9
    v_add_f32 v101, v101, v9
    v_add_f32 v102, v102, v9
    v_add_f32 v103, v103, v9
    v_mul_f32 v6, v6, v11
    ds_write_b32 v3, v11 offset:0
    v_exp_f32 v120, v80
    v_exp_f32 v121, v81
    v_exp_f32 v122, v82
    v_exp_f32 v123, v83
    v_cvt_pk_bf16_f32 v112, v120, v121
    v_exp_f32 v124, v84
    v_exp_f32 v125, v85
    v_cvt_pk_bf16_f32 v113, v122, v123
    v_exp_f32 v126, v86
    v_exp_f32 v127, v87
    v_cvt_pk_bf16_f32 v114, v124, v125
    v_cvt_pk_bf16_f32 v115, v126, v127
    s_lshl_b32 s42, s33, 3
    s_add_u32 s42, s42, 160256
    v_mov_b32 v9, s42
    v_mov_b32 v13, s39
    ds_write_b32 v9, v13 offset:0
    s_waitcnt lgkmcnt(0)
    s_setpc_b64 s[54:55]
L_rare_sb_q1:
    v_max3_f32 v9, v96, v97, v98
    v_max3_f32 v9, v9, v99, v100
    v_max3_f32 v9, v9, v101, v102
    v_max_f32 v9, v9, v103
    v_mov_b32 v11, v9
    s_nop 1
    v_permlane16_swap_b32 v9, v11
    v_max_f32 v9, v9, v11
    v_mov_b32 v11, v9
    s_nop 1
    v_permlane32_swap_b32 v9, v11
    v_max_f32 v9, v9, v11
    v_sub_f32 v9, 0xc0e00000, v9
    v_min_f32 v9, 0, v9
    v_exp_f32 v11, v9
    v_add_f32 v136, v136, v9
    v_add_f32 v137, v137, v9
    v_add_f32 v138, v138, v9
    v_add_f32 v139, v139, v9
    v_add_f32 v96, v96, v9
    v_add_f32 v97, v97, v9
    v_add_f32 v98, v98, v9
    v_add_f32 v99, v99, v9
    v_add_f32 v100, v100, v9
    v_add_f32 v101, v101, v9
    v_add_f32 v102, v102, v9
    v_add_f32 v103, v103, v9
    v_add_f32 v80, v80, v9
    v_add_f32 v81, v81, v9
    v_add_f32 v82, v82, v9
    v_add_f32 v83, v83, v9
    v_add_f32 v84, v84, v9
    v_add_f32 v85, v85, v9
    v_add_f32 v86, v86, v9
    v_add_f32 v87, v87, v9
    v_mul_f32 v6, v6, v11
    ds_write_b32 v3, v11 offset:448
    v_exp_f32 v120, v96
    v_exp_f32 v121, v97
    v_exp_f32 v122, v98
    v_exp_f32 v123, v99
    v_cvt_pk_bf16_f32 v112, v120, v121
    v_exp_f32 v124, v100
    v_exp_f32 v125, v101
    v_cvt_pk_bf16_f32 v113, v122, v123
    v_exp_f32 v126, v102
    v_exp_f32 v127, v103
    v_cvt_pk_bf16_f32 v114, v124, v125
    v_cvt_pk_bf16_f32 v115, v126, v127
    s_lshl_b32 s42, s33, 3
    s_add_u32 s42, s42, 160384
    v_mov_b32 v9, s42
    v_mov_b32 v13, s39
    ds_write_b32 v9, v13 offset:0
    s_waitcnt lgkmcnt(0)
    s_setpc_b64 s[54:55]
L_rare_sb_n1:
    v_max3_f32 v9, v96, v97, v98
    v_max3_f32 v9, v9, v99, v100
    v_max3_f32 v9, v9, v101, v102
    v_max_f32 v9, v9, v103
    v_mov_b32 v11, v9
    s_nop 1
    v_permlane16_swap_b32 v9, v11
    v_max_f32 v9, v9, v11
    v_mov_b32 v11, v9
    s_nop 1
    v_permlane32_swap_b32 v9, v11
    v_max_f32 v9, v9, v11
    v_sub_f32 v9, 0xc0e00000, v9
    v_min_f32 v9, 0, v9
    v_exp_f32 v11, v9
    v_add_f32 v136, v136, v9
    v_add_f32 v137, v137, v9
    v_add_f32 v138, v138, v9
    v_add_f32 v139, v139, v9
    v_add_f32 v96, v96, v9
    v_add_f32 v97, v97, v9
    v_add_f32 v98, v98, v9
    v_add_f32 v99, v99, v9
    v_add_f32 v100, v100, v9
    v_add_f32 v101, v101, v9
    v_add_f32 v102, v102, v9
    v_add_f32 v103, v103, v9
    v_mul_f32 v6, v6, v11
    ds_write_b32 v3, v11 offset:448
    v_exp_f32 v120, v96
    v_exp_f32 v121, v97
    v_exp_f32 v122, v98
    v_exp_f32 v123, v99
    v_cvt_pk_bf16_f32 v112, v120, v121
    v_exp_f32 v124, v100
    v_exp_f32 v125, v101
    v_cvt_pk_bf16_f32 v113, v122, v123
    v_exp_f32 v126, v102
    v_exp_f32 v127, v103
    v_cvt_pk_bf16_f32 v114, v124, v125
    v_cvt_pk_bf16_f32 v115, v126, v127
    s_lshl_b32 s42, s33, 3
    s_add_u32 s42, s42, 160384
    v_mov_b32 v9, s42
    v_mov_b32 v13, s39
    ds_write_b32 v9, v13 offset:0
    s_waitcnt lgkmcnt(0)
    s_setpc_b64 s[54:55]
L_stub_oa2:
    s_call_b64 s[54:55], L_rare_oa_0
    s_branch L_back_oa2
L_stub_oa3:
    s_call_b64 s[54:55], L_rare_oa_1
    s_branch L_back_oa3
L_stub_oa4:
    s_call_b64 s[54:55], L_rare_oa_0
    s_branch L_back_oa4
L_stub_oa5:
    s_call_b64 s[54:55], L_rare_oa_1
    s_branch L_back_oa5
L_stub_oa6:
    s_call_b64 s[54:55], L_rare_oa_0
    s_branch L_back_oa6
L_stub_oa7:
    s_call_b64 s[54:55], L_rare_oa_1
    s_branch L_back_oa7
L_stub_oa8:
    s_call_b64 s[54:55], L_rare_oa_0
    s_branch L_back_oa8
L_stub_oa61:
    s_call_b64 s[54:55], L_rare_oa_1
    s_branch L_back_oa61
L_stub_oa62:
    s_call_b64 s[54:55], L_rare_oa_0
    s_branch L_back_oa62
L_stub_oa63:
    s_call_b64 s[54:55], L_rare_oa_1
    s_branch L_back_oa63
L_stub_oa64:
    s_call_b64 s[54:55], L_rare_oa_0
    s_branch L_back_oa64
L_stub_oa65:
    s_call_b64 s[54:55], L_rare_oa_1
    s_branch L_back_oa65
L_stub_ob2:
    s_call_b64 s[54:55], L_rare_ob_0
    s_branch L_back_ob2
L_stub_ob3:
    s_call_b64 s[54:55], L_rare_ob_1
    s_branch L_back_ob3
L_stub_ob4:
    s_call_b64 s[54:55], L_rare_ob_0
    s_branch L_back_ob4
L_stub_ob5:
    s_call_b64 s[54:55], L_rare_ob_1
    s_branch L_back_ob5
L_stub_ob6:
    s_call_b64 s[54:55], L_rare_ob_0
    s_branch L_back_ob6
L_stub_ob7:
    s_call_b64 s[54:55], L_rare_ob_1
    s_branch L_back_ob7
L_stub_ob8:
    s_call_b64 s[54:55], L_rare_ob_0
    s_branch L_back_ob8
L_stub_ob61:
    s_call_b64 s[54:55], L_rare_ob_1
    s_branch L_back_ob61
L_stub_ob62:
    s_call_b64 s[54:55], L_rare_ob_0
    s_branch L_back_ob62
L_stub_ob63:
    s_call_b64 s[54:55], L_rare_ob_1
    s_branch L_back_ob63
L_stub_ob64:
    s_call_b64 s[54:55], L_rare_ob_0
    s_branch L_back_ob64
L_stub_ob65:
    s_call_b64 s[54:55], L_rare_ob_1
    s_branch L_back_ob65
L_rare_oa_0:
    s_nop 7
    s_mov_b32 s42, vcc_lo
    v_and_b32 v6, 15, v0
    v_lshlrev_b32 v6, 2, v6
    v_add_u32 v6, 160512, v6
    s_bitcmp1_b32 s42, 0
    s_cbranch_scc0 L_rare_oa_0_0
    ds_read_b32 v5, v6 offset:0
    s_waitcnt lgkmcnt(0)
    v_mul_f32 v68, v5, v68
    v_mul_f32 v69, v5, v69
    v_mul_f32 v70, v5, v70
    v_mul_f32 v71, v5, v71
    v_mul_f32 v72, v5, v72
    v_mul_f32 v73, v5, v73
    v_mul_f32 v74, v5, v74
    v_mul_f32 v75, v5, v75
    v_mul_f32 v76, v5, v76
    v_mul_f32 v77, v5, v77
    v_mul_f32 v78, v5, v78
    v_mul_f32 v79, v5, v79
    v_mul_f32 v80, v5, v80
    v_mul_f32 v81, v5, v81
    v_mul_f32 v82, v5, v82
    v_mul_f32 v83, v5, v83
L_rare_oa_0_0:
    s_bitcmp1_b32 s42, 1
    s_cbranch_scc0 L_rare_oa_0_1
    ds_read_b32 v5, v6 offset:64
    s_waitcnt lgkmcnt(0)
    v_mul_f32 v84, v5, v84
    v_mul_f32 v85, v5, v85
    v_mul_f32 v86, v5, v86
    v_mul_f32 v87, v5, v87
    v_mul_f32 v88, v5, v88
    v_mul_f32 v89, v5, v89
    v_mul_f32 v90, v5, v90
    v_mul_f32 v91, v5, v91
    v_mul_f32 v92, v5, v92
    v_mul_f32 v93, v5, v93
    v_mul_f32 v94, v5, v94
    v_mul_f32 v95, v5, v95
    v_mul_f32 v96, v5, v96
    v_mul_f32 v97, v5, v97
    v_mul_f32 v98, v5, v98
    v_mul_f32 v99, v5, v99
L_rare_oa_0_1:
    s_bitcmp1_b32 s42, 2
    s_cbranch_scc0 L_rare_oa_0_2
    ds_read_b32 v5, v6 offset:128
    s_waitcnt lgkmcnt(0)
    v_mul_f32 v100, v5, v100
    v_mul_f32 v101, v5, v101
    v_mul_f32 v102, v5, v102
    v_mul_f32 v103, v5, v103
    v_mul_f32 v104, v5, v104
    v_mul_f32 v105, v5, v105
    v_mul_f32 v106, v5, v106
    v_mul_f32 v107, v5, v107
    v_mul_f32 v108, v5, v108
    v_mul_f32 v109, v5, v109
    v_mul_f32 v110, v5, v110
    v_mul_f32 v111, v5, v111
    v_mul_f32 v112, v5, v112
    v_mul_f32 v113, v5, v113
    v_mul_f32 v114, v5, v114
    v_mul_f32 v115, v5, v115
L_rare_oa_0_2:
    s_bitcmp1_b32 s42, 3
    s_cbranch_scc0 L_rare_oa_0_3
    ds_read_b32 v5, v6 offset:192
    s_waitcnt lgkmcnt(0)
    v_mul_f32 v116, v5, v116
    v_mul_f32 v117, v5, v117
    v_mul_f32 v118, v5, v118
    v_mul_f32 v119, v5, v119
    v_mul_f32 v120, v5, v120
    v_mul_f32 v121, v5, v121
    v_mul_f32 v122, v5, v122
    v_mul_f32 v123, v5, v123
    v_mul_f32 v124, v5, v124
    v_mul_f32 v125, v5, v125
    v_mul_f32 v126, v5, v126
    v_mul_f32 v127, v5, v127
    v_mul_f32 v128, v5, v128
    v_mul_f32 v129, v5, v129
    v_mul_f32 v130, v5, v130
    v_mul_f32 v131, v5, v131
L_rare_oa_0_3:
    s_bitcmp1_b32 s42, 4
    s_cbranch_scc0 L_rare_oa_0_4
    ds_read_b32 v5, v6 offset:256
    s_waitcnt lgkmcnt(0)
    v_mul_f32 v132, v5, v132
    v_mul_f32 v133, v5, v133
    v_mul_f32 v134, v5, v134
    v_mul_f32 v135, v5, v135
    v_mul_f32 v136, v5, v136
    v_mul_f32 v137, v5, v137
    v_mul_f32 v138, v5, v138
    v_mul_f32 v139, v5, v139
    v_mul_f32 v140, v5, v140
    v_mul_f32 v141, v5, v141
    v_mul_f32 v142, v5, v142
    v_mul_f32 v143, v5, v143
L_rare_oa_0_4:
    s_bitcmp1_b32 s42, 5
    s_cbranch_scc0 L_rare_oa_0_5
    ds_read_b32 v5, v6 offset:320
    s_waitcnt lgkmcnt(0)
    v_mul_f32 v148, v5, v148
    v_mul_f32 v149, v5, v149
    v_mul_f32 v150, v5, v150
    v_mul_f32 v151, v5, v151
    v_mul_f32 v152, v5, v152
    v_mul_f32 v153, v5, v153
    v_mul_f32 v154, v5, v154
    v_mul_f32 v155, v5, v155
    v_mul_f32 v156, v5, v156
    v_mul_f32 v157, v5, v157
    v_mul_f32 v158, v5, v158
    v_mul_f32 v159, v5, v159
L_rare_oa_0_5:
    s_bitcmp1_b32 s42, 6
    s_cbranch_scc0 L_rare_oa_0_6
    ds_read_b32 v5, v6 offset:384
    s_waitcnt lgkmcnt(0)
    v_mul_f32 v164, v5, v164
    v_mul_f32 v165, v5, v165
    v_mul_f32 v166, v5, v166
    v_mul_f32 v167, v5, v167
    v_mul_f32 v168, v5, v168
    v_mul_f32 v169, v5, v169
    v_mul_f32 v170, v5, v170
    v_mul_f32 v171, v5, v171
    v_mul_f32 v172, v5, v172
    v_mul_f32 v173, v5, v173
    v_mul_f32 v174, v5, v174
    v_mul_f32 v175, v5, v175
L_rare_oa_0_6:
    s_nop 1
    s_setpc_b64 s[54:55]
L_rare_oa_1:
    s_nop 7
    s_mov_b32 s42, vcc_lo
    v_and_b32 v6, 15, v0
    v_lshlrev_b32 v6, 2, v6
    v_add_u32 v6, 160960, v6
    s_bitcmp1_b32 s42, 0
    s_cbranch_scc0 L_rare_oa_1_0
    ds_read_b32 v5, v6 offset:0
    s_waitcnt lgkmcnt(0)
    v_mul_f32 v68, v5, v68
    v_mul_f32 v69, v5, v69
    v_mul_f32 v70, v5, v70
    v_mul_f32 v71, v5, v71
    v_mul_f32 v72, v5, v72
    v_mul_f32 v73, v5, v73
    v_mul_f32 v74, v5, v74
    v_mul_f32 v75, v5, v75
    v_mul_f32 v76, v5, v76
    v_mul_f32 v77, v5, v77
    v_mul_f32 v78, v5, v78
    v_mul_f32 v79, v5, v79
    v_mul_f32 v80, v5, v80
    v_mul_f32 v81, v5, v81
    v_mul_f32 v82, v5, v82
    v_mul_f32 v83, v5, v83
L_rare_oa_1_0:
    s_bitcmp1_b32 s42, 1
    s_cbranch_scc0 L_rare_oa_1_1
    ds_read_b32 v5, v6 offset:64
    s_waitcnt lgkmcnt(0)
    v_mul_f32 v84, v5, v84
    v_mul_f32 v85, v5, v85
    v_mul_f32 v86, v5, v86
    v_mul_f32 v87, v5, v87
    v_mul_f32 v88, v5, v88
    v_mul_f32 v89, v5, v89
    v_mul_f32 v90, v5, v90
    v_mul_f32 v91, v5, v91
    v_mul_f32 v92, v5, v92
    v_mul_f32 v93, v5, v93
    v_mul_f32 v94, v5, v94
    v_mul_f32 v95, v5, v95
    v_mul_f32 v96, v5, v96
    v_mul_f32 v97, v5, v97
    v_mul_f32 v98, v5, v98
    v_mul_f32 v99, v5, v99
L_rare_oa_1_1:
    s_bitcmp1_b32 s42, 2
    s_cbranch_scc0 L_rare_oa_1_2
    ds_read_b32 v5, v6 offset:128
    s_waitcnt lgkmcnt(0)
    v_mul_f32 v100, v5, v100
    v_mul_f32 v101, v5, v101
    v_mul_f32 v102, v5, v102
    v_mul_f32 v103, v5, v103
    v_mul_f32 v104, v5, v104
    v_mul_f32 v105, v5, v105
    v_mul_f32 v106, v5, v106
    v_mul_f32 v107, v5, v107
    v_mul_f32 v108, v5, v108
    v_mul_f32 v109, v5, v109
    v_mul_f32 v110, v5, v110
    v_mul_f32 v111, v5, v111
    v_mul_f32 v112, v5, v112
    v_mul_f32 v113, v5, v113
    v_mul_f32 v114, v5, v114
    v_mul_f32 v115, v5, v115
L_rare_oa_1_2:
    s_bitcmp1_b32 s42, 3
    s_cbranch_scc0 L_rare_oa_1_3
    ds_read_b32 v5, v6 offset:192
    s_waitcnt lgkmcnt(0)
    v_mul_f32 v116, v5, v116
    v_mul_f32 v117, v5, v117
    v_mul_f32 v118, v5, v118
    v_mul_f32 v119, v5, v119
    v_mul_f32 v120, v5, v120
    v_mul_f32 v121, v5, v121
    v_mul_f32 v122, v5, v122
    v_mul_f32 v123, v5, v123
    v_mul_f32 v124, v5, v124
    v_mul_f32 v125, v5, v125
    v_mul_f32 v126, v5, v126
    v_mul_f32 v127, v5, v127
    v_mul_f32 v128, v5, v128
    v_mul_f32 v129, v5, v129
    v_mul_f32 v130, v5, v130
    v_mul_f32 v131, v5, v131
L_rare_oa_1_3:
    s_bitcmp1_b32 s42, 4
    s_cbranch_scc0 L_rare_oa_1_4
    ds_read_b32 v5, v6 offset:256
    s_waitcnt lgkmcnt(0)
    v_mul_f32 v132, v5, v132
    v_mul_f32 v133, v5, v133
    v_mul_f32 v134, v5, v134
    v_mul_f32 v135, v5, v135
    v_mul_f32 v136, v5, v136
    v_mul_f32 v137, v5, v137
    v_mul_f32 v138, v5, v138
    v_mul_f32 v139, v5, v139
    v_mul_f32 v140, v5, v140
    v_mul_f32 v141, v5, v141
    v_mul_f32 v142, v5, v142
    v_mul_f32 v143, v5, v143
L_rare_oa_1_4:
    s_bitcmp1_b32 s42, 5
    s_cbranch_scc0 L_rare_oa_1_5
    ds_read_b32 v5, v6 offset:320
    s_waitcnt lgkmcnt(0)
    v_mul_f32 v148, v5, v148
    v_mul_f32 v149, v5, v149
    v_mul_f32 v150, v5, v150
    v_mul_f32 v151, v5, v151
    v_mul_f32 v152, v5, v152
    v_mul_f32 v153, v5, v153
    v_mul_f32 v154, v5, v154
    v_mul_f32 v155, v5, v155
    v_mul_f32 v156, v5, v156
    v_mul_f32 v157, v5, v157
    v_mul_f32 v158, v5, v158
    v_mul_f32 v159, v5, v159
L_rare_oa_1_5:
    s_bitcmp1_b32 s42, 6
    s_cbranch_scc0 L_rare_oa_1_6
    ds_read_b32 v5, v6 offset:384
    s_waitcnt lgkmcnt(0)
    v_mul_f32 v164, v5, v164
    v_mul_f32 v165, v5, v165
    v_mul_f32 v166, v5, v166
    v_mul_f32 v167, v5, v167
    v_mul_f32 v168, v5, v168
    v_mul_f32 v169, v5, v169
    v_mul_f32 v170, v5, v170
    v_mul_f32 v171, v5, v171
    v_mul_f32 v172, v5, v172
    v_mul_f32 v173, v5, v173
    v_mul_f32 v174, v5, v174
    v_mul_f32 v175, v5, v175
L_rare_oa_1_6:
    s_nop 1
    s_setpc_b64 s[54:55]
L_rare_ob_0:
    s_nop 7
    s_mov_b32 s42, vcc_lo
    v_and_b32 v6, 15, v0
    v_lshlrev_b32 v6, 2, v6
    v_add_u32 v6, 160512, v6
    s_bitcmp1_b32 s42, 0
    s_cbranch_scc0 L_rare_ob_0_0
    ds_read_b32 v5, v6 offset:0
    s_waitcnt lgkmcnt(0)
    v_mul_f32 v68, v5, v68
    v_mul_f32 v69, v5, v69
    v_mul_f32 v70, v5, v70
    v_mul_f32 v71, v5, v71
    v_mul_f32 v72, v5, v72
    v_mul_f32 v73, v5, v73
    v_mul_f32 v74, v5, v74
    v_mul_f32 v75, v5, v75
    v_mul_f32 v76, v5, v76
    v_mul_f32 v77, v5, v77
    v_mul_f32 v78, v5, v78
    v_mul_f32 v79, v5, v79
    v_mul_f32 v80, v5, v80
    v_mul_f32 v81, v5, v81
    v_mul_f32 v82, v5, v82
    v_mul_f32 v83, v5, v83
L_rare_ob_0_0:
    s_bitcmp1_b32 s42, 1
    s_cbranch_scc0 L_rare_ob_0_1
    ds_read_b32 v5, v6 offset:64
    s_waitcnt lgkmcnt(0)
    v_mul_f32 v84, v5, v84
    v_mul_f32 v85, v5, v85
    v_mul_f32 v86, v5, v86
    v_mul_f32 v87, v5, v87
    v_mul_f32 v88, v5, v88
    v_mul_f32 v89, v5, v89
    v_mul_f32 v90, v5, v90
    v_mul_f32 v91, v5, v91
    v_mul_f32 v92, v5, v92
    v_mul_f32 v93, v5, v93
    v_mul_f32 v94, v5, v94
    v_mul_f32 v95, v5, v95
    v_mul_f32 v96, v5, v96
    v_mul_f32 v97, v5, v97
    v_mul_f32 v98, v5, v98
    v_mul_f32 v99, v5, v99
L_rare_ob_0_1:
    s_bitcmp1_b32 s42, 2
    s_cbranch_scc0 L_rare_ob_0_2
    ds_read_b32 v5, v6 offset:128
    s_waitcnt lgkmcnt(0)
    v_mul_f32 v100, v5, v100
    v_mul_f32 v101, v5, v101
    v_mul_f32 v102, v5, v102
    v_mul_f32 v103, v5, v103
    v_mul_f32 v104, v5, v104
    v_mul_f32 v105, v5, v105
    v_mul_f32 v106, v5, v106
    v_mul_f32 v107, v5, v107
    v_mul_f32 v108, v5, v108
    v_mul_f32 v109, v5, v109
    v_mul_f32 v110, v5, v110
    v_mul_f32 v111, v5, v111
    v_mul_f32 v112, v5, v112
    v_mul_f32 v113, v5, v113
    v_mul_f32 v114, v5, v114
    v_mul_f32 v115, v5, v115
L_rare_ob_0_2:
    s_bitcmp1_b32 s42, 3
    s_cbranch_scc0 L_rare_ob_0_3
    ds_read_b32 v5, v6 offset:192
    s_waitcnt lgkmcnt(0)
    v_mul_f32 v116, v5, v116
    v_mul_f32 v117, v5, v117
    v_mul_f32 v118, v5, v118
    v_mul_f32 v119, v5, v119
    v_mul_f32 v120, v5, v120
    v_mul_f32 v121, v5, v121
    v_mul_f32 v122, v5, v122
    v_mul_f32 v123, v5, v123
    v_mul_f32 v124, v5, v124
    v_mul_f32 v125, v5, v125
    v_mul_f32 v126, v5, v126
    v_mul_f32 v127, v5, v127
    v_mul_f32 v128, v5, v128
    v_mul_f32 v129, v5, v129
    v_mul_f32 v130, v5, v130
    v_mul_f32 v131, v5, v131
L_rare_ob_0_3:
    s_bitcmp1_b32 s42, 4
    s_cbranch_scc0 L_rare_ob_0_4
    ds_read_b32 v5, v6 offset:256
    s_waitcnt lgkmcnt(0)
    v_mul_f32 v132, v5, v132
    v_mul_f32 v133, v5, v133
    v_mul_f32 v134, v5, v134
    v_mul_f32 v135, v5, v135
    v_mul_f32 v136, v5, v136
    v_mul_f32 v137, v5, v137
    v_mul_f32 v138, v5, v138
    v_mul_f32 v139, v5, v139
    v_mul_f32 v140, v5, v140
    v_mul_f32 v141, v5, v141
    v_mul_f32 v142, v5, v142
    v_mul_f32 v143, v5, v143
    v_mul_f32 v144, v5, v144
    v_mul_f32 v145, v5, v145
    v_mul_f32 v146, v5, v146
    v_mul_f32 v147, v5, v147
    v_mul_f32 v192, v5, v192
    v_mul_f32 v193, v5, v193
    v_mul_f32 v194, v5, v194
    v_mul_f32 v195, v5, v195
    v_mul_f32 v196, v5, v196
    v_mul_f32 v197, v5, v197
    v_mul_f32 v198, v5, v198
    v_mul_f32 v199, v5, v199
    v_mul_f32 v200, v5, v200
    v_mul_f32 v201, v5, v201
    v_mul_f32 v202, v5, v202
    v_mul_f32 v203, v5, v203
L_rare_ob_0_4:
    s_bitcmp1_b32 s42, 5
    s_cbranch_scc0 L_rare_ob_0_5
    ds_read_b32 v5, v6 offset:320
    s_waitcnt lgkmcnt(0)
    v_mul_f32 v148, v5, v148
    v_mul_f32 v149, v5, v149
    v_mul_f32 v150, v5, v150
    v_mul_f32 v151, v5, v151
    v_mul_f32 v152, v5, v152
    v_mul_f32 v153, v5, v153
    v_mul_f32 v154, v5, v154
    v_mul_f32 v155, v5, v155
    v_mul_f32 v156, v5, v156
    v_mul_f32 v157, v5, v157
    v_mul_f32 v158, v5, v158
    v_mul_f32 v159, v5, v159
    v_mul_f32 v160, v5, v160
    v_mul_f32 v161, v5, v161
    v_mul_f32 v162, v5, v162
    v_mul_f32 v163, v5, v163
    v_mul_f32 v204, v5, v204
    v_mul_f32 v205, v5, v205
    v_mul_f32 v206, v5, v206
    v_mul_f32 v207, v5, v207
    v_mul_f32 v208, v5, v208
    v_mul_f32 v209, v5, v209
    v_mul_f32 v210, v5, v210
    v_mul_f32 v211, v5, v211
    v_mul_f32 v212, v5, v212
    v_mul_f32 v213, v5, v213
    v_mul_f32 v214, v5, v214
    v_mul_f32 v215, v5, v215
L_rare_ob_0_5:
    s_bitcmp1_b32 s42, 6
    s_cbranch_scc0 L_rare_ob_0_6
    ds_read_b32 v5, v6 offset:384
    s_waitcnt lgkmcnt(0)
    v_mul_f32 v164, v5, v164
    v_mul_f32 v165, v5, v165
    v_mul_f32 v166, v5, v166
    v_mul_f32 v167, v5, v167
    v_mul_f32 v168, v5, v168
    v_mul_f32 v169, v5, v169
    v_mul_f32 v170, v5, v170
    v_mul_f32 v171, v5, v171
    v_mul_f32 v172, v5, v172
    v_mul_f32 v173, v5, v173
    v_mul_f32 v174, v5, v174
    v_mul_f32 v175, v5, v175
    v_mul_f32 v176, v5, v176
    v_mul_f32 v177, v5, v177
    v_mul_f32 v178, v5, v178
    v_mul_f32 v179, v5, v179
    v_mul_f32 v216, v5, v216
    v_mul_f32 v217, v5, v217
    v_mul_f32 v218, v5, v218
    v_mul_f32 v219, v5, v219
    v_mul_f32 v220, v5, v220
    v_mul_f32 v221, v5, v221
    v_mul_f32 v222, v5, v222
    v_mul_f32 v223, v5, v223
    v_mul_f32 v224, v5, v224
    v_mul_f32 v225, v5, v225
    v_mul_f32 v226, v5, v226
    v_mul_f32 v227, v5, v227
L_rare_ob_0_6:
    s_nop 1
    s_setpc_b64 s[54:55]
L_rare_ob_1:
    s_nop 7
    s_mov_b32 s42, vcc_lo
    v_and_b32 v6, 15, v0
    v_lshlrev_b32 v6, 2, v6
    v_add_u32 v6, 160960, v6
    s_bitcmp1_b32 s42, 0
    s_cbranch_scc0 L_rare_ob_1_0
    ds_read_b32 v5, v6 offset:0
    s_waitcnt lgkmcnt(0)
    v_mul_f32 v68, v5, v68
    v_mul_f32 v69, v5, v69
    v_mul_f32 v70, v5, v70
    v_mul_f32 v71, v5, v71
    v_mul_f32 v72, v5, v72
    v_mul_f32 v73, v5, v73
    v_mul_f32 v74, v5, v74
    v_mul_f32 v75, v5, v75
    v_mul_f32 v76, v5, v76
    v_mul_f32 v77, v5, v77
    v_mul_f32 v78, v5, v78
    v_mul_f32 v79, v5, v79
    v_mul_f32 v80, v5, v80
    v_mul_f32 v81, v5, v81
    v_mul_f32 v82, v5, v82
    v_mul_f32 v83, v5, v83
L_rare_ob_1_0:
    s_bitcmp1_b32 s42, 1
    s_cbranch_scc0 L_rare_ob_1_1
    ds_read_b32 v5, v6 offset:64
    s_waitcnt lgkmcnt(0)
    v_mul_f32 v84, v5, v84
    v_mul_f32 v85, v5, v85
    v_mul_f32 v86, v5, v86
    v_mul_f32 v87, v5, v87
    v_mul_f32 v88, v5, v88
    v_mul_f32 v89, v5, v89
    v_mul_f32 v90, v5, v90
    v_mul_f32 v91, v5, v91
    v_mul_f32 v92, v5, v92
    v_mul_f32 v93, v5, v93
    v_mul_f32 v94, v5, v94
    v_mul_f32 v95, v5, v95
    v_mul_f32 v96, v5, v96
    v_mul_f32 v97, v5, v97
    v_mul_f32 v98, v5, v98
    v_mul_f32 v99, v5, v99
L_rare_ob_1_1:
    s_bitcmp1_b32 s42, 2
    s_cbranch_scc0 L_rare_ob_1_2
    ds_read_b32 v5, v6 offset:128
    s_waitcnt lgkmcnt(0)
    v_mul_f32 v100, v5, v100
    v_mul_f32 v101, v5, v101
    v_mul_f32 v102, v5, v102
    v_mul_f32 v103, v5, v103
    v_mul_f32 v104, v5, v104
    v_mul_f32 v105, v5, v105
    v_mul_f32 v106, v5, v106
    v_mul_f32 v107, v5, v107
    v_mul_f32 v108, v5, v108
    v_mul_f32 v109, v5, v109
    v_mul_f32 v110, v5, v110
    v_mul_f32 v111, v5, v111
    v_mul_f32 v112, v5, v112
    v_mul_f32 v113, v5, v113
    v_mul_f32 v114, v5, v114
    v_mul_f32 v115, v5, v115
L_rare_ob_1_2:
    s_bitcmp1_b32 s42, 3
    s_cbranch_scc0 L_rare_ob_1_3
    ds_read_b32 v5, v6 offset:192
    s_waitcnt lgkmcnt(0)
    v_mul_f32 v116, v5, v116
    v_mul_f32 v117, v5, v117
    v_mul_f32 v118, v5, v118
    v_mul_f32 v119, v5, v119
    v_mul_f32 v120, v5, v120
    v_mul_f32 v121, v5, v121
    v_mul_f32 v122, v5, v122
    v_mul_f32 v123, v5, v123
    v_mul_f32 v124, v5, v124
    v_mul_f32 v125, v5, v125
    v_mul_f32 v126, v5, v126
    v_mul_f32 v127, v5, v127
    v_mul_f32 v128, v5, v128
    v_mul_f32 v129, v5, v129
    v_mul_f32 v130, v5, v130
    v_mul_f32 v131, v5, v131
L_rare_ob_1_3:
    s_bitcmp1_b32 s42, 4
    s_cbranch_scc0 L_rare_ob_1_4
    ds_read_b32 v5, v6 offset:256
    s_waitcnt lgkmcnt(0)
    v_mul_f32 v132, v5, v132
    v_mul_f32 v133, v5, v133
    v_mul_f32 v134, v5, v134
    v_mul_f32 v135, v5, v135
    v_mul_f32 v136, v5, v136
    v_mul_f32 v137, v5, v137
    v_mul_f32 v138, v5, v138
    v_mul_f32 v139, v5, v139
    v_mul_f32 v140, v5, v140
    v_mul_f32 v141, v5, v141
    v_mul_f32 v142, v5, v142
    v_mul_f32 v143, v5, v143
    v_mul_f32 v144, v5, v144
    v_mul_f32 v145, v5, v145
    v_mul_f32 v146, v5, v146
    v_mul_f32 v147, v5, v147
    v_mul_f32 v192, v5, v192
    v_mul_f32 v193, v5, v193
    v_mul_f32 v194, v5, v194
    v_mul_f32 v195, v5, v195
    v_mul_f32 v196, v5, v196
    v_mul_f32 v197, v5, v197
    v_mul_f32 v198, v5, v198
    v_mul_f32 v199, v5, v199
    v_mul_f32 v200, v5, v200
    v_mul_f32 v201, v5, v201
    v_mul_f32 v202, v5, v202
    v_mul_f32 v203, v5, v203
L_rare_ob_1_4:
    s_bitcmp1_b32 s42, 5
    s_cbranch_scc0 L_rare_ob_1_5
    ds_read_b32 v5, v6 offset:320
    s_waitcnt lgkmcnt(0)
    v_mul_f32 v148, v5, v148
    v_mul_f32 v149, v5, v149
    v_mul_f32 v150, v5, v150
    v_mul_f32 v151, v5, v151
    v_mul_f32 v152, v5, v152
    v_mul_f32 v153, v5, v153
    v_mul_f32 v154, v5, v154
    v_mul_f32 v155, v5, v155
    v_mul_f32 v156, v5, v156
    v_mul_f32 v157, v5, v157
    v_mul_f32 v158, v5, v158
    v_mul_f32 v159, v5, v159
    v_mul_f32 v160, v5, v160
    v_mul_f32 v161, v5, v161
    v_mul_f32 v162, v5, v162
    v_mul_f32 v163, v5, v163
    v_mul_f32 v204, v5, v204
    v_mul_f32 v205, v5, v205
    v_mul_f32 v206, v5, v206
    v_mul_f32 v207, v5, v207
    v_mul_f32 v208, v5, v208
    v_mul_f32 v209, v5, v209
    v_mul_f32 v210, v5, v210
    v_mul_f32 v211, v5, v211
    v_mul_f32 v212, v5, v212
    v_mul_f32 v213, v5, v213
    v_mul_f32 v214, v5, v214
    v_mul_f32 v215, v5, v215
L_rare_ob_1_5:
    s_bitcmp1_b32 s42, 6
    s_cbranch_scc0 L_rare_ob_1_6
    ds_read_b32 v5, v6 offset:384
    s_waitcnt lgkmcnt(0)
    v_mul_f32 v164, v5, v164
    v_mul_f32 v165, v5, v165
    v_mul_f32 v166, v5, v166
    v_mul_f32 v167, v5, v167
    v_mul_f32 v168, v5, v168
    v_mul_f32 v169, v5, v169
    v_mul_f32 v170, v5, v170
    v_mul_f32 v171, v5, v171
    v_mul_f32 v172, v5, v172
    v_mul_f32 v173, v5, v173
    v_mul_f32 v174, v5, v174
    v_mul_f32 v175, v5, v175
    v_mul_f32 v176, v5, v176
    v_mul_f32 v177, v5, v177
    v_mul_f32 v178, v5, v178
    v_mul_f32 v179, v5, v179
    v_mul_f32 v216, v5, v216
    v_mul_f32 v217, v5, v217
    v_mul_f32 v218, v5, v218
    v_mul_f32 v219, v5, v219
    v_mul_f32 v220, v5, v220
    v_mul_f32 v221, v5, v221
    v_mul_f32 v222, v5, v222
    v_mul_f32 v223, v5, v223
    v_mul_f32 v224, v5, v224
    v_mul_f32 v225, v5, v225
    v_mul_f32 v226, v5, v226
    v_mul_f32 v227, v5, v227
L_rare_ob_1_6:
    s_nop 1
    s_setpc_b64 s[54:55]
L_code_end:
.section .rodata,"a"
.p2align 6
.amdhsa_kernel concat_heads__gqa_block_cached__gqa_block_cached__near_ridge_kernel
  .amdhsa_next_free_vgpr 256
  .amdhsa_next_free_sgpr 102
  .amdhsa_accum_offset 256
  .amdhsa_group_segment_fixed_size 0
  .amdhsa_kernarg_size 104
  .amdhsa_user_sgpr_count 2
  .amdhsa_user_sgpr_kernarg_segment_ptr 1
  .amdhsa_system_sgpr_workgroup_id_x 1
.end_amdhsa_kernel
```
